```python
import torch

def _softmax(x, axis=-1):
    return torch.softmax(x, dim=axis)
def _gelu(x):
    return torch.nn.functional.gelu(x, approximate="tanh")
def _silu(x):
    return torch.nn.functional.silu(x)
def _sigmoid(x):
    return torch.sigmoid(x)
def _layernorm(x, axis=-1, eps=1e-5):
    m = x.mean(dim=axis, keepdim=True)
    v = x.var(dim=axis, keepdim=True, unbiased=False)
    return (x - m) / torch.sqrt(v + eps)
def _scatter_add(tgt, idx, src, axis=0):
    return tgt.clone().index_add_(axis, idx, src)
def _segment_sum(src, seg, n):
    out = torch.zeros((n,) + src.shape[1:], dtype=src.dtype)
    return out.index_add_(0, seg, src)
def _pad(x, pw):
    flat = tuple(v for pair in reversed(pw) for v in pair)
    return torch.nn.functional.pad(x, flat)

kernel_name = 'interleave_layers__spectral_fnet__swiglu_ffn__prompt'

def setup_inputs():

    _w = (lambda a: (lambda t: t.to(torch.bfloat16) if t.is_floating_point() else t)(torch.as_tensor(a)))
    def _A_setup():
        B, S, D = 1, 2048, 512
        ns = torch.arange(S)[:, None] * torch.arange(S)[None, :]
        nd = torch.arange(D)[:, None] * torch.arange(D)[None, :]
        Ws_re = torch.cos(-2.0 * torch.pi * ns / S).to(float)
        Ws_im = torch.sin(-2.0 * torch.pi * ns / S).to(float)
        Wd_re = torch.cos(-2.0 * torch.pi * nd / D).to(float)
        Wd_im = torch.sin(-2.0 * torch.pi * nd / D).to(float)
        return {
            "x": _w((lambda *s: torch.randn(*s, dtype=torch.bfloat16) * 0.05)(B, S, D)),
            "dft_seq_re": _w(Ws_re),
            "dft_seq_im": _w(Ws_im),
            "dft_hid_re": _w(Wd_re),
            "dft_hid_im": _w(Wd_im),
        }
    _A_in = _A_setup()

    def _B_setup():
        B, S, D, F = 1, 2048, 512, 1376
        return {
            "x": _w((lambda *s: torch.randn(*s, dtype=torch.bfloat16) * 0.05)(B, S, D)),
            "w_gate": _w((lambda *s: torch.randn(*s, dtype=torch.bfloat16) * 0.4)(D, F)),
            "w_up": _w((lambda *s: torch.randn(*s, dtype=torch.bfloat16) * 0.4)(D, F)),
            "w_down": _w((lambda *s: torch.randn(*s, dtype=torch.bfloat16) * 0.4)(F, D)),
        }
    _B_in = _B_setup()

    return {
        "A_x": _A_in["x"],
        "A_dft_seq_re": _A_in["dft_seq_re"],
        "A_dft_seq_im": _A_in["dft_seq_im"],
        "A_dft_hid_re": _A_in["dft_hid_re"],
        "A_dft_hid_im": _A_in["dft_hid_im"],
        "B_x": _B_in["x"],
        "B_w_gate": _B_in["w_gate"],
        "B_w_up": _B_in["w_up"],
        "B_w_down": _B_in["w_down"],
    }

def reference(A_x, A_dft_seq_re, A_dft_seq_im, A_dft_hid_re, A_dft_hid_im, B_x, B_w_gate, B_w_up, B_w_down):
    def _A_ref(x, dft_seq_re, dft_seq_im, dft_hid_re, dft_hid_im):
        a = torch.einsum("bsd,ed->bse", x, dft_hid_re)
        b = torch.einsum("bsd,ed->bse", x, dft_hid_im)
        y = torch.einsum("ts,bse->bte", dft_seq_re, a) - torch.einsum("ts,bse->bte", dft_seq_im, b)
        return y

    def _B_ref(x, w_gate, w_up, w_down):
        g = _silu(x @ w_gate)
        u = x @ w_up
        return (g * u) @ w_down

    x = A_x
    x = x + _A_ref(_layernorm(x, axis=-1), A_dft_seq_re, A_dft_seq_im, A_dft_hid_re, A_dft_hid_im)
    x = x + _B_ref(_layernorm(x, axis=-1), B_w_gate, B_w_up, B_w_down)
    x = x + _A_ref(_layernorm(x, axis=-1), A_dft_seq_re, A_dft_seq_im, A_dft_hid_re, A_dft_hid_im)
    x = x + _B_ref(_layernorm(x, axis=-1), B_w_gate, B_w_up, B_w_down)
    return x
```

```asm
; @launch kernel=interleave_layers__spectral_fnet__swiglu_ffn__prompt_kernel grid=(256,1,1) block=(256,1,1) lds=163840
.amdgcn_target "amdgcn-amd-amdhsa--gfx950"
.text
.globl interleave_layers__spectral_fnet__swiglu_ffn__prompt_kernel
.p2align 8
.type interleave_layers__spectral_fnet__swiglu_ffn__prompt_kernel,@function
interleave_layers__spectral_fnet__swiglu_ffn__prompt_kernel:
    s_load_dwordx2 s[4:5], s[0:1], 0
    s_load_dwordx2 s[8:9], s[0:1], 48
    s_load_dwordx2 s[12:13], s[0:1], 56
    s_load_dwordx2 s[16:17], s[0:1], 64
    s_load_dwordx2 s[20:21], s[0:1], 72
    s_load_dwordx2 s[24:25], s[0:1], 88
    s_cmp_ge_u32 s2, 256
    s_cbranch_scc1 L_end
    s_getpc_b64 s[30:31]
L_pc:
    s_lshr_b32 s36, s2, 3
    v_and_b32 v1, 15, v0
    v_lshlrev_b32 v1, 7, v1
    v_lshl_add_u32 v1, s36, 11, v1
    v_and_b32 v248, 63, v0
    v_lshrrev_b32 v2, 6, v0
    v_min_u32 v1, 52888, v1
    v_readfirstlane_b32 s34, v2
    global_load_dword v252, v1, s[30:31]
    v_and_b32 v254, 31, v0
    v_bfe_u32 v253, v0, 5, 1
    v_lshlrev_b32 v255, 4, v248
    s_lshl_b32 s67, s34, 12
    s_add_u32 s67, s67, L_f1_table-L_pc
    v_add_u32 v66, s67, v255
    global_load_dwordx4 v[128:131], v66, s[30:31] offset:0
    global_load_dwordx4 v[132:135], v66, s[30:31] offset:1024
    global_load_dwordx4 v[144:147], v66, s[30:31] offset:2048
    global_load_dwordx4 v[148:151], v66, s[30:31] offset:3072
    s_and_b32 s35, s2, 7
    s_lshr_b32 s37, s36, 3
    s_and_b32 s38, s36, 7
    s_lshl_b32 s58, s35, 1
    s_sub_u32 s59, 32, s58
    s_cmp_eq_u32 s35, 0
    s_cselect_b32 s59, 16, s59
    s_add_u32 s60, s58, 1
    s_sub_u32 s61, 31, s58
    s_bitcmp1_b32 s37, 0
    s_cselect_b32 s58, s59, s58
    s_cselect_b32 s60, s61, s60
    s_bitcmp1_b32 s37, 1
    s_cselect_b32 s39, s60, s58
    s_mov_b32 s6, 2097152
    s_mov_b32 s7, 0x00020000
    v_lshrrev_b32 v2, 4, v248
    v_and_b32 v3, 15, v248
    v_xor_b32 v3, v3, v2
    v_lshlrev_b32 v3, 4, v3
    v_lshl_add_u32 v4, v2, 16, v3
    v_xor_b32 v5, 64, v4
    v_xor_b32 v6, 128, v4
    v_xor_b32 v7, 192, v4
    s_lshl_b32 s56, s39, 10
    s_lshl_b32 s57, s34, 8
    s_add_u32 s56, s56, s57
    s_and_b32 s63, s38, 1
    s_lshl_b32 s58, s63, 15
    s_add_u32 s59, s56, s58
    s_xor_b32 s58, s58, 0x8000
    s_add_u32 s60, s56, s58
    s_lshl_b32 s63, s63, 13
    s_lshl_b32 s61, s34, 14
    s_add_u32 s61, s61, 98304
    s_add_u32 s64, s61, s63
    s_xor_b32 s63, s63, 0x2000
    s_add_u32 s65, s61, s63
    s_mov_b32 s26, 19922944
    s_mov_b32 s27, 0x00020000
    v_bfe_u32 v8, v248, 1, 3
    s_lshr_b32 s58, s38, 1
    s_lshl_b32 s58, s58, 19
    v_lshl_add_u32 v8, v8, 16, s58
    v_and_b32 v9, 1, v248
    v_lshl_add_u32 v8, v9, 7, v8
    s_waitcnt lgkmcnt(0)
    buffer_load_dword v252, v8, s[4:7], s59 offen
    s_load_dwordx2 s[32:33], s[24:25], 0
    s_mul_i32 s42, s36, 3
    s_min_u32 s42, s42, 83
    s_cmp_ge_u32 s36, 29
    s_cselect_b32 s28, 1073741824, 0
    s_lshl_b32 s44, s35, 3
    s_lshl_b32 s58, s37, 1
    s_add_u32 s44, s44, s58
    s_mov_b32 s43, 0x3f803f80
    s_mov_b32 s75, 0
    s_mov_b32 s45, 0x3b000000
    s_mov_b32 s40, 0
    s_cmp_eq_u32 s34, 0
    s_cselect_b64 s[72:73], -1, 0
    s_getreg_b32 s41, hwreg(HW_REG_XCC_ID)
    s_and_b32 s41, s41, 7
    s_lshl_b32 s46, s35, 8
    s_lshl_b32 s58, s36, 3
    s_add_u32 s46, s46, 8192
    v_add_u32 v250, 49152, v255
    s_add_u32 s58, s58, s46
    v_mov_b32 v2, s58
    v_mov_b32 v3, 1073741824
    v_cmp_eq_u32 vcc, 0, v0
    s_mov_b32 s22, 2097152
    s_mov_b32 s23, 0x00020000
    s_mov_b32 s10, 1409024
    s_mov_b32 s11, 0x00020000
    s_mov_b32 s14, 1409024
    s_mov_b32 s15, 0x00020000
    s_mov_b32 s18, 1409024
    s_mov_b32 s19, 0x00020000
    v_cndmask_b32 v249, v3, v2, vcc
    v_mul_u32_u24 v2, 43, v248
    v_lshrrev_b32 v2, 8, v2
    v_mul_u32_u24 v3, 2656, v2
    v_lshl_add_u32 v170, v248, 4, v3
    s_lshl_b32 s85, s42, 5
    s_mul_i32 s57, s34, 44032
    s_add_u32 s85, s85, s57
    s_add_u32 s85, s85, s28
    s_mul_i32 s80, s34, 3072
    s_mul_i32 s89, s35, 1
    s_lshl_b32 s68, s38, 5
    v_add_u32 v8, s68, v254
    v_cmp_eq_u32 vcc, 0, v8
    v_mov_b32 v9, 256
    s_lshl_b32 s68, s34, 4
    v_cndmask_b32 v8, v8, v9, vcc
    v_add_u32 v9, s68, v253
    v_cvt_f32_u32 v8, v8
    v_cvt_f32_u32 v9, v9
    v_mul_f32 v8, 0xbb000000, v8
    v_mul_f32 v9, 0x41000000, v9
    s_lshr_b32 s68, s34, 1
    v_mul_f32 v9, v8, v9
    v_cvt_f32_u32 v11, s68
    v_fract_f32 v9, v9
    v_mul_f32 v11, 0x3e800000, v11
    v_sub_f32 v10, v9, v11
    v_add_f32 v11, v9, v11
    v_add_f32 v11, 0xbe800000, v11
    s_lshl_b32 s68, s68, 31
    s_xor_b32 s68, s68, 0x41800000
    v_mul_f32 v29, s68, v8
    v_mov_b32 v12, v10
    v_mov_b32 v20, v11
    v_cos_f32 v28, v29
    v_sin_f32 v29, v29
    v_add_f32 v13, v8, v12
    v_add_f32 v21, v8, v20
    v_add_f32 v14, v8, v13
    v_add_f32 v22, v8, v21
    v_add_f32 v15, v8, v14
    v_add_f32 v23, v8, v22
    v_add_f32 v16, v8, v15
    v_add_f32 v24, v8, v23
    v_add_f32 v17, v8, v16
    v_add_f32 v25, v8, v24
    v_add_f32 v18, v8, v17
    v_add_f32 v26, v8, v25
    v_add_f32 v19, v8, v18
    v_add_f32 v27, v8, v26
    v_cos_f32 v12, v12
    v_cos_f32 v13, v13
    v_cos_f32 v14, v14
    v_cos_f32 v15, v15
    v_cos_f32 v16, v16
    v_cos_f32 v17, v17
    v_cos_f32 v18, v18
    v_cos_f32 v19, v19
    v_cos_f32 v20, v20
    v_cos_f32 v21, v21
    v_cos_f32 v22, v22
    v_cos_f32 v23, v23
    v_cos_f32 v24, v24
    v_cos_f32 v25, v25
    v_cos_f32 v26, v26
    v_cos_f32 v27, v27
    v_pk_mov_b32 v[48:49], v[12:13], v[12:13] op_sel:[0,1]
    v_pk_mov_b32 v[50:51], v[14:15], v[14:15] op_sel:[0,1]
    v_pk_mov_b32 v[52:53], v[16:17], v[16:17] op_sel:[0,1]
    v_pk_mov_b32 v[54:55], v[18:19], v[18:19] op_sel:[0,1]
    v_pk_mov_b32 v[56:57], v[20:21], v[20:21] op_sel:[0,1]
    v_pk_mov_b32 v[58:59], v[22:23], v[22:23] op_sel:[0,1]
    v_pk_mov_b32 v[60:61], v[24:25], v[24:25] op_sel:[0,1]
    v_pk_mov_b32 v[62:63], v[26:27], v[26:27] op_sel:[0,1]
    v_pk_mul_f32 v[32:33], v[56:57], v[28:29] op_sel:[0,1] op_sel_hi:[1,1]
    v_pk_mul_f32 v[34:35], v[48:49], v[28:29] op_sel:[0,1] op_sel_hi:[1,1]
    v_pk_fma_f32 v[48:49], v[48:49], v[28:29], v[32:33] op_sel_hi:[1,0,1] neg_lo:[0,0,1] neg_hi:[0,0,1]
    v_pk_fma_f32 v[56:57], v[56:57], v[28:29], v[34:35] op_sel_hi:[1,0,1]
    v_pk_mul_f32 v[36:37], v[58:59], v[28:29] op_sel:[0,1] op_sel_hi:[1,1]
    v_pk_mul_f32 v[38:39], v[50:51], v[28:29] op_sel:[0,1] op_sel_hi:[1,1]
    v_pk_fma_f32 v[50:51], v[50:51], v[28:29], v[36:37] op_sel_hi:[1,0,1] neg_lo:[0,0,1] neg_hi:[0,0,1]
    v_pk_fma_f32 v[58:59], v[58:59], v[28:29], v[38:39] op_sel_hi:[1,0,1]
    v_pk_mul_f32 v[32:33], v[60:61], v[28:29] op_sel:[0,1] op_sel_hi:[1,1]
    v_pk_mul_f32 v[34:35], v[52:53], v[28:29] op_sel:[0,1] op_sel_hi:[1,1]
    v_pk_fma_f32 v[52:53], v[52:53], v[28:29], v[32:33] op_sel_hi:[1,0,1] neg_lo:[0,0,1] neg_hi:[0,0,1]
    v_pk_fma_f32 v[60:61], v[60:61], v[28:29], v[34:35] op_sel_hi:[1,0,1]
    v_pk_mul_f32 v[36:37], v[62:63], v[28:29] op_sel:[0,1] op_sel_hi:[1,1]
    v_pk_mul_f32 v[38:39], v[54:55], v[28:29] op_sel:[0,1] op_sel_hi:[1,1]
    v_pk_fma_f32 v[54:55], v[54:55], v[28:29], v[36:37] op_sel_hi:[1,0,1] neg_lo:[0,0,1] neg_hi:[0,0,1]
    v_pk_fma_f32 v[62:63], v[62:63], v[28:29], v[38:39] op_sel_hi:[1,0,1]
    v_add_f32 v28, v28, v28
    s_mov_b32 s68, 0
L_genb:
    s_set_gpr_idx_on s68, gpr_idx(DST)
    s_nop 0
    v_cvt_pk_bf16_f32 v184, v12, v13
    v_cvt_pk_bf16_f32 v185, v14, v15
    v_cvt_pk_bf16_f32 v186, v16, v17
    v_cvt_pk_bf16_f32 v187, v18, v19
    v_cvt_pk_bf16_f32 v216, v20, v21
    v_cvt_pk_bf16_f32 v217, v22, v23
    v_cvt_pk_bf16_f32 v218, v24, v25
    v_cvt_pk_bf16_f32 v219, v26, v27
    v_cvt_pk_bf16_f32 v188, v48, v49
    v_cvt_pk_bf16_f32 v189, v50, v51
    v_cvt_pk_bf16_f32 v190, v52, v53
    v_cvt_pk_bf16_f32 v191, v54, v55
    v_cvt_pk_bf16_f32 v220, v56, v57
    v_cvt_pk_bf16_f32 v221, v58, v59
    v_cvt_pk_bf16_f32 v222, v60, v61
    v_cvt_pk_bf16_f32 v223, v62, v63
    s_set_gpr_idx_off
    v_pk_fma_f32 v[12:13], v[48:49], v[28:29], v[12:13] op_sel_hi:[1,0,1] neg_lo:[0,0,1] neg_hi:[0,0,1]
    v_pk_fma_f32 v[14:15], v[50:51], v[28:29], v[14:15] op_sel_hi:[1,0,1] neg_lo:[0,0,1] neg_hi:[0,0,1]
    v_pk_fma_f32 v[16:17], v[52:53], v[28:29], v[16:17] op_sel_hi:[1,0,1] neg_lo:[0,0,1] neg_hi:[0,0,1]
    v_pk_fma_f32 v[18:19], v[54:55], v[28:29], v[18:19] op_sel_hi:[1,0,1] neg_lo:[0,0,1] neg_hi:[0,0,1]
    v_pk_fma_f32 v[20:21], v[56:57], v[28:29], v[20:21] op_sel_hi:[1,0,1] neg_lo:[0,0,1] neg_hi:[0,0,1]
    v_pk_fma_f32 v[22:23], v[58:59], v[28:29], v[22:23] op_sel_hi:[1,0,1] neg_lo:[0,0,1] neg_hi:[0,0,1]
    v_pk_fma_f32 v[24:25], v[60:61], v[28:29], v[24:25] op_sel_hi:[1,0,1] neg_lo:[0,0,1] neg_hi:[0,0,1]
    v_pk_fma_f32 v[26:27], v[62:63], v[28:29], v[26:27] op_sel_hi:[1,0,1] neg_lo:[0,0,1] neg_hi:[0,0,1]
    v_pk_fma_f32 v[48:49], v[12:13], v[28:29], v[48:49] op_sel_hi:[1,0,1] neg_lo:[0,0,1] neg_hi:[0,0,1]
    v_pk_fma_f32 v[50:51], v[14:15], v[28:29], v[50:51] op_sel_hi:[1,0,1] neg_lo:[0,0,1] neg_hi:[0,0,1]
    v_pk_fma_f32 v[52:53], v[16:17], v[28:29], v[52:53] op_sel_hi:[1,0,1] neg_lo:[0,0,1] neg_hi:[0,0,1]
    v_pk_fma_f32 v[54:55], v[18:19], v[28:29], v[54:55] op_sel_hi:[1,0,1] neg_lo:[0,0,1] neg_hi:[0,0,1]
    v_pk_fma_f32 v[56:57], v[20:21], v[28:29], v[56:57] op_sel_hi:[1,0,1] neg_lo:[0,0,1] neg_hi:[0,0,1]
    v_pk_fma_f32 v[58:59], v[22:23], v[28:29], v[58:59] op_sel_hi:[1,0,1] neg_lo:[0,0,1] neg_hi:[0,0,1]
    v_pk_fma_f32 v[60:61], v[24:25], v[28:29], v[60:61] op_sel_hi:[1,0,1] neg_lo:[0,0,1] neg_hi:[0,0,1]
    v_pk_fma_f32 v[62:63], v[26:27], v[28:29], v[62:63] op_sel_hi:[1,0,1] neg_lo:[0,0,1] neg_hi:[0,0,1]
    s_add_u32 s68, s68, 8
    s_cmp_lt_u32 s68, 16
    s_cbranch_scc1 L_genb
    v_lshrrev_b32 v44, 3, v248
    v_and_b32 v45, 7, v248
    v_lshlrev_b32 v44, 15, v44
    v_lshl_add_u32 v44, v45, 4, v44
    s_lshl_b32 s57, s34, 19
    s_lshl_b32 s58, s39, 10
    s_add_u32 s57, s57, s58
    s_lshl_b32 s58, s38, 7
    s_add_u32 s47, s57, s58
    v_mov_b32 v40, -1
    v_mov_b32 v41, -1
    v_mov_b32 v42, -1
    v_mov_b32 v43, -1
    s_add_u32 s58, s47, 12582912
    buffer_store_dwordx4 v[40:43], v44, s[24:27], s58 offen sc1
    s_add_u32 s58, s47, 12845056
    buffer_store_dwordx4 v[40:43], v44, s[24:27], s58 offen sc1
    s_and_b32 s57, s34, 1
    s_lshl_b32 s57, s57, 4
    v_xor_b32 v3, s57, v254
    v_and_b32 v2, 15, v254
    v_xor_b32 v2, v2, v253
    v_lshlrev_b32 v2, 4, v2
    s_lshl_b32 s67, s34, 14
    s_add_u32 s67, s67, 98304
    v_lshl_add_u32 v174, v254, 8, v2
    v_lshl_add_u32 v2, v3, 8, v2
    v_add_u32 v160, s67, v2
    s_sub_u32 s57, 15, s38
    s_lshr_b32 s58, s34, 1
    s_cmp_lg_u32 s58, 0
    s_cselect_b32 s57, s57, s38
    s_lshr_b32 s58, s57, 2
    s_lshl_b32 s58, s58, 14
    s_and_b32 s66, s34, 1
    s_lshl_b32 s66, s66, 13
    s_add_u32 s58, s58, s66
    s_add_u32 s58, s58, 98304
    s_and_b32 s57, s57, 3
    s_lshl_b32 s57, s57, 6
    v_xor_b32 v174, s57, v174
    v_add_u32 v174, s58, v174
    v_xor_b32 v175, 32, v174
    s_lshl_b32 s58, s34, 4
    s_add_u32 s58, s58, 147456
    v_lshlrev_b32 v3, 6, v3
    v_lshl_add_u32 v173, v253, 3, v3
    v_add_u32 v173, s58, v173
    v_and_b32 v3, 15, v254
    s_and_b32 s66, s34, 1
    s_lshl_b32 s66, s66, 10
    s_add_u32 s66, s66, 147456
    v_lshl_add_u32 v172, v3, 6, s66
    v_xor_b32 v161, 32, v160
    v_xor_b32 v162, 64, v160
    v_xor_b32 v163, 96, v160
    v_xor_b32 v164, 128, v160
    v_xor_b32 v165, 160, v160
    v_xor_b32 v166, 192, v160
    v_xor_b32 v167, 224, v160
    v_mov_b32 v180, 0
    v_mov_b32 v181, 0
    v_mov_b32 v182, 0
    v_mov_b32 v183, 0
    v_lshrrev_b32 v171, 3, v248
    v_and_b32 v2, 7, v248
    v_lshlrev_b32 v171, 10, v171
    v_lshl_add_u32 v171, v2, 4, v171
    s_mul_i32 s81, s39, 3
    s_add_u32 s81, s81, s34
    s_lshl_b32 s83, s81, 14
    s_lshl_b32 s84, s38, 7
    s_add_u32 s83, s83, s84
    s_add_u32 s84, s83, 8192
    s_add_u32 s82, s89, 7
    s_and_b32 s82, s82, 7
    s_mul_i32 s82, s82, 12288
    s_add_u32 s82, s82, s80
    s_add_u32 m0, s64, 0
    s_add_u32 s62, s59, 0
    buffer_load_dwordx4 v4, s[4:7], s62 offen lds
    v_cvt_pk_bf16_f32 v200, v12, v13
    v_cvt_pk_bf16_f32 v201, v14, v15
    v_cvt_pk_bf16_f32 v202, v16, v17
    s_add_u32 m0, s64, 1024
    s_add_u32 s62, s59, 262144
    buffer_load_dwordx4 v5, s[4:7], s62 offen lds
    v_cvt_pk_bf16_f32 v203, v18, v19
    v_cvt_pk_bf16_f32 v232, v20, v21
    v_cvt_pk_bf16_f32 v233, v22, v23
    s_add_u32 m0, s64, 2048
    s_add_u32 s62, s59, 524288
    buffer_load_dwordx4 v6, s[4:7], s62 offen lds
    v_cvt_pk_bf16_f32 v234, v24, v25
    v_cvt_pk_bf16_f32 v235, v26, v27
    v_cvt_pk_bf16_f32 v204, v48, v49
    s_add_u32 m0, s64, 3072
    s_add_u32 s62, s59, 786432
    buffer_load_dwordx4 v7, s[4:7], s62 offen lds
    v_cvt_pk_bf16_f32 v205, v50, v51
    v_cvt_pk_bf16_f32 v206, v52, v53
    v_cvt_pk_bf16_f32 v207, v54, v55
    s_add_u32 m0, s64, 4096
    s_add_u32 s62, s59, 1048576
    buffer_load_dwordx4 v4, s[4:7], s62 offen lds
    v_cvt_pk_bf16_f32 v236, v56, v57
    v_cvt_pk_bf16_f32 v237, v58, v59
    v_cvt_pk_bf16_f32 v238, v60, v61
    s_add_u32 m0, s64, 5120
    s_add_u32 s62, s59, 1310720
    buffer_load_dwordx4 v5, s[4:7], s62 offen lds
    v_cvt_pk_bf16_f32 v239, v62, v63
    v_pk_fma_f32 v[12:13], v[48:49], v[28:29], v[12:13] op_sel_hi:[1,0,1] neg_lo:[0,0,1] neg_hi:[0,0,1]
    v_pk_fma_f32 v[14:15], v[50:51], v[28:29], v[14:15] op_sel_hi:[1,0,1] neg_lo:[0,0,1] neg_hi:[0,0,1]
    s_add_u32 m0, s64, 6144
    s_add_u32 s62, s59, 1572864
    buffer_load_dwordx4 v6, s[4:7], s62 offen lds
    v_pk_fma_f32 v[16:17], v[52:53], v[28:29], v[16:17] op_sel_hi:[1,0,1] neg_lo:[0,0,1] neg_hi:[0,0,1]
    v_pk_fma_f32 v[18:19], v[54:55], v[28:29], v[18:19] op_sel_hi:[1,0,1] neg_lo:[0,0,1] neg_hi:[0,0,1]
    v_pk_fma_f32 v[20:21], v[56:57], v[28:29], v[20:21] op_sel_hi:[1,0,1] neg_lo:[0,0,1] neg_hi:[0,0,1]
    s_add_u32 m0, s64, 7168
    s_add_u32 s62, s59, 1835008
    buffer_load_dwordx4 v7, s[4:7], s62 offen lds
    v_pk_fma_f32 v[22:23], v[58:59], v[28:29], v[22:23] op_sel_hi:[1,0,1] neg_lo:[0,0,1] neg_hi:[0,0,1]
    v_pk_fma_f32 v[24:25], v[60:61], v[28:29], v[24:25] op_sel_hi:[1,0,1] neg_lo:[0,0,1] neg_hi:[0,0,1]
    v_pk_fma_f32 v[26:27], v[62:63], v[28:29], v[26:27] op_sel_hi:[1,0,1] neg_lo:[0,0,1] neg_hi:[0,0,1]
    s_add_u32 m0, s65, 0
    s_add_u32 s62, s60, 0
    buffer_load_dwordx4 v4, s[4:7], s62 offen lds
    v_pk_fma_f32 v[48:49], v[12:13], v[28:29], v[48:49] op_sel_hi:[1,0,1] neg_lo:[0,0,1] neg_hi:[0,0,1]
    v_pk_fma_f32 v[50:51], v[14:15], v[28:29], v[50:51] op_sel_hi:[1,0,1] neg_lo:[0,0,1] neg_hi:[0,0,1]
    v_pk_fma_f32 v[52:53], v[16:17], v[28:29], v[52:53] op_sel_hi:[1,0,1] neg_lo:[0,0,1] neg_hi:[0,0,1]
    s_add_u32 m0, s65, 1024
    s_add_u32 s62, s60, 262144
    buffer_load_dwordx4 v5, s[4:7], s62 offen lds
    v_pk_fma_f32 v[54:55], v[18:19], v[28:29], v[54:55] op_sel_hi:[1,0,1] neg_lo:[0,0,1] neg_hi:[0,0,1]
    v_pk_fma_f32 v[56:57], v[20:21], v[28:29], v[56:57] op_sel_hi:[1,0,1] neg_lo:[0,0,1] neg_hi:[0,0,1]
    v_pk_fma_f32 v[58:59], v[22:23], v[28:29], v[58:59] op_sel_hi:[1,0,1] neg_lo:[0,0,1] neg_hi:[0,0,1]
    s_add_u32 m0, s65, 2048
    s_add_u32 s62, s60, 524288
    buffer_load_dwordx4 v6, s[4:7], s62 offen lds
    v_pk_fma_f32 v[60:61], v[24:25], v[28:29], v[60:61] op_sel_hi:[1,0,1] neg_lo:[0,0,1] neg_hi:[0,0,1]
    v_pk_fma_f32 v[62:63], v[26:27], v[28:29], v[62:63] op_sel_hi:[1,0,1] neg_lo:[0,0,1] neg_hi:[0,0,1]
    v_cvt_pk_bf16_f32 v208, v12, v13
    s_add_u32 m0, s65, 3072
    s_add_u32 s62, s60, 786432
    buffer_load_dwordx4 v7, s[4:7], s62 offen lds
    v_cvt_pk_bf16_f32 v209, v14, v15
    v_cvt_pk_bf16_f32 v210, v16, v17
    v_cvt_pk_bf16_f32 v211, v18, v19
    s_add_u32 m0, s65, 4096
    s_add_u32 s62, s60, 1048576
    buffer_load_dwordx4 v4, s[4:7], s62 offen lds
    v_cvt_pk_bf16_f32 v240, v20, v21
    v_cvt_pk_bf16_f32 v241, v22, v23
    v_cvt_pk_bf16_f32 v242, v24, v25
    s_add_u32 m0, s65, 5120
    s_add_u32 s62, s60, 1310720
    buffer_load_dwordx4 v5, s[4:7], s62 offen lds
    v_cvt_pk_bf16_f32 v243, v26, v27
    v_cvt_pk_bf16_f32 v212, v48, v49
    v_cvt_pk_bf16_f32 v213, v50, v51
    s_add_u32 m0, s65, 6144
    s_add_u32 s62, s60, 1572864
    buffer_load_dwordx4 v6, s[4:7], s62 offen lds
    v_cvt_pk_bf16_f32 v214, v52, v53
    v_cvt_pk_bf16_f32 v215, v54, v55
    v_cvt_pk_bf16_f32 v244, v56, v57
    s_add_u32 m0, s65, 7168
    s_add_u32 s62, s60, 1835008
    buffer_load_dwordx4 v7, s[4:7], s62 offen lds
    v_cvt_pk_bf16_f32 v245, v58, v59
    v_cvt_pk_bf16_f32 v246, v60, v61
    v_cvt_pk_bf16_f32 v247, v62, v63
    s_barrier
    s_and_b32 s58, s34, 1
    s_add_u32 s58, s58, s44
    s_lshl_b32 s58, s58, 12
    s_lshl_b32 s57, s38, 9
    s_add_u32 s58, s58, s57
    s_add_u32 s58, s58, 5242880
    v_and_b32 v46, 3, v248
    v_lshl_add_u32 v46, v46, 7, s58
    v_cmp_eq_u32 vcc, 0, v253
    v_and_b32 v47, 1, v248
    v_lshl_add_u32 v47, v47, 7, s46
    v_cndmask_b32 v46, v47, v46, vcc
    buffer_load_dword v252, v46, s[24:27], 0 offen sc1
    s_bfm_b64 exec, 48, 0
    s_add_u32 s86, s89, 0
    s_and_b32 s86, s86, 7
    s_mul_i32 s87, s86, 12288
    s_mul_i32 s88, s86, 176128
    s_add_u32 s87, s87, s80
    s_add_u32 s88, s88, s85
    s_add_u32 m0, s87, 0
    s_add_u32 s86, s88, 0
    buffer_load_dwordx4 v170, s[8:11], s86 offen lds
    s_add_u32 m0, s87, 768
    s_add_u32 s86, s88, 22016
    buffer_load_dwordx4 v170, s[8:11], s86 offen lds
    s_add_u32 m0, s87, 1536
    s_add_u32 s86, s88, 0
    buffer_load_dwordx4 v170, s[12:15], s86 offen lds
    s_add_u32 m0, s87, 2304
    s_add_u32 s86, s88, 22016
    buffer_load_dwordx4 v170, s[12:15], s86 offen lds
    s_mov_b64 exec, -1
    s_branch L_body
.p2align 7
.type L_f1_table,@object
L_f1_table:
.long 0x3f803f80,0x3f803f80,0x3f803f80,0x3f803f80
.long 0x0,0x0,0x0,0x0
.long 0x3f7b3f80,0x3f553f6d,0xbe480000,0xbf0ebec4
.long 0xbe480000,0xbf0ebec4,0xbf7bbf80,0xbf55bf6d
.long 0x3f6d3f80,0x3ec43f35,0xbf6dbf80,0xbec4bf35
.long 0xbec40000,0xbf6dbf35,0x3ec40000,0x3f6d3f35
.long 0x3f553f80,0xbe483ec4,0x3f0e0000,0x3f7b3f6d
.long 0xbf0e0000,0xbf7bbf6d,0x3f553f80,0xbe483ec4
.long 0x3f353f80,0xbf350000,0x3f353f80,0xbf350000
.long 0xbf350000,0xbf35bf80,0xbf350000,0xbf35bf80
.long 0x3f0e3f80,0xbf7bbec4,0xbf550000,0xbe48bf6d
.long 0xbf550000,0xbe48bf6d,0xbf0ebf80,0x3f7b3ec4
.long 0x3ec43f80,0xbf6dbf35,0xbec4bf80,0x3f6d3f35
.long 0xbf6d0000,0x3ec4bf35,0x3f6d0000,0xbec43f35
.long 0x3e483f80,0xbf0ebf6d,0x3f7b0000,0xbf553ec4
.long 0xbf7b0000,0x3f55bec4,0x3e483f80,0xbf0ebf6d
.long 0x3f80,0xbf80,0x3f80,0xbf80
.long 0xbf800000,0x3f800000,0xbf800000,0x3f800000
.long 0xbe483f80,0x3f0ebf6d,0xbf7b0000,0x3f553ec4
.long 0xbf7b0000,0x3f553ec4,0x3e48bf80,0xbf0e3f6d
.long 0xbec43f80,0x3f6dbf35,0x3ec4bf80,0xbf6d3f35
.long 0xbf6d0000,0x3ec43f35,0x3f6d0000,0xbec4bf35
.long 0xbf0e3f80,0x3f7bbec4,0x3f550000,0x3e48bf6d
.long 0xbf550000,0xbe483f6d,0xbf0e3f80,0x3f7bbec4
.long 0xbf353f80,0x3f350000,0xbf353f80,0x3f350000
.long 0xbf350000,0xbf353f80,0xbf350000,0xbf353f80
.long 0xbf553f80,0x3e483ec4,0xbf0e0000,0xbf7b3f6d
.long 0xbf0e0000,0xbf7b3f6d,0x3f55bf80,0xbe48bec4
.long 0xbf6d3f80,0xbec43f35,0x3f6dbf80,0x3ec4bf35
.long 0xbec40000,0xbf6d3f35,0x3ec40000,0x3f6dbf35
.long 0xbf7b3f80,0xbf553f6d,0x3e480000,0x3f0ebec4
.long 0xbe480000,0xbf0e3ec4,0xbf7b3f80,0xbf553f6d
.long 0x3f803f80,0x3f803f80,0x3f803f80,0x3f803f80
.long 0x0,0x0,0x0,0x0
.long 0x3f0e3f35,0x3e483ec4,0xbf55bf35,0xbf7bbf6d
.long 0xbf55bf35,0xbf7bbf6d,0xbf0ebf35,0xbe48bec4
.long 0xbec40000,0xbf6dbf35,0x3ec40000,0x3f6d3f35
.long 0xbf6dbf80,0xbec4bf35,0x3f6d3f80,0x3ec43f35
.long 0xbf7bbf35,0xbf0ebf6d,0x3e483f35,0xbf55bec4
.long 0xbe48bf35,0x3f553ec4,0xbf7bbf35,0xbf0ebf6d
.long 0xbf35bf80,0x3f350000,0xbf35bf80,0x3f350000
.long 0x3f350000,0x3f353f80,0x3f350000,0x3f353f80
.long 0x3e48bf35,0x3f553f6d,0x3f7b3f35,0xbf0e3ec4
.long 0x3f7b3f35,0xbf0e3ec4,0xbe483f35,0xbf55bf6d
.long 0x3f6d0000,0xbec43f35,0xbf6d0000,0x3ec4bf35
.long 0x3ec43f80,0xbf6dbf35,0xbec4bf80,0x3f6d3f35
.long 0x3f553f35,0xbf7bbec4,0x3f0ebf35,0xbe483f6d
.long 0xbf0e3f35,0x3e48bf6d,0x3f553f35,0xbf7bbec4
.long 0x3f80,0xbf80,0x3f80,0xbf80
.long 0xbf800000,0x3f800000,0xbf800000,0x3f800000
.long 0xbf553f35,0x3f7bbec4,0xbf0ebf35,0x3e483f6d
.long 0xbf0ebf35,0x3e483f6d,0x3f55bf35,0xbf7b3ec4
.long 0xbf6d0000,0x3ec43f35,0x3f6d0000,0xbec4bf35
.long 0x3ec4bf80,0xbf6d3f35,0xbec43f80,0x3f6dbf35
.long 0xbe48bf35,0xbf553f6d,0xbf7b3f35,0x3f0e3ec4
.long 0x3f7bbf35,0xbf0ebec4,0xbe48bf35,0xbf553f6d
.long 0x3f35bf80,0xbf350000,0x3f35bf80,0xbf350000
.long 0x3f350000,0x3f35bf80,0x3f350000,0x3f35bf80
.long 0x3f7bbf35,0x3f0ebf6d,0xbe483f35,0x3f55bec4
.long 0xbe483f35,0x3f55bec4,0xbf7b3f35,0xbf0e3f6d
.long 0x3ec40000,0x3f6dbf35,0xbec40000,0xbf6d3f35
.long 0xbf6d3f80,0xbec43f35,0x3f6dbf80,0x3ec4bf35
.long 0xbf0e3f35,0xbe483ec4,0x3f55bf35,0x3f7bbf6d
.long 0xbf553f35,0xbf7b3f6d,0xbf0e3f35,0xbe483ec4
.long 0x3f803f80,0x3f803f80,0x3f803f80,0x3f803f80
.long 0x0,0x0,0x0,0x0
.long 0xbf7bbf80,0xbf55bf6d,0x3e480000,0x3f0e3ec4
.long 0x3e480000,0x3f0e3ec4,0x3f7b3f80,0x3f553f6d
.long 0x3f6d3f80,0x3ec43f35,0xbf6dbf80,0xbec4bf35
.long 0xbec40000,0xbf6dbf35,0x3ec40000,0x3f6d3f35
.long 0xbf55bf80,0x3e48bec4,0xbf0e0000,0xbf7bbf6d
.long 0x3f0e0000,0x3f7b3f6d,0xbf55bf80,0x3e48bec4
.long 0x3f353f80,0xbf350000,0x3f353f80,0xbf350000
.long 0xbf350000,0xbf35bf80,0xbf350000,0xbf35bf80
.long 0xbf0ebf80,0x3f7b3ec4,0x3f550000,0x3e483f6d
.long 0x3f550000,0x3e483f6d,0x3f0e3f80,0xbf7bbec4
.long 0x3ec43f80,0xbf6dbf35,0xbec4bf80,0x3f6d3f35
.long 0xbf6d0000,0x3ec4bf35,0x3f6d0000,0xbec43f35
.long 0xbe48bf80,0x3f0e3f6d,0xbf7b0000,0x3f55bec4
.long 0x3f7b0000,0xbf553ec4,0xbe48bf80,0x3f0e3f6d
.long 0x3f80,0xbf80,0x3f80,0xbf80
.long 0xbf800000,0x3f800000,0xbf800000,0x3f800000
.long 0x3e48bf80,0xbf0e3f6d,0x3f7b0000,0xbf55bec4
.long 0x3f7b0000,0xbf55bec4,0xbe483f80,0x3f0ebf6d
.long 0xbec43f80,0x3f6dbf35,0x3ec4bf80,0xbf6d3f35
.long 0xbf6d0000,0x3ec43f35,0x3f6d0000,0xbec4bf35
.long 0x3f0ebf80,0xbf7b3ec4,0xbf550000,0xbe483f6d
.long 0x3f550000,0x3e48bf6d,0x3f0ebf80,0xbf7b3ec4
.long 0xbf353f80,0x3f350000,0xbf353f80,0x3f350000
.long 0xbf350000,0xbf353f80,0xbf350000,0xbf353f80
.long 0x3f55bf80,0xbe48bec4,0x3f0e0000,0x3f7bbf6d
.long 0x3f0e0000,0x3f7bbf6d,0xbf553f80,0x3e483ec4
.long 0xbf6d3f80,0xbec43f35,0x3f6dbf80,0x3ec4bf35
.long 0xbec40000,0xbf6d3f35,0x3ec40000,0x3f6dbf35
.long 0x3f7bbf80,0x3f55bf6d,0xbe480000,0xbf0e3ec4
.long 0x3e480000,0x3f0ebec4,0x3f7bbf80,0x3f55bf6d
.long 0x3f803f80,0x3f803f80,0x3f803f80,0x3f803f80
.long 0x0,0x0,0x0,0x0
.long 0xbf0ebf35,0xbe48bec4,0x3f553f35,0x3f7b3f6d
.long 0x3f553f35,0x3f7b3f6d,0x3f0e3f35,0x3e483ec4
.long 0xbec40000,0xbf6dbf35,0x3ec40000,0x3f6d3f35
.long 0xbf6dbf80,0xbec4bf35,0x3f6d3f80,0x3ec43f35
.long 0x3f7b3f35,0x3f0e3f6d,0xbe48bf35,0x3f553ec4
.long 0x3e483f35,0xbf55bec4,0x3f7b3f35,0x3f0e3f6d
.long 0xbf35bf80,0x3f350000,0xbf35bf80,0x3f350000
.long 0x3f350000,0x3f353f80,0x3f350000,0x3f353f80
.long 0xbe483f35,0xbf55bf6d,0xbf7bbf35,0x3f0ebec4
.long 0xbf7bbf35,0x3f0ebec4,0x3e48bf35,0x3f553f6d
.long 0x3f6d0000,0xbec43f35,0xbf6d0000,0x3ec4bf35
.long 0x3ec43f80,0xbf6dbf35,0xbec4bf80,0x3f6d3f35
.long 0xbf55bf35,0x3f7b3ec4,0xbf0e3f35,0x3e48bf6d
.long 0x3f0ebf35,0xbe483f6d,0xbf55bf35,0x3f7b3ec4
.long 0x3f80,0xbf80,0x3f80,0xbf80
.long 0xbf800000,0x3f800000,0xbf800000,0x3f800000
.long 0x3f55bf35,0xbf7b3ec4,0x3f0e3f35,0xbe48bf6d
.long 0x3f0e3f35,0xbe48bf6d,0xbf553f35,0x3f7bbec4
.long 0xbf6d0000,0x3ec43f35,0x3f6d0000,0xbec4bf35
.long 0x3ec4bf80,0xbf6d3f35,0xbec43f80,0x3f6dbf35
.long 0x3e483f35,0x3f55bf6d,0x3f7bbf35,0xbf0ebec4
.long 0xbf7b3f35,0x3f0e3ec4,0x3e483f35,0x3f55bf6d
.long 0x3f35bf80,0xbf350000,0x3f35bf80,0xbf350000
.long 0x3f350000,0x3f35bf80,0x3f350000,0x3f35bf80
.long 0xbf7b3f35,0xbf0e3f6d,0x3e48bf35,0xbf553ec4
.long 0x3e48bf35,0xbf553ec4,0x3f7bbf35,0x3f0ebf6d
.long 0x3ec40000,0x3f6dbf35,0xbec40000,0xbf6d3f35
.long 0xbf6d3f80,0xbec43f35,0x3f6dbf80,0x3ec4bf35
.long 0x3f0ebf35,0x3e48bec4,0xbf553f35,0xbf7b3f6d
.long 0x3f55bf35,0x3f7bbf6d,0x3f0ebf35,0x3e48bec4
.long 0x3f803f80,0x3f803f80,0x3f803f80,0x3f803f80
.long 0x0,0x0,0x0,0x0
.long 0x3f753f7f,0x3f463f62,0xbe95bdc9,0xbf22bef1
.long 0xbe95bdc9,0xbf22bef1,0xbf75bf7f,0xbf46bf62
.long 0x3f553f7b,0x3e483f0e,0xbf55bf7b,0xbe48bf0e
.long 0xbf0ebe48,0xbf7bbf55,0x3f0e3e48,0x3f7b3f55
.long 0x3f223f75,0xbef13dc9,0x3f463e95,0x3f623f7f
.long 0xbf46be95,0xbf62bf7f,0x3f223f75,0xbef13dc9
.long 0x3ec43f6d,0xbf6dbec4,0x3ec43f6d,0xbf6dbec4
.long 0xbf6dbec4,0xbec4bf6d,0xbf6dbec4,0xbec4bf6d
.long 0x3dc93f62,0xbf75bf46,0xbf7fbef1,0x3e95bf22
.long 0xbf7fbef1,0x3e95bf22,0xbdc9bf62,0x3f753f46
.long 0xbe483f55,0xbf0ebf7b,0x3e48bf55,0x3f0e3f7b
.long 0xbf7bbf0e,0x3f55be48,0x3f7b3f0e,0xbf553e48
.long 0xbef13f46,0x3dc9bf75,0x3f623f22,0xbf7fbe95
.long 0xbf62bf22,0x3f7f3e95,0xbef13f46,0x3dc9bf75
.long 0xbf353f35,0x3f35bf35,0xbf353f35,0x3f35bf35
.long 0xbf35bf35,0x3f353f35,0xbf35bf35,0x3f353f35
.long 0xbf623f22,0x3f7fbe95,0xbef1bf46,0x3dc93f75
.long 0xbef1bf46,0x3dc93f75,0x3f62bf22,0xbf7f3e95
.long 0xbf7b3f0e,0x3f553e48,0x3f7bbf0e,0xbf55be48
.long 0xbe48bf55,0xbf0e3f7b,0x3e483f55,0x3f0ebf7b
.long 0xbf7f3ef1,0x3e953f22,0xbdc93f62,0x3f75bf46
.long 0x3dc9bf62,0xbf753f46,0xbf7f3ef1,0x3e953f22
.long 0xbf6d3ec4,0xbec43f6d,0xbf6d3ec4,0xbec43f6d
.long 0x3ec4bf6d,0xbf6d3ec4,0x3ec4bf6d,0xbf6d3ec4
.long 0xbf463e95,0xbf623f7f,0x3f22bf75,0xbef1bdc9
.long 0x3f22bf75,0xbef1bdc9,0x3f46be95,0x3f62bf7f
.long 0xbf0e3e48,0xbf7b3f55,0x3f0ebe48,0x3f7bbf55
.long 0x3f55bf7b,0x3e48bf0e,0xbf553f7b,0xbe483f0e
.long 0xbe953dc9,0xbf223ef1,0xbf753f7f,0xbf463f62
.long 0x3f75bf7f,0x3f46bf62,0xbe953dc9,0xbf223ef1
.long 0x3f803f80,0x3f803f80,0x3f803f80,0x3f803f80
.long 0x0,0x0,0x0,0x0
.long 0x3ef13f22,0x3dc93e95,0xbf62bf46,0xbf7fbf75
.long 0xbf62bf46,0xbf7fbf75,0xbef1bf22,0xbdc9be95
.long 0xbf0ebe48,0xbf7bbf55,0x3f0e3e48,0x3f7b3f55
.long 0xbf55bf7b,0xbe48bf0e,0x3f553f7b,0x3e483f0e
.long 0xbf7fbf62,0xbe95bf46,0xbdc93ef1,0xbf75bf22
.long 0x3dc9bef1,0x3f753f22,0xbf7fbf62,0xbe95bf46
.long 0xbec4bf6d,0x3f6d3ec4,0xbec4bf6d,0x3f6d3ec4
.long 0x3f6d3ec4,0x3ec43f6d,0x3f6d3ec4,0x3ec43f6d
.long 0x3f22be95,0x3ef13f7f,0x3f463f75,0xbf62bdc9
.long 0x3f463f75,0xbf62bdc9,0xbf223e95,0xbef1bf7f
.long 0x3f7b3f0e,0xbf553e48,0xbf7bbf0e,0x3f55be48
.long 0xbe483f55,0xbf0ebf7b,0x3e48bf55,0x3f0e3f7b
.long 0x3e953f7f,0xbf22bf62,0x3f75bdc9,0xbf463ef1
.long 0xbf753dc9,0x3f46bef1,0x3e953f7f,0xbf22bf62
.long 0xbf353f35,0x3f35bf35,0xbf353f35,0x3f35bf35
.long 0xbf35bf35,0x3f353f35,0xbf35bf35,0x3f353f35
.long 0xbf75bdc9,0x3f463ef1,0x3e95bf7f,0xbf223f62
.long 0x3e95bf7f,0xbf223f62,0x3f753dc9,0xbf46bef1
.long 0xbe48bf55,0xbf0e3f7b,0x3e483f55,0x3f0ebf7b
.long 0x3f7bbf0e,0xbf55be48,0xbf7b3f0e,0x3f553e48
.long 0x3f46bf75,0xbf623dc9,0xbf22be95,0xbef13f7f
.long 0x3f223e95,0x3ef1bf7f,0x3f46bf75,0xbf623dc9
.long 0x3f6dbec4,0x3ec4bf6d,0x3f6dbec4,0x3ec4bf6d
.long 0xbec43f6d,0x3f6dbec4,0xbec43f6d,0x3f6dbec4
.long 0x3dc93ef1,0x3f75bf22,0xbf7f3f62,0xbe953f46
.long 0xbf7f3f62,0xbe953f46,0xbdc9bef1,0xbf753f22
.long 0xbf553f7b,0xbe483f0e,0x3f55bf7b,0x3e48bf0e
.long 0xbf0e3e48,0xbf7b3f55,0x3f0ebe48,0x3f7bbf55
.long 0xbf623f46,0xbf7f3f75,0xbef13f22,0xbdc93e95
.long 0x3ef1bf22,0x3dc9be95,0xbf623f46,0xbf7f3f75
.long 0x3f803f80,0x3f803f80,0x3f803f80,0x3f803f80
.long 0x0,0x0,0x0,0x0
.long 0xbf75bf7f,0xbf46bf62,0x3e953dc9,0x3f223ef1
.long 0x3e953dc9,0x3f223ef1,0x3f753f7f,0x3f463f62
.long 0x3f553f7b,0x3e483f0e,0xbf55bf7b,0xbe48bf0e
.long 0xbf0ebe48,0xbf7bbf55,0x3f0e3e48,0x3f7b3f55
.long 0xbf22bf75,0x3ef1bdc9,0xbf46be95,0xbf62bf7f
.long 0x3f463e95,0x3f623f7f,0xbf22bf75,0x3ef1bdc9
.long 0x3ec43f6d,0xbf6dbec4,0x3ec43f6d,0xbf6dbec4
.long 0xbf6dbec4,0xbec4bf6d,0xbf6dbec4,0xbec4bf6d
.long 0xbdc9bf62,0x3f753f46,0x3f7f3ef1,0xbe953f22
.long 0x3f7f3ef1,0xbe953f22,0x3dc93f62,0xbf75bf46
.long 0xbe483f55,0xbf0ebf7b,0x3e48bf55,0x3f0e3f7b
.long 0xbf7bbf0e,0x3f55be48,0x3f7b3f0e,0xbf553e48
.long 0x3ef1bf46,0xbdc93f75,0xbf62bf22,0x3f7f3e95
.long 0x3f623f22,0xbf7fbe95,0x3ef1bf46,0xbdc93f75
.long 0xbf353f35,0x3f35bf35,0xbf353f35,0x3f35bf35
.long 0xbf35bf35,0x3f353f35,0xbf35bf35,0x3f353f35
.long 0x3f62bf22,0xbf7f3e95,0x3ef13f46,0xbdc9bf75
.long 0x3ef13f46,0xbdc9bf75,0xbf623f22,0x3f7fbe95
.long 0xbf7b3f0e,0x3f553e48,0x3f7bbf0e,0xbf55be48
.long 0xbe48bf55,0xbf0e3f7b,0x3e483f55,0x3f0ebf7b
.long 0x3f7fbef1,0xbe95bf22,0x3dc9bf62,0xbf753f46
.long 0xbdc93f62,0x3f75bf46,0x3f7fbef1,0xbe95bf22
.long 0xbf6d3ec4,0xbec43f6d,0xbf6d3ec4,0xbec43f6d
.long 0x3ec4bf6d,0xbf6d3ec4,0x3ec4bf6d,0xbf6d3ec4
.long 0x3f46be95,0x3f62bf7f,0xbf223f75,0x3ef13dc9
.long 0xbf223f75,0x3ef13dc9,0xbf463e95,0xbf623f7f
.long 0xbf0e3e48,0xbf7b3f55,0x3f0ebe48,0x3f7bbf55
.long 0x3f55bf7b,0x3e48bf0e,0xbf553f7b,0xbe483f0e
.long 0x3e95bdc9,0x3f22bef1,0x3f75bf7f,0x3f46bf62
.long 0xbf753f7f,0xbf463f62,0x3e95bdc9,0x3f22bef1
.long 0x3f803f80,0x3f803f80,0x3f803f80,0x3f803f80
.long 0x0,0x0,0x0,0x0
.long 0xbef1bf22,0xbdc9be95,0x3f623f46,0x3f7f3f75
.long 0x3f623f46,0x3f7f3f75,0x3ef13f22,0x3dc93e95
.long 0xbf0ebe48,0xbf7bbf55,0x3f0e3e48,0x3f7b3f55
.long 0xbf55bf7b,0xbe48bf0e,0x3f553f7b,0x3e483f0e
.long 0x3f7f3f62,0x3e953f46,0x3dc9bef1,0x3f753f22
.long 0xbdc93ef1,0xbf75bf22,0x3f7f3f62,0x3e953f46
.long 0xbec4bf6d,0x3f6d3ec4,0xbec4bf6d,0x3f6d3ec4
.long 0x3f6d3ec4,0x3ec43f6d,0x3f6d3ec4,0x3ec43f6d
.long 0xbf223e95,0xbef1bf7f,0xbf46bf75,0x3f623dc9
.long 0xbf46bf75,0x3f623dc9,0x3f22be95,0x3ef13f7f
.long 0x3f7b3f0e,0xbf553e48,0xbf7bbf0e,0x3f55be48
.long 0xbe483f55,0xbf0ebf7b,0x3e48bf55,0x3f0e3f7b
.long 0xbe95bf7f,0x3f223f62,0xbf753dc9,0x3f46bef1
.long 0x3f75bdc9,0xbf463ef1,0xbe95bf7f,0x3f223f62
.long 0xbf353f35,0x3f35bf35,0xbf353f35,0x3f35bf35
.long 0xbf35bf35,0x3f353f35,0xbf35bf35,0x3f353f35
.long 0x3f753dc9,0xbf46bef1,0xbe953f7f,0x3f22bf62
.long 0xbe953f7f,0x3f22bf62,0xbf75bdc9,0x3f463ef1
.long 0xbe48bf55,0xbf0e3f7b,0x3e483f55,0x3f0ebf7b
.long 0x3f7bbf0e,0xbf55be48,0xbf7b3f0e,0x3f553e48
.long 0xbf463f75,0x3f62bdc9,0x3f223e95,0x3ef1bf7f
.long 0xbf22be95,0xbef13f7f,0xbf463f75,0x3f62bdc9
.long 0x3f6dbec4,0x3ec4bf6d,0x3f6dbec4,0x3ec4bf6d
.long 0xbec43f6d,0x3f6dbec4,0xbec43f6d,0x3f6dbec4
.long 0xbdc9bef1,0xbf753f22,0x3f7fbf62,0x3e95bf46
.long 0x3f7fbf62,0x3e95bf46,0x3dc93ef1,0x3f75bf22
.long 0xbf553f7b,0xbe483f0e,0x3f55bf7b,0x3e48bf0e
.long 0xbf0e3e48,0xbf7b3f55,0x3f0ebe48,0x3f7bbf55
.long 0x3f62bf46,0x3f7fbf75,0x3ef1bf22,0x3dc9be95
.long 0xbef13f22,0xbdc93e95,0x3f62bf46,0x3f7fbf75
.long 0xbf803f80,0xbf803f80,0xbf803f80,0xbf803f80
.long 0x0,0x0,0x0,0x0
.long 0xbf7b3f80,0xbf553f6d,0x3e480000,0x3f0ebec4
.long 0x3e480000,0x3f0ebec4,0x3f7bbf80,0x3f55bf6d
.long 0xbf6d3f80,0xbec43f35,0x3f6dbf80,0x3ec4bf35
.long 0x3ec40000,0x3f6dbf35,0xbec40000,0xbf6d3f35
.long 0xbf553f80,0x3e483ec4,0xbf0e0000,0xbf7b3f6d
.long 0x3f0e0000,0x3f7bbf6d,0xbf553f80,0x3e483ec4
.long 0xbf353f80,0x3f350000,0xbf353f80,0x3f350000
.long 0x3f350000,0x3f35bf80,0x3f350000,0x3f35bf80
.long 0xbf0e3f80,0x3f7bbec4,0x3f550000,0x3e48bf6d
.long 0x3f550000,0x3e48bf6d,0x3f0ebf80,0xbf7b3ec4
.long 0xbec43f80,0x3f6dbf35,0x3ec4bf80,0xbf6d3f35
.long 0x3f6d0000,0xbec4bf35,0xbf6d0000,0x3ec43f35
.long 0xbe483f80,0x3f0ebf6d,0xbf7b0000,0x3f553ec4
.long 0x3f7b0000,0xbf55bec4,0xbe483f80,0x3f0ebf6d
.long 0x3f80,0xbf80,0x3f80,0xbf80
.long 0x3f800000,0xbf800000,0x3f800000,0xbf800000
.long 0x3e483f80,0xbf0ebf6d,0x3f7b0000,0xbf553ec4
.long 0x3f7b0000,0xbf553ec4,0xbe48bf80,0x3f0e3f6d
.long 0x3ec43f80,0xbf6dbf35,0xbec4bf80,0x3f6d3f35
.long 0x3f6d0000,0xbec43f35,0xbf6d0000,0x3ec4bf35
.long 0x3f0e3f80,0xbf7bbec4,0xbf550000,0xbe48bf6d
.long 0x3f550000,0x3e483f6d,0x3f0e3f80,0xbf7bbec4
.long 0x3f353f80,0xbf350000,0x3f353f80,0xbf350000
.long 0x3f350000,0x3f353f80,0x3f350000,0x3f353f80
.long 0x3f553f80,0xbe483ec4,0x3f0e0000,0x3f7b3f6d
.long 0x3f0e0000,0x3f7b3f6d,0xbf55bf80,0x3e48bec4
.long 0x3f6d3f80,0x3ec43f35,0xbf6dbf80,0xbec4bf35
.long 0x3ec40000,0x3f6d3f35,0xbec40000,0xbf6dbf35
.long 0x3f7b3f80,0x3f553f6d,0xbe480000,0xbf0ebec4
.long 0x3e480000,0x3f0e3ec4,0x3f7b3f80,0x3f553f6d
.long 0xbf803f80,0xbf803f80,0xbf803f80,0xbf803f80
.long 0x0,0x0,0x0,0x0
.long 0xbf0e3f35,0xbe483ec4,0x3f55bf35,0x3f7bbf6d
.long 0x3f55bf35,0x3f7bbf6d,0x3f0ebf35,0x3e48bec4
.long 0x3ec40000,0x3f6dbf35,0xbec40000,0xbf6d3f35
.long 0x3f6dbf80,0x3ec4bf35,0xbf6d3f80,0xbec43f35
.long 0x3f7bbf35,0x3f0ebf6d,0xbe483f35,0x3f55bec4
.long 0x3e48bf35,0xbf553ec4,0x3f7bbf35,0x3f0ebf6d
.long 0x3f35bf80,0xbf350000,0x3f35bf80,0xbf350000
.long 0xbf350000,0xbf353f80,0xbf350000,0xbf353f80
.long 0xbe48bf35,0xbf553f6d,0xbf7b3f35,0x3f0e3ec4
.long 0xbf7b3f35,0x3f0e3ec4,0x3e483f35,0x3f55bf6d
.long 0xbf6d0000,0x3ec43f35,0x3f6d0000,0xbec4bf35
.long 0xbec43f80,0x3f6dbf35,0x3ec4bf80,0xbf6d3f35
.long 0xbf553f35,0x3f7bbec4,0xbf0ebf35,0x3e483f6d
.long 0x3f0e3f35,0xbe48bf6d,0xbf553f35,0x3f7bbec4
.long 0x3f80,0xbf80,0x3f80,0xbf80
.long 0x3f800000,0xbf800000,0x3f800000,0xbf800000
.long 0x3f553f35,0xbf7bbec4,0x3f0ebf35,0xbe483f6d
.long 0x3f0ebf35,0xbe483f6d,0xbf55bf35,0x3f7b3ec4
.long 0x3f6d0000,0xbec43f35,0xbf6d0000,0x3ec4bf35
.long 0xbec4bf80,0x3f6d3f35,0x3ec43f80,0xbf6dbf35
.long 0x3e48bf35,0x3f553f6d,0x3f7b3f35,0xbf0e3ec4
.long 0xbf7bbf35,0x3f0ebec4,0x3e48bf35,0x3f553f6d
.long 0xbf35bf80,0x3f350000,0xbf35bf80,0x3f350000
.long 0xbf350000,0xbf35bf80,0xbf350000,0xbf35bf80
.long 0xbf7bbf35,0xbf0ebf6d,0x3e483f35,0xbf55bec4
.long 0x3e483f35,0xbf55bec4,0x3f7b3f35,0x3f0e3f6d
.long 0xbec40000,0xbf6dbf35,0x3ec40000,0x3f6d3f35
.long 0x3f6d3f80,0x3ec43f35,0xbf6dbf80,0xbec4bf35
.long 0x3f0e3f35,0x3e483ec4,0xbf55bf35,0xbf7bbf6d
.long 0x3f553f35,0x3f7b3f6d,0x3f0e3f35,0x3e483ec4
.long 0xbf803f80,0xbf803f80,0xbf803f80,0xbf803f80
.long 0x0,0x0,0x0,0x0
.long 0x3f7bbf80,0x3f55bf6d,0xbe480000,0xbf0e3ec4
.long 0xbe480000,0xbf0e3ec4,0xbf7b3f80,0xbf553f6d
.long 0xbf6d3f80,0xbec43f35,0x3f6dbf80,0x3ec4bf35
.long 0x3ec40000,0x3f6dbf35,0xbec40000,0xbf6d3f35
.long 0x3f55bf80,0xbe48bec4,0x3f0e0000,0x3f7bbf6d
.long 0xbf0e0000,0xbf7b3f6d,0x3f55bf80,0xbe48bec4
.long 0xbf353f80,0x3f350000,0xbf353f80,0x3f350000
.long 0x3f350000,0x3f35bf80,0x3f350000,0x3f35bf80
.long 0x3f0ebf80,0xbf7b3ec4,0xbf550000,0xbe483f6d
.long 0xbf550000,0xbe483f6d,0xbf0e3f80,0x3f7bbec4
.long 0xbec43f80,0x3f6dbf35,0x3ec4bf80,0xbf6d3f35
.long 0x3f6d0000,0xbec4bf35,0xbf6d0000,0x3ec43f35
.long 0x3e48bf80,0xbf0e3f6d,0x3f7b0000,0xbf55bec4
.long 0xbf7b0000,0x3f553ec4,0x3e48bf80,0xbf0e3f6d
.long 0x3f80,0xbf80,0x3f80,0xbf80
.long 0x3f800000,0xbf800000,0x3f800000,0xbf800000
.long 0xbe48bf80,0x3f0e3f6d,0xbf7b0000,0x3f55bec4
.long 0xbf7b0000,0x3f55bec4,0x3e483f80,0xbf0ebf6d
.long 0x3ec43f80,0xbf6dbf35,0xbec4bf80,0x3f6d3f35
.long 0x3f6d0000,0xbec43f35,0xbf6d0000,0x3ec4bf35
.long 0xbf0ebf80,0x3f7b3ec4,0x3f550000,0x3e483f6d
.long 0xbf550000,0xbe48bf6d,0xbf0ebf80,0x3f7b3ec4
.long 0x3f353f80,0xbf350000,0x3f353f80,0xbf350000
.long 0x3f350000,0x3f353f80,0x3f350000,0x3f353f80
.long 0xbf55bf80,0x3e48bec4,0xbf0e0000,0xbf7bbf6d
.long 0xbf0e0000,0xbf7bbf6d,0x3f553f80,0xbe483ec4
.long 0x3f6d3f80,0x3ec43f35,0xbf6dbf80,0xbec4bf35
.long 0x3ec40000,0x3f6d3f35,0xbec40000,0xbf6dbf35
.long 0xbf7bbf80,0xbf55bf6d,0x3e480000,0x3f0e3ec4
.long 0xbe480000,0xbf0ebec4,0xbf7bbf80,0xbf55bf6d
.long 0xbf803f80,0xbf803f80,0xbf803f80,0xbf803f80
.long 0x0,0x0,0x0,0x0
.long 0x3f0ebf35,0x3e48bec4,0xbf553f35,0xbf7b3f6d
.long 0xbf553f35,0xbf7b3f6d,0xbf0e3f35,0xbe483ec4
.long 0x3ec40000,0x3f6dbf35,0xbec40000,0xbf6d3f35
.long 0x3f6dbf80,0x3ec4bf35,0xbf6d3f80,0xbec43f35
.long 0xbf7b3f35,0xbf0e3f6d,0x3e48bf35,0xbf553ec4
.long 0xbe483f35,0x3f55bec4,0xbf7b3f35,0xbf0e3f6d
.long 0x3f35bf80,0xbf350000,0x3f35bf80,0xbf350000
.long 0xbf350000,0xbf353f80,0xbf350000,0xbf353f80
.long 0x3e483f35,0x3f55bf6d,0x3f7bbf35,0xbf0ebec4
.long 0x3f7bbf35,0xbf0ebec4,0xbe48bf35,0xbf553f6d
.long 0xbf6d0000,0x3ec43f35,0x3f6d0000,0xbec4bf35
.long 0xbec43f80,0x3f6dbf35,0x3ec4bf80,0xbf6d3f35
.long 0x3f55bf35,0xbf7b3ec4,0x3f0e3f35,0xbe48bf6d
.long 0xbf0ebf35,0x3e483f6d,0x3f55bf35,0xbf7b3ec4
.long 0x3f80,0xbf80,0x3f80,0xbf80
.long 0x3f800000,0xbf800000,0x3f800000,0xbf800000
.long 0xbf55bf35,0x3f7b3ec4,0xbf0e3f35,0x3e48bf6d
.long 0xbf0e3f35,0x3e48bf6d,0x3f553f35,0xbf7bbec4
.long 0x3f6d0000,0xbec43f35,0xbf6d0000,0x3ec4bf35
.long 0xbec4bf80,0x3f6d3f35,0x3ec43f80,0xbf6dbf35
.long 0xbe483f35,0xbf55bf6d,0xbf7bbf35,0x3f0ebec4
.long 0x3f7b3f35,0xbf0e3ec4,0xbe483f35,0xbf55bf6d
.long 0xbf35bf80,0x3f350000,0xbf35bf80,0x3f350000
.long 0xbf350000,0xbf35bf80,0xbf350000,0xbf35bf80
.long 0x3f7b3f35,0x3f0e3f6d,0xbe48bf35,0x3f553ec4
.long 0xbe48bf35,0x3f553ec4,0xbf7bbf35,0xbf0ebf6d
.long 0xbec40000,0xbf6dbf35,0x3ec40000,0x3f6d3f35
.long 0x3f6d3f80,0x3ec43f35,0xbf6dbf80,0xbec4bf35
.long 0xbf0ebf35,0xbe48bec4,0x3f553f35,0x3f7b3f6d
.long 0xbf55bf35,0xbf7bbf6d,0xbf0ebf35,0xbe48bec4
.long 0x0,0x0,0x0,0x0
.long 0x3f80bf80,0x3f80bf80,0x3f80bf80,0x3f80bf80
.long 0x3e95bdc9,0x3f22bef1,0x3f75bf7f,0x3f46bf62
.long 0x3f75bf7f,0x3f46bf62,0xbe953dc9,0xbf223ef1
.long 0x3f0ebe48,0x3f7bbf55,0xbf0e3e48,0xbf7b3f55
.long 0x3f55bf7b,0x3e48bf0e,0xbf553f7b,0xbe483f0e
.long 0x3f46be95,0x3f62bf7f,0xbf223f75,0x3ef13dc9
.long 0x3f22bf75,0xbef1bdc9,0x3f46be95,0x3f62bf7f
.long 0x3f6dbec4,0x3ec4bf6d,0x3f6dbec4,0x3ec4bf6d
.long 0x3ec4bf6d,0xbf6d3ec4,0x3ec4bf6d,0xbf6d3ec4
.long 0x3f7fbef1,0xbe95bf22,0x3dc9bf62,0xbf753f46
.long 0x3dc9bf62,0xbf753f46,0xbf7f3ef1,0x3e953f22
.long 0x3f7bbf0e,0xbf55be48,0xbf7b3f0e,0x3f553e48
.long 0xbe48bf55,0xbf0e3f7b,0x3e483f55,0x3f0ebf7b
.long 0x3f62bf22,0xbf7f3e95,0x3ef13f46,0xbdc9bf75
.long 0xbef1bf46,0x3dc93f75,0x3f62bf22,0xbf7f3e95
.long 0x3f35bf35,0xbf353f35,0x3f35bf35,0xbf353f35
.long 0xbf35bf35,0x3f353f35,0xbf35bf35,0x3f353f35
.long 0x3ef1bf46,0xbdc93f75,0xbf62bf22,0x3f7f3e95
.long 0xbf62bf22,0x3f7f3e95,0xbef13f46,0x3dc9bf75
.long 0x3e48bf55,0x3f0e3f7b,0xbe483f55,0xbf0ebf7b
.long 0xbf7bbf0e,0x3f55be48,0x3f7b3f0e,0xbf553e48
.long 0xbdc9bf62,0x3f753f46,0x3f7f3ef1,0xbe953f22
.long 0xbf7fbef1,0x3e95bf22,0xbdc9bf62,0x3f753f46
.long 0xbec4bf6d,0x3f6d3ec4,0xbec4bf6d,0x3f6d3ec4
.long 0xbf6dbec4,0xbec4bf6d,0xbf6dbec4,0xbec4bf6d
.long 0xbf22bf75,0x3ef1bdc9,0xbf46be95,0xbf62bf7f
.long 0xbf46be95,0xbf62bf7f,0x3f223f75,0xbef13dc9
.long 0xbf55bf7b,0xbe48bf0e,0x3f553f7b,0x3e483f0e
.long 0xbf0ebe48,0xbf7bbf55,0x3f0e3e48,0x3f7b3f55
.long 0xbf75bf7f,0xbf46bf62,0x3e953dc9,0x3f223ef1
.long 0xbe95bdc9,0xbf22bef1,0xbf75bf7f,0xbf46bf62
.long 0x0,0x0,0x0,0x0
.long 0x3f80bf80,0x3f80bf80,0x3f80bf80,0x3f80bf80
.long 0x3f62bf46,0x3f7fbf75,0x3ef1bf22,0x3dc9be95
.long 0x3ef1bf22,0x3dc9be95,0xbf623f46,0xbf7f3f75
.long 0x3f55bf7b,0x3e48bf0e,0xbf553f7b,0xbe483f0e
.long 0xbf0e3e48,0xbf7b3f55,0x3f0ebe48,0x3f7bbf55
.long 0xbdc9bef1,0xbf753f22,0x3f7fbf62,0x3e95bf46
.long 0xbf7f3f62,0xbe953f46,0xbdc9bef1,0xbf753f22
.long 0xbf6d3ec4,0xbec43f6d,0xbf6d3ec4,0xbec43f6d
.long 0xbec43f6d,0x3f6dbec4,0xbec43f6d,0x3f6dbec4
.long 0xbf463f75,0x3f62bdc9,0x3f223e95,0x3ef1bf7f
.long 0x3f223e95,0x3ef1bf7f,0x3f46bf75,0xbf623dc9
.long 0x3e483f55,0x3f0ebf7b,0xbe48bf55,0xbf0e3f7b
.long 0x3f7bbf0e,0xbf55be48,0xbf7b3f0e,0x3f553e48
.long 0x3f753dc9,0xbf46bef1,0xbe953f7f,0x3f22bf62
.long 0x3e95bf7f,0xbf223f62,0x3f753dc9,0xbf46bef1
.long 0x3f35bf35,0xbf353f35,0x3f35bf35,0xbf353f35
.long 0xbf35bf35,0x3f353f35,0xbf35bf35,0x3f353f35
.long 0xbe95bf7f,0x3f223f62,0xbf753dc9,0x3f46bef1
.long 0xbf753dc9,0x3f46bef1,0x3e953f7f,0xbf22bf62
.long 0xbf7bbf0e,0x3f55be48,0x3f7b3f0e,0xbf553e48
.long 0xbe483f55,0xbf0ebf7b,0x3e48bf55,0x3f0e3f7b
.long 0xbf223e95,0xbef1bf7f,0xbf46bf75,0x3f623dc9
.long 0x3f463f75,0xbf62bdc9,0xbf223e95,0xbef1bf7f
.long 0x3ec43f6d,0xbf6dbec4,0x3ec43f6d,0xbf6dbec4
.long 0x3f6d3ec4,0x3ec43f6d,0x3f6d3ec4,0x3ec43f6d
.long 0x3f7f3f62,0x3e953f46,0x3dc9bef1,0x3f753f22
.long 0x3dc9bef1,0x3f753f22,0xbf7fbf62,0xbe95bf46
.long 0x3f0e3e48,0x3f7b3f55,0xbf0ebe48,0xbf7bbf55
.long 0xbf55bf7b,0xbe48bf0e,0x3f553f7b,0x3e483f0e
.long 0xbef1bf22,0xbdc9be95,0x3f623f46,0x3f7f3f75
.long 0xbf62bf46,0xbf7fbf75,0xbef1bf22,0xbdc9be95
.long 0x0,0x0,0x0,0x0
.long 0x3f80bf80,0x3f80bf80,0x3f80bf80,0x3f80bf80
.long 0xbe953dc9,0xbf223ef1,0xbf753f7f,0xbf463f62
.long 0xbf753f7f,0xbf463f62,0x3e95bdc9,0x3f22bef1
.long 0x3f0ebe48,0x3f7bbf55,0xbf0e3e48,0xbf7b3f55
.long 0x3f55bf7b,0x3e48bf0e,0xbf553f7b,0xbe483f0e
.long 0xbf463e95,0xbf623f7f,0x3f22bf75,0xbef1bdc9
.long 0xbf223f75,0x3ef13dc9,0xbf463e95,0xbf623f7f
.long 0x3f6dbec4,0x3ec4bf6d,0x3f6dbec4,0x3ec4bf6d
.long 0x3ec4bf6d,0xbf6d3ec4,0x3ec4bf6d,0xbf6d3ec4
.long 0xbf7f3ef1,0x3e953f22,0xbdc93f62,0x3f75bf46
.long 0xbdc93f62,0x3f75bf46,0x3f7fbef1,0xbe95bf22
.long 0x3f7bbf0e,0xbf55be48,0xbf7b3f0e,0x3f553e48
.long 0xbe48bf55,0xbf0e3f7b,0x3e483f55,0x3f0ebf7b
.long 0xbf623f22,0x3f7fbe95,0xbef1bf46,0x3dc93f75
.long 0x3ef13f46,0xbdc9bf75,0xbf623f22,0x3f7fbe95
.long 0x3f35bf35,0xbf353f35,0x3f35bf35,0xbf353f35
.long 0xbf35bf35,0x3f353f35,0xbf35bf35,0x3f353f35
.long 0xbef13f46,0x3dc9bf75,0x3f623f22,0xbf7fbe95
.long 0x3f623f22,0xbf7fbe95,0x3ef1bf46,0xbdc93f75
.long 0x3e48bf55,0x3f0e3f7b,0xbe483f55,0xbf0ebf7b
.long 0xbf7bbf0e,0x3f55be48,0x3f7b3f0e,0xbf553e48
.long 0x3dc93f62,0xbf75bf46,0xbf7fbef1,0x3e95bf22
.long 0x3f7f3ef1,0xbe953f22,0x3dc93f62,0xbf75bf46
.long 0xbec4bf6d,0x3f6d3ec4,0xbec4bf6d,0x3f6d3ec4
.long 0xbf6dbec4,0xbec4bf6d,0xbf6dbec4,0xbec4bf6d
.long 0x3f223f75,0xbef13dc9,0x3f463e95,0x3f623f7f
.long 0x3f463e95,0x3f623f7f,0xbf22bf75,0x3ef1bdc9
.long 0xbf55bf7b,0xbe48bf0e,0x3f553f7b,0x3e483f0e
.long 0xbf0ebe48,0xbf7bbf55,0x3f0e3e48,0x3f7b3f55
.long 0x3f753f7f,0x3f463f62,0xbe95bdc9,0xbf22bef1
.long 0x3e953dc9,0x3f223ef1,0x3f753f7f,0x3f463f62
.long 0x0,0x0,0x0,0x0
.long 0x3f80bf80,0x3f80bf80,0x3f80bf80,0x3f80bf80
.long 0xbf623f46,0xbf7f3f75,0xbef13f22,0xbdc93e95
.long 0xbef13f22,0xbdc93e95,0x3f62bf46,0x3f7fbf75
.long 0x3f55bf7b,0x3e48bf0e,0xbf553f7b,0xbe483f0e
.long 0xbf0e3e48,0xbf7b3f55,0x3f0ebe48,0x3f7bbf55
.long 0x3dc93ef1,0x3f75bf22,0xbf7f3f62,0xbe953f46
.long 0x3f7fbf62,0x3e95bf46,0x3dc93ef1,0x3f75bf22
.long 0xbf6d3ec4,0xbec43f6d,0xbf6d3ec4,0xbec43f6d
.long 0xbec43f6d,0x3f6dbec4,0xbec43f6d,0x3f6dbec4
.long 0x3f46bf75,0xbf623dc9,0xbf22be95,0xbef13f7f
.long 0xbf22be95,0xbef13f7f,0xbf463f75,0x3f62bdc9
.long 0x3e483f55,0x3f0ebf7b,0xbe48bf55,0xbf0e3f7b
.long 0x3f7bbf0e,0xbf55be48,0xbf7b3f0e,0x3f553e48
.long 0xbf75bdc9,0x3f463ef1,0x3e95bf7f,0xbf223f62
.long 0xbe953f7f,0x3f22bf62,0xbf75bdc9,0x3f463ef1
.long 0x3f35bf35,0xbf353f35,0x3f35bf35,0xbf353f35
.long 0xbf35bf35,0x3f353f35,0xbf35bf35,0x3f353f35
.long 0x3e953f7f,0xbf22bf62,0x3f75bdc9,0xbf463ef1
.long 0x3f75bdc9,0xbf463ef1,0xbe95bf7f,0x3f223f62
.long 0xbf7bbf0e,0x3f55be48,0x3f7b3f0e,0xbf553e48
.long 0xbe483f55,0xbf0ebf7b,0x3e48bf55,0x3f0e3f7b
.long 0x3f22be95,0x3ef13f7f,0x3f463f75,0xbf62bdc9
.long 0xbf46bf75,0x3f623dc9,0x3f22be95,0x3ef13f7f
.long 0x3ec43f6d,0xbf6dbec4,0x3ec43f6d,0xbf6dbec4
.long 0x3f6d3ec4,0x3ec43f6d,0x3f6d3ec4,0x3ec43f6d
.long 0xbf7fbf62,0xbe95bf46,0xbdc93ef1,0xbf75bf22
.long 0xbdc93ef1,0xbf75bf22,0x3f7f3f62,0x3e953f46
.long 0x3f0e3e48,0x3f7b3f55,0xbf0ebe48,0xbf7bbf55
.long 0xbf55bf7b,0xbe48bf0e,0x3f553f7b,0x3e483f0e
.long 0x3ef13f22,0x3dc93e95,0xbf62bf46,0xbf7fbf75
.long 0x3f623f46,0x3f7f3f75,0x3ef13f22,0x3dc93e95
.long 0x3f803f80,0x3f803f80,0x3f803f80,0x3f803f80
.long 0x0,0x0,0x0,0x0
.long 0x3f7b3f80,0x3f553f6d,0xbe480000,0xbf0ebec4
.long 0xbe480000,0xbf0ebec4,0xbf7bbf80,0xbf55bf6d
.long 0x3f6d3f80,0x3ec43f35,0xbf6dbf80,0xbec4bf35
.long 0xbec40000,0xbf6dbf35,0x3ec40000,0x3f6d3f35
.long 0x3f553f80,0xbe483ec4,0x3f0e0000,0x3f7b3f6d
.long 0xbf0e0000,0xbf7bbf6d,0x3f553f80,0xbe483ec4
.long 0x3f353f80,0xbf350000,0x3f353f80,0xbf350000
.long 0xbf350000,0xbf35bf80,0xbf350000,0xbf35bf80
.long 0x3f0e3f80,0xbf7bbec4,0xbf550000,0xbe48bf6d
.long 0xbf550000,0xbe48bf6d,0xbf0ebf80,0x3f7b3ec4
.long 0x3ec43f80,0xbf6dbf35,0xbec4bf80,0x3f6d3f35
.long 0xbf6d0000,0x3ec4bf35,0x3f6d0000,0xbec43f35
.long 0x3e483f80,0xbf0ebf6d,0x3f7b0000,0xbf553ec4
.long 0xbf7b0000,0x3f55bec4,0x3e483f80,0xbf0ebf6d
.long 0x3f80,0xbf80,0x3f80,0xbf80
.long 0xbf800000,0x3f800000,0xbf800000,0x3f800000
.long 0xbe483f80,0x3f0ebf6d,0xbf7b0000,0x3f553ec4
.long 0xbf7b0000,0x3f553ec4,0x3e48bf80,0xbf0e3f6d
.long 0xbec43f80,0x3f6dbf35,0x3ec4bf80,0xbf6d3f35
.long 0xbf6d0000,0x3ec43f35,0x3f6d0000,0xbec4bf35
.long 0xbf0e3f80,0x3f7bbec4,0x3f550000,0x3e48bf6d
.long 0xbf550000,0xbe483f6d,0xbf0e3f80,0x3f7bbec4
.long 0xbf353f80,0x3f350000,0xbf353f80,0x3f350000
.long 0xbf350000,0xbf353f80,0xbf350000,0xbf353f80
.long 0xbf553f80,0x3e483ec4,0xbf0e0000,0xbf7b3f6d
.long 0xbf0e0000,0xbf7b3f6d,0x3f55bf80,0xbe48bec4
.long 0xbf6d3f80,0xbec43f35,0x3f6dbf80,0x3ec4bf35
.long 0xbec40000,0xbf6d3f35,0x3ec40000,0x3f6dbf35
.long 0xbf7b3f80,0xbf553f6d,0x3e480000,0x3f0ebec4
.long 0xbe480000,0xbf0e3ec4,0xbf7b3f80,0xbf553f6d
.long 0x3f803f80,0x3f803f80,0x3f803f80,0x3f803f80
.long 0x0,0x0,0x0,0x0
.long 0x3f0e3f35,0x3e483ec4,0xbf55bf35,0xbf7bbf6d
.long 0xbf55bf35,0xbf7bbf6d,0xbf0ebf35,0xbe48bec4
.long 0xbec40000,0xbf6dbf35,0x3ec40000,0x3f6d3f35
.long 0xbf6dbf80,0xbec4bf35,0x3f6d3f80,0x3ec43f35
.long 0xbf7bbf35,0xbf0ebf6d,0x3e483f35,0xbf55bec4
.long 0xbe48bf35,0x3f553ec4,0xbf7bbf35,0xbf0ebf6d
.long 0xbf35bf80,0x3f350000,0xbf35bf80,0x3f350000
.long 0x3f350000,0x3f353f80,0x3f350000,0x3f353f80
.long 0x3e48bf35,0x3f553f6d,0x3f7b3f35,0xbf0e3ec4
.long 0x3f7b3f35,0xbf0e3ec4,0xbe483f35,0xbf55bf6d
.long 0x3f6d0000,0xbec43f35,0xbf6d0000,0x3ec4bf35
.long 0x3ec43f80,0xbf6dbf35,0xbec4bf80,0x3f6d3f35
.long 0x3f553f35,0xbf7bbec4,0x3f0ebf35,0xbe483f6d
.long 0xbf0e3f35,0x3e48bf6d,0x3f553f35,0xbf7bbec4
.long 0x3f80,0xbf80,0x3f80,0xbf80
.long 0xbf800000,0x3f800000,0xbf800000,0x3f800000
.long 0xbf553f35,0x3f7bbec4,0xbf0ebf35,0x3e483f6d
.long 0xbf0ebf35,0x3e483f6d,0x3f55bf35,0xbf7b3ec4
.long 0xbf6d0000,0x3ec43f35,0x3f6d0000,0xbec4bf35
.long 0x3ec4bf80,0xbf6d3f35,0xbec43f80,0x3f6dbf35
.long 0xbe48bf35,0xbf553f6d,0xbf7b3f35,0x3f0e3ec4
.long 0x3f7bbf35,0xbf0ebec4,0xbe48bf35,0xbf553f6d
.long 0x3f35bf80,0xbf350000,0x3f35bf80,0xbf350000
.long 0x3f350000,0x3f35bf80,0x3f350000,0x3f35bf80
.long 0x3f7bbf35,0x3f0ebf6d,0xbe483f35,0x3f55bec4
.long 0xbe483f35,0x3f55bec4,0xbf7b3f35,0xbf0e3f6d
.long 0x3ec40000,0x3f6dbf35,0xbec40000,0xbf6d3f35
.long 0xbf6d3f80,0xbec43f35,0x3f6dbf80,0x3ec4bf35
.long 0xbf0e3f35,0xbe483ec4,0x3f55bf35,0x3f7bbf6d
.long 0xbf553f35,0xbf7b3f6d,0xbf0e3f35,0xbe483ec4
.long 0x3f803f80,0x3f803f80,0x3f803f80,0x3f803f80
.long 0x0,0x0,0x0,0x0
.long 0xbf7bbf80,0xbf55bf6d,0x3e480000,0x3f0e3ec4
.long 0x3e480000,0x3f0e3ec4,0x3f7b3f80,0x3f553f6d
.long 0x3f6d3f80,0x3ec43f35,0xbf6dbf80,0xbec4bf35
.long 0xbec40000,0xbf6dbf35,0x3ec40000,0x3f6d3f35
.long 0xbf55bf80,0x3e48bec4,0xbf0e0000,0xbf7bbf6d
.long 0x3f0e0000,0x3f7b3f6d,0xbf55bf80,0x3e48bec4
.long 0x3f353f80,0xbf350000,0x3f353f80,0xbf350000
.long 0xbf350000,0xbf35bf80,0xbf350000,0xbf35bf80
.long 0xbf0ebf80,0x3f7b3ec4,0x3f550000,0x3e483f6d
.long 0x3f550000,0x3e483f6d,0x3f0e3f80,0xbf7bbec4
.long 0x3ec43f80,0xbf6dbf35,0xbec4bf80,0x3f6d3f35
.long 0xbf6d0000,0x3ec4bf35,0x3f6d0000,0xbec43f35
.long 0xbe48bf80,0x3f0e3f6d,0xbf7b0000,0x3f55bec4
.long 0x3f7b0000,0xbf553ec4,0xbe48bf80,0x3f0e3f6d
.long 0x3f80,0xbf80,0x3f80,0xbf80
.long 0xbf800000,0x3f800000,0xbf800000,0x3f800000
.long 0x3e48bf80,0xbf0e3f6d,0x3f7b0000,0xbf55bec4
.long 0x3f7b0000,0xbf55bec4,0xbe483f80,0x3f0ebf6d
.long 0xbec43f80,0x3f6dbf35,0x3ec4bf80,0xbf6d3f35
.long 0xbf6d0000,0x3ec43f35,0x3f6d0000,0xbec4bf35
.long 0x3f0ebf80,0xbf7b3ec4,0xbf550000,0xbe483f6d
.long 0x3f550000,0x3e48bf6d,0x3f0ebf80,0xbf7b3ec4
.long 0xbf353f80,0x3f350000,0xbf353f80,0x3f350000
.long 0xbf350000,0xbf353f80,0xbf350000,0xbf353f80
.long 0x3f55bf80,0xbe48bec4,0x3f0e0000,0x3f7bbf6d
.long 0x3f0e0000,0x3f7bbf6d,0xbf553f80,0x3e483ec4
.long 0xbf6d3f80,0xbec43f35,0x3f6dbf80,0x3ec4bf35
.long 0xbec40000,0xbf6d3f35,0x3ec40000,0x3f6dbf35
.long 0x3f7bbf80,0x3f55bf6d,0xbe480000,0xbf0e3ec4
.long 0x3e480000,0x3f0ebec4,0x3f7bbf80,0x3f55bf6d
.long 0x3f803f80,0x3f803f80,0x3f803f80,0x3f803f80
.long 0x0,0x0,0x0,0x0
.long 0xbf0ebf35,0xbe48bec4,0x3f553f35,0x3f7b3f6d
.long 0x3f553f35,0x3f7b3f6d,0x3f0e3f35,0x3e483ec4
.long 0xbec40000,0xbf6dbf35,0x3ec40000,0x3f6d3f35
.long 0xbf6dbf80,0xbec4bf35,0x3f6d3f80,0x3ec43f35
.long 0x3f7b3f35,0x3f0e3f6d,0xbe48bf35,0x3f553ec4
.long 0x3e483f35,0xbf55bec4,0x3f7b3f35,0x3f0e3f6d
.long 0xbf35bf80,0x3f350000,0xbf35bf80,0x3f350000
.long 0x3f350000,0x3f353f80,0x3f350000,0x3f353f80
.long 0xbe483f35,0xbf55bf6d,0xbf7bbf35,0x3f0ebec4
.long 0xbf7bbf35,0x3f0ebec4,0x3e48bf35,0x3f553f6d
.long 0x3f6d0000,0xbec43f35,0xbf6d0000,0x3ec4bf35
.long 0x3ec43f80,0xbf6dbf35,0xbec4bf80,0x3f6d3f35
.long 0xbf55bf35,0x3f7b3ec4,0xbf0e3f35,0x3e48bf6d
.long 0x3f0ebf35,0xbe483f6d,0xbf55bf35,0x3f7b3ec4
.long 0x3f80,0xbf80,0x3f80,0xbf80
.long 0xbf800000,0x3f800000,0xbf800000,0x3f800000
.long 0x3f55bf35,0xbf7b3ec4,0x3f0e3f35,0xbe48bf6d
.long 0x3f0e3f35,0xbe48bf6d,0xbf553f35,0x3f7bbec4
.long 0xbf6d0000,0x3ec43f35,0x3f6d0000,0xbec4bf35
.long 0x3ec4bf80,0xbf6d3f35,0xbec43f80,0x3f6dbf35
.long 0x3e483f35,0x3f55bf6d,0x3f7bbf35,0xbf0ebec4
.long 0xbf7b3f35,0x3f0e3ec4,0x3e483f35,0x3f55bf6d
.long 0x3f35bf80,0xbf350000,0x3f35bf80,0xbf350000
.long 0x3f350000,0x3f35bf80,0x3f350000,0x3f35bf80
.long 0xbf7b3f35,0xbf0e3f6d,0x3e48bf35,0xbf553ec4
.long 0x3e48bf35,0xbf553ec4,0x3f7bbf35,0x3f0ebf6d
.long 0x3ec40000,0x3f6dbf35,0xbec40000,0xbf6d3f35
.long 0xbf6d3f80,0xbec43f35,0x3f6dbf80,0x3ec4bf35
.long 0x3f0ebf35,0x3e48bec4,0xbf553f35,0xbf7b3f6d
.long 0x3f55bf35,0x3f7bbf6d,0x3f0ebf35,0x3e48bec4
.long 0xbf80bf80,0xbf80bf80,0xbf80bf80,0xbf80bf80
.long 0x0,0x0,0x0,0x0
.long 0xbf75bf7f,0xbf46bf62,0x3e953dc9,0x3f223ef1
.long 0x3e953dc9,0x3f223ef1,0x3f753f7f,0x3f463f62
.long 0xbf55bf7b,0xbe48bf0e,0x3f553f7b,0x3e483f0e
.long 0x3f0e3e48,0x3f7b3f55,0xbf0ebe48,0xbf7bbf55
.long 0xbf22bf75,0x3ef1bdc9,0xbf46be95,0xbf62bf7f
.long 0x3f463e95,0x3f623f7f,0xbf22bf75,0x3ef1bdc9
.long 0xbec4bf6d,0x3f6d3ec4,0xbec4bf6d,0x3f6d3ec4
.long 0x3f6d3ec4,0x3ec43f6d,0x3f6d3ec4,0x3ec43f6d
.long 0xbdc9bf62,0x3f753f46,0x3f7f3ef1,0xbe953f22
.long 0x3f7f3ef1,0xbe953f22,0x3dc93f62,0xbf75bf46
.long 0x3e48bf55,0x3f0e3f7b,0xbe483f55,0xbf0ebf7b
.long 0x3f7b3f0e,0xbf553e48,0xbf7bbf0e,0x3f55be48
.long 0x3ef1bf46,0xbdc93f75,0xbf62bf22,0x3f7f3e95
.long 0x3f623f22,0xbf7fbe95,0x3ef1bf46,0xbdc93f75
.long 0x3f35bf35,0xbf353f35,0x3f35bf35,0xbf353f35
.long 0x3f353f35,0xbf35bf35,0x3f353f35,0xbf35bf35
.long 0x3f62bf22,0xbf7f3e95,0x3ef13f46,0xbdc9bf75
.long 0x3ef13f46,0xbdc9bf75,0xbf623f22,0x3f7fbe95
.long 0x3f7bbf0e,0xbf55be48,0xbf7b3f0e,0x3f553e48
.long 0x3e483f55,0x3f0ebf7b,0xbe48bf55,0xbf0e3f7b
.long 0x3f7fbef1,0xbe95bf22,0x3dc9bf62,0xbf753f46
.long 0xbdc93f62,0x3f75bf46,0x3f7fbef1,0xbe95bf22
.long 0x3f6dbec4,0x3ec4bf6d,0x3f6dbec4,0x3ec4bf6d
.long 0xbec43f6d,0x3f6dbec4,0xbec43f6d,0x3f6dbec4
.long 0x3f46be95,0x3f62bf7f,0xbf223f75,0x3ef13dc9
.long 0xbf223f75,0x3ef13dc9,0xbf463e95,0xbf623f7f
.long 0x3f0ebe48,0x3f7bbf55,0xbf0e3e48,0xbf7b3f55
.long 0xbf553f7b,0xbe483f0e,0x3f55bf7b,0x3e48bf0e
.long 0x3e95bdc9,0x3f22bef1,0x3f75bf7f,0x3f46bf62
.long 0xbf753f7f,0xbf463f62,0x3e95bdc9,0x3f22bef1
.long 0xbf80bf80,0xbf80bf80,0xbf80bf80,0xbf80bf80
.long 0x0,0x0,0x0,0x0
.long 0xbef1bf22,0xbdc9be95,0x3f623f46,0x3f7f3f75
.long 0x3f623f46,0x3f7f3f75,0x3ef13f22,0x3dc93e95
.long 0x3f0e3e48,0x3f7b3f55,0xbf0ebe48,0xbf7bbf55
.long 0x3f553f7b,0x3e483f0e,0xbf55bf7b,0xbe48bf0e
.long 0x3f7f3f62,0x3e953f46,0x3dc9bef1,0x3f753f22
.long 0xbdc93ef1,0xbf75bf22,0x3f7f3f62,0x3e953f46
.long 0x3ec43f6d,0xbf6dbec4,0x3ec43f6d,0xbf6dbec4
.long 0xbf6dbec4,0xbec4bf6d,0xbf6dbec4,0xbec4bf6d
.long 0xbf223e95,0xbef1bf7f,0xbf46bf75,0x3f623dc9
.long 0xbf46bf75,0x3f623dc9,0x3f22be95,0x3ef13f7f
.long 0xbf7bbf0e,0x3f55be48,0x3f7b3f0e,0xbf553e48
.long 0x3e48bf55,0x3f0e3f7b,0xbe483f55,0xbf0ebf7b
.long 0xbe95bf7f,0x3f223f62,0xbf753dc9,0x3f46bef1
.long 0x3f75bdc9,0xbf463ef1,0xbe95bf7f,0x3f223f62
.long 0x3f35bf35,0xbf353f35,0x3f35bf35,0xbf353f35
.long 0x3f353f35,0xbf35bf35,0x3f353f35,0xbf35bf35
.long 0x3f753dc9,0xbf46bef1,0xbe953f7f,0x3f22bf62
.long 0xbe953f7f,0x3f22bf62,0xbf75bdc9,0x3f463ef1
.long 0x3e483f55,0x3f0ebf7b,0xbe48bf55,0xbf0e3f7b
.long 0xbf7b3f0e,0x3f553e48,0x3f7bbf0e,0xbf55be48
.long 0xbf463f75,0x3f62bdc9,0x3f223e95,0x3ef1bf7f
.long 0xbf22be95,0xbef13f7f,0xbf463f75,0x3f62bdc9
.long 0xbf6d3ec4,0xbec43f6d,0xbf6d3ec4,0xbec43f6d
.long 0x3ec4bf6d,0xbf6d3ec4,0x3ec4bf6d,0xbf6d3ec4
.long 0xbdc9bef1,0xbf753f22,0x3f7fbf62,0x3e95bf46
.long 0x3f7fbf62,0x3e95bf46,0x3dc93ef1,0x3f75bf22
.long 0x3f55bf7b,0x3e48bf0e,0xbf553f7b,0xbe483f0e
.long 0x3f0ebe48,0x3f7bbf55,0xbf0e3e48,0xbf7b3f55
.long 0x3f62bf46,0x3f7fbf75,0x3ef1bf22,0x3dc9be95
.long 0xbef13f22,0xbdc93e95,0x3f62bf46,0x3f7fbf75
.long 0xbf80bf80,0xbf80bf80,0xbf80bf80,0xbf80bf80
.long 0x0,0x0,0x0,0x0
.long 0x3f753f7f,0x3f463f62,0xbe95bdc9,0xbf22bef1
.long 0xbe95bdc9,0xbf22bef1,0xbf75bf7f,0xbf46bf62
.long 0xbf55bf7b,0xbe48bf0e,0x3f553f7b,0x3e483f0e
.long 0x3f0e3e48,0x3f7b3f55,0xbf0ebe48,0xbf7bbf55
.long 0x3f223f75,0xbef13dc9,0x3f463e95,0x3f623f7f
.long 0xbf46be95,0xbf62bf7f,0x3f223f75,0xbef13dc9
.long 0xbec4bf6d,0x3f6d3ec4,0xbec4bf6d,0x3f6d3ec4
.long 0x3f6d3ec4,0x3ec43f6d,0x3f6d3ec4,0x3ec43f6d
.long 0x3dc93f62,0xbf75bf46,0xbf7fbef1,0x3e95bf22
.long 0xbf7fbef1,0x3e95bf22,0xbdc9bf62,0x3f753f46
.long 0x3e48bf55,0x3f0e3f7b,0xbe483f55,0xbf0ebf7b
.long 0x3f7b3f0e,0xbf553e48,0xbf7bbf0e,0x3f55be48
.long 0xbef13f46,0x3dc9bf75,0x3f623f22,0xbf7fbe95
.long 0xbf62bf22,0x3f7f3e95,0xbef13f46,0x3dc9bf75
.long 0x3f35bf35,0xbf353f35,0x3f35bf35,0xbf353f35
.long 0x3f353f35,0xbf35bf35,0x3f353f35,0xbf35bf35
.long 0xbf623f22,0x3f7fbe95,0xbef1bf46,0x3dc93f75
.long 0xbef1bf46,0x3dc93f75,0x3f62bf22,0xbf7f3e95
.long 0x3f7bbf0e,0xbf55be48,0xbf7b3f0e,0x3f553e48
.long 0x3e483f55,0x3f0ebf7b,0xbe48bf55,0xbf0e3f7b
.long 0xbf7f3ef1,0x3e953f22,0xbdc93f62,0x3f75bf46
.long 0x3dc9bf62,0xbf753f46,0xbf7f3ef1,0x3e953f22
.long 0x3f6dbec4,0x3ec4bf6d,0x3f6dbec4,0x3ec4bf6d
.long 0xbec43f6d,0x3f6dbec4,0xbec43f6d,0x3f6dbec4
.long 0xbf463e95,0xbf623f7f,0x3f22bf75,0xbef1bdc9
.long 0x3f22bf75,0xbef1bdc9,0x3f46be95,0x3f62bf7f
.long 0x3f0ebe48,0x3f7bbf55,0xbf0e3e48,0xbf7b3f55
.long 0xbf553f7b,0xbe483f0e,0x3f55bf7b,0x3e48bf0e
.long 0xbe953dc9,0xbf223ef1,0xbf753f7f,0xbf463f62
.long 0x3f75bf7f,0x3f46bf62,0xbe953dc9,0xbf223ef1
.long 0xbf80bf80,0xbf80bf80,0xbf80bf80,0xbf80bf80
.long 0x0,0x0,0x0,0x0
.long 0x3ef13f22,0x3dc93e95,0xbf62bf46,0xbf7fbf75
.long 0xbf62bf46,0xbf7fbf75,0xbef1bf22,0xbdc9be95
.long 0x3f0e3e48,0x3f7b3f55,0xbf0ebe48,0xbf7bbf55
.long 0x3f553f7b,0x3e483f0e,0xbf55bf7b,0xbe48bf0e
.long 0xbf7fbf62,0xbe95bf46,0xbdc93ef1,0xbf75bf22
.long 0x3dc9bef1,0x3f753f22,0xbf7fbf62,0xbe95bf46
.long 0x3ec43f6d,0xbf6dbec4,0x3ec43f6d,0xbf6dbec4
.long 0xbf6dbec4,0xbec4bf6d,0xbf6dbec4,0xbec4bf6d
.long 0x3f22be95,0x3ef13f7f,0x3f463f75,0xbf62bdc9
.long 0x3f463f75,0xbf62bdc9,0xbf223e95,0xbef1bf7f
.long 0xbf7bbf0e,0x3f55be48,0x3f7b3f0e,0xbf553e48
.long 0x3e48bf55,0x3f0e3f7b,0xbe483f55,0xbf0ebf7b
.long 0x3e953f7f,0xbf22bf62,0x3f75bdc9,0xbf463ef1
.long 0xbf753dc9,0x3f46bef1,0x3e953f7f,0xbf22bf62
.long 0x3f35bf35,0xbf353f35,0x3f35bf35,0xbf353f35
.long 0x3f353f35,0xbf35bf35,0x3f353f35,0xbf35bf35
.long 0xbf75bdc9,0x3f463ef1,0x3e95bf7f,0xbf223f62
.long 0x3e95bf7f,0xbf223f62,0x3f753dc9,0xbf46bef1
.long 0x3e483f55,0x3f0ebf7b,0xbe48bf55,0xbf0e3f7b
.long 0xbf7b3f0e,0x3f553e48,0x3f7bbf0e,0xbf55be48
.long 0x3f46bf75,0xbf623dc9,0xbf22be95,0xbef13f7f
.long 0x3f223e95,0x3ef1bf7f,0x3f46bf75,0xbf623dc9
.long 0xbf6d3ec4,0xbec43f6d,0xbf6d3ec4,0xbec43f6d
.long 0x3ec4bf6d,0xbf6d3ec4,0x3ec4bf6d,0xbf6d3ec4
.long 0x3dc93ef1,0x3f75bf22,0xbf7f3f62,0xbe953f46
.long 0xbf7f3f62,0xbe953f46,0xbdc9bef1,0xbf753f22
.long 0x3f55bf7b,0x3e48bf0e,0xbf553f7b,0xbe483f0e
.long 0x3f0ebe48,0x3f7bbf55,0xbf0e3e48,0xbf7b3f55
.long 0xbf623f46,0xbf7f3f75,0xbef13f22,0xbdc93e95
.long 0x3ef1bf22,0x3dc9be95,0xbf623f46,0xbf7f3f75
.long 0xbf803f80,0xbf803f80,0xbf803f80,0xbf803f80
.long 0x0,0x0,0x0,0x0
.long 0xbf7b3f80,0xbf553f6d,0x3e480000,0x3f0ebec4
.long 0x3e480000,0x3f0ebec4,0x3f7bbf80,0x3f55bf6d
.long 0xbf6d3f80,0xbec43f35,0x3f6dbf80,0x3ec4bf35
.long 0x3ec40000,0x3f6dbf35,0xbec40000,0xbf6d3f35
.long 0xbf553f80,0x3e483ec4,0xbf0e0000,0xbf7b3f6d
.long 0x3f0e0000,0x3f7bbf6d,0xbf553f80,0x3e483ec4
.long 0xbf353f80,0x3f350000,0xbf353f80,0x3f350000
.long 0x3f350000,0x3f35bf80,0x3f350000,0x3f35bf80
.long 0xbf0e3f80,0x3f7bbec4,0x3f550000,0x3e48bf6d
.long 0x3f550000,0x3e48bf6d,0x3f0ebf80,0xbf7b3ec4
.long 0xbec43f80,0x3f6dbf35,0x3ec4bf80,0xbf6d3f35
.long 0x3f6d0000,0xbec4bf35,0xbf6d0000,0x3ec43f35
.long 0xbe483f80,0x3f0ebf6d,0xbf7b0000,0x3f553ec4
.long 0x3f7b0000,0xbf55bec4,0xbe483f80,0x3f0ebf6d
.long 0x3f80,0xbf80,0x3f80,0xbf80
.long 0x3f800000,0xbf800000,0x3f800000,0xbf800000
.long 0x3e483f80,0xbf0ebf6d,0x3f7b0000,0xbf553ec4
.long 0x3f7b0000,0xbf553ec4,0xbe48bf80,0x3f0e3f6d
.long 0x3ec43f80,0xbf6dbf35,0xbec4bf80,0x3f6d3f35
.long 0x3f6d0000,0xbec43f35,0xbf6d0000,0x3ec4bf35
.long 0x3f0e3f80,0xbf7bbec4,0xbf550000,0xbe48bf6d
.long 0x3f550000,0x3e483f6d,0x3f0e3f80,0xbf7bbec4
.long 0x3f353f80,0xbf350000,0x3f353f80,0xbf350000
.long 0x3f350000,0x3f353f80,0x3f350000,0x3f353f80
.long 0x3f553f80,0xbe483ec4,0x3f0e0000,0x3f7b3f6d
.long 0x3f0e0000,0x3f7b3f6d,0xbf55bf80,0x3e48bec4
.long 0x3f6d3f80,0x3ec43f35,0xbf6dbf80,0xbec4bf35
.long 0x3ec40000,0x3f6d3f35,0xbec40000,0xbf6dbf35
.long 0x3f7b3f80,0x3f553f6d,0xbe480000,0xbf0ebec4
.long 0x3e480000,0x3f0e3ec4,0x3f7b3f80,0x3f553f6d
.long 0xbf803f80,0xbf803f80,0xbf803f80,0xbf803f80
.long 0x0,0x0,0x0,0x0
.long 0xbf0e3f35,0xbe483ec4,0x3f55bf35,0x3f7bbf6d
.long 0x3f55bf35,0x3f7bbf6d,0x3f0ebf35,0x3e48bec4
.long 0x3ec40000,0x3f6dbf35,0xbec40000,0xbf6d3f35
.long 0x3f6dbf80,0x3ec4bf35,0xbf6d3f80,0xbec43f35
.long 0x3f7bbf35,0x3f0ebf6d,0xbe483f35,0x3f55bec4
.long 0x3e48bf35,0xbf553ec4,0x3f7bbf35,0x3f0ebf6d
.long 0x3f35bf80,0xbf350000,0x3f35bf80,0xbf350000
.long 0xbf350000,0xbf353f80,0xbf350000,0xbf353f80
.long 0xbe48bf35,0xbf553f6d,0xbf7b3f35,0x3f0e3ec4
.long 0xbf7b3f35,0x3f0e3ec4,0x3e483f35,0x3f55bf6d
.long 0xbf6d0000,0x3ec43f35,0x3f6d0000,0xbec4bf35
.long 0xbec43f80,0x3f6dbf35,0x3ec4bf80,0xbf6d3f35
.long 0xbf553f35,0x3f7bbec4,0xbf0ebf35,0x3e483f6d
.long 0x3f0e3f35,0xbe48bf6d,0xbf553f35,0x3f7bbec4
.long 0x3f80,0xbf80,0x3f80,0xbf80
.long 0x3f800000,0xbf800000,0x3f800000,0xbf800000
.long 0x3f553f35,0xbf7bbec4,0x3f0ebf35,0xbe483f6d
.long 0x3f0ebf35,0xbe483f6d,0xbf55bf35,0x3f7b3ec4
.long 0x3f6d0000,0xbec43f35,0xbf6d0000,0x3ec4bf35
.long 0xbec4bf80,0x3f6d3f35,0x3ec43f80,0xbf6dbf35
.long 0x3e48bf35,0x3f553f6d,0x3f7b3f35,0xbf0e3ec4
.long 0xbf7bbf35,0x3f0ebec4,0x3e48bf35,0x3f553f6d
.long 0xbf35bf80,0x3f350000,0xbf35bf80,0x3f350000
.long 0xbf350000,0xbf35bf80,0xbf350000,0xbf35bf80
.long 0xbf7bbf35,0xbf0ebf6d,0x3e483f35,0xbf55bec4
.long 0x3e483f35,0xbf55bec4,0x3f7b3f35,0x3f0e3f6d
.long 0xbec40000,0xbf6dbf35,0x3ec40000,0x3f6d3f35
.long 0x3f6d3f80,0x3ec43f35,0xbf6dbf80,0xbec4bf35
.long 0x3f0e3f35,0x3e483ec4,0xbf55bf35,0xbf7bbf6d
.long 0x3f553f35,0x3f7b3f6d,0x3f0e3f35,0x3e483ec4
.long 0xbf803f80,0xbf803f80,0xbf803f80,0xbf803f80
.long 0x0,0x0,0x0,0x0
.long 0x3f7bbf80,0x3f55bf6d,0xbe480000,0xbf0e3ec4
.long 0xbe480000,0xbf0e3ec4,0xbf7b3f80,0xbf553f6d
.long 0xbf6d3f80,0xbec43f35,0x3f6dbf80,0x3ec4bf35
.long 0x3ec40000,0x3f6dbf35,0xbec40000,0xbf6d3f35
.long 0x3f55bf80,0xbe48bec4,0x3f0e0000,0x3f7bbf6d
.long 0xbf0e0000,0xbf7b3f6d,0x3f55bf80,0xbe48bec4
.long 0xbf353f80,0x3f350000,0xbf353f80,0x3f350000
.long 0x3f350000,0x3f35bf80,0x3f350000,0x3f35bf80
.long 0x3f0ebf80,0xbf7b3ec4,0xbf550000,0xbe483f6d
.long 0xbf550000,0xbe483f6d,0xbf0e3f80,0x3f7bbec4
.long 0xbec43f80,0x3f6dbf35,0x3ec4bf80,0xbf6d3f35
.long 0x3f6d0000,0xbec4bf35,0xbf6d0000,0x3ec43f35
.long 0x3e48bf80,0xbf0e3f6d,0x3f7b0000,0xbf55bec4
.long 0xbf7b0000,0x3f553ec4,0x3e48bf80,0xbf0e3f6d
.long 0x3f80,0xbf80,0x3f80,0xbf80
.long 0x3f800000,0xbf800000,0x3f800000,0xbf800000
.long 0xbe48bf80,0x3f0e3f6d,0xbf7b0000,0x3f55bec4
.long 0xbf7b0000,0x3f55bec4,0x3e483f80,0xbf0ebf6d
.long 0x3ec43f80,0xbf6dbf35,0xbec4bf80,0x3f6d3f35
.long 0x3f6d0000,0xbec43f35,0xbf6d0000,0x3ec4bf35
.long 0xbf0ebf80,0x3f7b3ec4,0x3f550000,0x3e483f6d
.long 0xbf550000,0xbe48bf6d,0xbf0ebf80,0x3f7b3ec4
.long 0x3f353f80,0xbf350000,0x3f353f80,0xbf350000
.long 0x3f350000,0x3f353f80,0x3f350000,0x3f353f80
.long 0xbf55bf80,0x3e48bec4,0xbf0e0000,0xbf7bbf6d
.long 0xbf0e0000,0xbf7bbf6d,0x3f553f80,0xbe483ec4
.long 0x3f6d3f80,0x3ec43f35,0xbf6dbf80,0xbec4bf35
.long 0x3ec40000,0x3f6d3f35,0xbec40000,0xbf6dbf35
.long 0xbf7bbf80,0xbf55bf6d,0x3e480000,0x3f0e3ec4
.long 0xbe480000,0xbf0ebec4,0xbf7bbf80,0xbf55bf6d
.long 0xbf803f80,0xbf803f80,0xbf803f80,0xbf803f80
.long 0x0,0x0,0x0,0x0
.long 0x3f0ebf35,0x3e48bec4,0xbf553f35,0xbf7b3f6d
.long 0xbf553f35,0xbf7b3f6d,0xbf0e3f35,0xbe483ec4
.long 0x3ec40000,0x3f6dbf35,0xbec40000,0xbf6d3f35
.long 0x3f6dbf80,0x3ec4bf35,0xbf6d3f80,0xbec43f35
.long 0xbf7b3f35,0xbf0e3f6d,0x3e48bf35,0xbf553ec4
.long 0xbe483f35,0x3f55bec4,0xbf7b3f35,0xbf0e3f6d
.long 0x3f35bf80,0xbf350000,0x3f35bf80,0xbf350000
.long 0xbf350000,0xbf353f80,0xbf350000,0xbf353f80
.long 0x3e483f35,0x3f55bf6d,0x3f7bbf35,0xbf0ebec4
.long 0x3f7bbf35,0xbf0ebec4,0xbe48bf35,0xbf553f6d
.long 0xbf6d0000,0x3ec43f35,0x3f6d0000,0xbec4bf35
.long 0xbec43f80,0x3f6dbf35,0x3ec4bf80,0xbf6d3f35
.long 0x3f55bf35,0xbf7b3ec4,0x3f0e3f35,0xbe48bf6d
.long 0xbf0ebf35,0x3e483f6d,0x3f55bf35,0xbf7b3ec4
.long 0x3f80,0xbf80,0x3f80,0xbf80
.long 0x3f800000,0xbf800000,0x3f800000,0xbf800000
.long 0xbf55bf35,0x3f7b3ec4,0xbf0e3f35,0x3e48bf6d
.long 0xbf0e3f35,0x3e48bf6d,0x3f553f35,0xbf7bbec4
.long 0x3f6d0000,0xbec43f35,0xbf6d0000,0x3ec4bf35
.long 0xbec4bf80,0x3f6d3f35,0x3ec43f80,0xbf6dbf35
.long 0xbe483f35,0xbf55bf6d,0xbf7bbf35,0x3f0ebec4
.long 0x3f7b3f35,0xbf0e3ec4,0xbe483f35,0xbf55bf6d
.long 0xbf35bf80,0x3f350000,0xbf35bf80,0x3f350000
.long 0xbf350000,0xbf35bf80,0xbf350000,0xbf35bf80
.long 0x3f7b3f35,0x3f0e3f6d,0xbe48bf35,0x3f553ec4
.long 0xbe48bf35,0x3f553ec4,0xbf7bbf35,0xbf0ebf6d
.long 0xbec40000,0xbf6dbf35,0x3ec40000,0x3f6d3f35
.long 0x3f6d3f80,0x3ec43f35,0xbf6dbf80,0xbec4bf35
.long 0xbf0ebf35,0xbe48bec4,0x3f553f35,0x3f7b3f6d
.long 0xbf55bf35,0xbf7bbf6d,0xbf0ebf35,0xbe48bec4
.long 0x0,0x0,0x0,0x0
.long 0xbf803f80,0xbf803f80,0xbf803f80,0xbf803f80
.long 0xbe953dc9,0xbf223ef1,0xbf753f7f,0xbf463f62
.long 0xbf753f7f,0xbf463f62,0x3e95bdc9,0x3f22bef1
.long 0xbf0e3e48,0xbf7b3f55,0x3f0ebe48,0x3f7bbf55
.long 0xbf553f7b,0xbe483f0e,0x3f55bf7b,0x3e48bf0e
.long 0xbf463e95,0xbf623f7f,0x3f22bf75,0xbef1bdc9
.long 0xbf223f75,0x3ef13dc9,0xbf463e95,0xbf623f7f
.long 0xbf6d3ec4,0xbec43f6d,0xbf6d3ec4,0xbec43f6d
.long 0xbec43f6d,0x3f6dbec4,0xbec43f6d,0x3f6dbec4
.long 0xbf7f3ef1,0x3e953f22,0xbdc93f62,0x3f75bf46
.long 0xbdc93f62,0x3f75bf46,0x3f7fbef1,0xbe95bf22
.long 0xbf7b3f0e,0x3f553e48,0x3f7bbf0e,0xbf55be48
.long 0x3e483f55,0x3f0ebf7b,0xbe48bf55,0xbf0e3f7b
.long 0xbf623f22,0x3f7fbe95,0xbef1bf46,0x3dc93f75
.long 0x3ef13f46,0xbdc9bf75,0xbf623f22,0x3f7fbe95
.long 0xbf353f35,0x3f35bf35,0xbf353f35,0x3f35bf35
.long 0x3f353f35,0xbf35bf35,0x3f353f35,0xbf35bf35
.long 0xbef13f46,0x3dc9bf75,0x3f623f22,0xbf7fbe95
.long 0x3f623f22,0xbf7fbe95,0x3ef1bf46,0xbdc93f75
.long 0xbe483f55,0xbf0ebf7b,0x3e48bf55,0x3f0e3f7b
.long 0x3f7b3f0e,0xbf553e48,0xbf7bbf0e,0x3f55be48
.long 0x3dc93f62,0xbf75bf46,0xbf7fbef1,0x3e95bf22
.long 0x3f7f3ef1,0xbe953f22,0x3dc93f62,0xbf75bf46
.long 0x3ec43f6d,0xbf6dbec4,0x3ec43f6d,0xbf6dbec4
.long 0x3f6d3ec4,0x3ec43f6d,0x3f6d3ec4,0x3ec43f6d
.long 0x3f223f75,0xbef13dc9,0x3f463e95,0x3f623f7f
.long 0x3f463e95,0x3f623f7f,0xbf22bf75,0x3ef1bdc9
.long 0x3f553f7b,0x3e483f0e,0xbf55bf7b,0xbe48bf0e
.long 0x3f0e3e48,0x3f7b3f55,0xbf0ebe48,0xbf7bbf55
.long 0x3f753f7f,0x3f463f62,0xbe95bdc9,0xbf22bef1
.long 0x3e953dc9,0x3f223ef1,0x3f753f7f,0x3f463f62
.long 0x0,0x0,0x0,0x0
.long 0xbf803f80,0xbf803f80,0xbf803f80,0xbf803f80
.long 0xbf623f46,0xbf7f3f75,0xbef13f22,0xbdc93e95
.long 0xbef13f22,0xbdc93e95,0x3f62bf46,0x3f7fbf75
.long 0xbf553f7b,0xbe483f0e,0x3f55bf7b,0x3e48bf0e
.long 0x3f0ebe48,0x3f7bbf55,0xbf0e3e48,0xbf7b3f55
.long 0x3dc93ef1,0x3f75bf22,0xbf7f3f62,0xbe953f46
.long 0x3f7fbf62,0x3e95bf46,0x3dc93ef1,0x3f75bf22
.long 0x3f6dbec4,0x3ec4bf6d,0x3f6dbec4,0x3ec4bf6d
.long 0x3ec4bf6d,0xbf6d3ec4,0x3ec4bf6d,0xbf6d3ec4
.long 0x3f46bf75,0xbf623dc9,0xbf22be95,0xbef13f7f
.long 0xbf22be95,0xbef13f7f,0xbf463f75,0x3f62bdc9
.long 0xbe48bf55,0xbf0e3f7b,0x3e483f55,0x3f0ebf7b
.long 0xbf7b3f0e,0x3f553e48,0x3f7bbf0e,0xbf55be48
.long 0xbf75bdc9,0x3f463ef1,0x3e95bf7f,0xbf223f62
.long 0xbe953f7f,0x3f22bf62,0xbf75bdc9,0x3f463ef1
.long 0xbf353f35,0x3f35bf35,0xbf353f35,0x3f35bf35
.long 0x3f353f35,0xbf35bf35,0x3f353f35,0xbf35bf35
.long 0x3e953f7f,0xbf22bf62,0x3f75bdc9,0xbf463ef1
.long 0x3f75bdc9,0xbf463ef1,0xbe95bf7f,0x3f223f62
.long 0x3f7b3f0e,0xbf553e48,0xbf7bbf0e,0x3f55be48
.long 0x3e48bf55,0x3f0e3f7b,0xbe483f55,0xbf0ebf7b
.long 0x3f22be95,0x3ef13f7f,0x3f463f75,0xbf62bdc9
.long 0xbf46bf75,0x3f623dc9,0x3f22be95,0x3ef13f7f
.long 0xbec4bf6d,0x3f6d3ec4,0xbec4bf6d,0x3f6d3ec4
.long 0xbf6dbec4,0xbec4bf6d,0xbf6dbec4,0xbec4bf6d
.long 0xbf7fbf62,0xbe95bf46,0xbdc93ef1,0xbf75bf22
.long 0xbdc93ef1,0xbf75bf22,0x3f7f3f62,0x3e953f46
.long 0xbf0ebe48,0xbf7bbf55,0x3f0e3e48,0x3f7b3f55
.long 0x3f553f7b,0x3e483f0e,0xbf55bf7b,0xbe48bf0e
.long 0x3ef13f22,0x3dc93e95,0xbf62bf46,0xbf7fbf75
.long 0x3f623f46,0x3f7f3f75,0x3ef13f22,0x3dc93e95
.long 0x0,0x0,0x0,0x0
.long 0xbf803f80,0xbf803f80,0xbf803f80,0xbf803f80
.long 0x3e95bdc9,0x3f22bef1,0x3f75bf7f,0x3f46bf62
.long 0x3f75bf7f,0x3f46bf62,0xbe953dc9,0xbf223ef1
.long 0xbf0e3e48,0xbf7b3f55,0x3f0ebe48,0x3f7bbf55
.long 0xbf553f7b,0xbe483f0e,0x3f55bf7b,0x3e48bf0e
.long 0x3f46be95,0x3f62bf7f,0xbf223f75,0x3ef13dc9
.long 0x3f22bf75,0xbef1bdc9,0x3f46be95,0x3f62bf7f
.long 0xbf6d3ec4,0xbec43f6d,0xbf6d3ec4,0xbec43f6d
.long 0xbec43f6d,0x3f6dbec4,0xbec43f6d,0x3f6dbec4
.long 0x3f7fbef1,0xbe95bf22,0x3dc9bf62,0xbf753f46
.long 0x3dc9bf62,0xbf753f46,0xbf7f3ef1,0x3e953f22
.long 0xbf7b3f0e,0x3f553e48,0x3f7bbf0e,0xbf55be48
.long 0x3e483f55,0x3f0ebf7b,0xbe48bf55,0xbf0e3f7b
.long 0x3f62bf22,0xbf7f3e95,0x3ef13f46,0xbdc9bf75
.long 0xbef1bf46,0x3dc93f75,0x3f62bf22,0xbf7f3e95
.long 0xbf353f35,0x3f35bf35,0xbf353f35,0x3f35bf35
.long 0x3f353f35,0xbf35bf35,0x3f353f35,0xbf35bf35
.long 0x3ef1bf46,0xbdc93f75,0xbf62bf22,0x3f7f3e95
.long 0xbf62bf22,0x3f7f3e95,0xbef13f46,0x3dc9bf75
.long 0xbe483f55,0xbf0ebf7b,0x3e48bf55,0x3f0e3f7b
.long 0x3f7b3f0e,0xbf553e48,0xbf7bbf0e,0x3f55be48
.long 0xbdc9bf62,0x3f753f46,0x3f7f3ef1,0xbe953f22
.long 0xbf7fbef1,0x3e95bf22,0xbdc9bf62,0x3f753f46
.long 0x3ec43f6d,0xbf6dbec4,0x3ec43f6d,0xbf6dbec4
.long 0x3f6d3ec4,0x3ec43f6d,0x3f6d3ec4,0x3ec43f6d
.long 0xbf22bf75,0x3ef1bdc9,0xbf46be95,0xbf62bf7f
.long 0xbf46be95,0xbf62bf7f,0x3f223f75,0xbef13dc9
.long 0x3f553f7b,0x3e483f0e,0xbf55bf7b,0xbe48bf0e
.long 0x3f0e3e48,0x3f7b3f55,0xbf0ebe48,0xbf7bbf55
.long 0xbf75bf7f,0xbf46bf62,0x3e953dc9,0x3f223ef1
.long 0xbe95bdc9,0xbf22bef1,0xbf75bf7f,0xbf46bf62
.long 0x0,0x0,0x0,0x0
.long 0xbf803f80,0xbf803f80,0xbf803f80,0xbf803f80
.long 0x3f62bf46,0x3f7fbf75,0x3ef1bf22,0x3dc9be95
.long 0x3ef1bf22,0x3dc9be95,0xbf623f46,0xbf7f3f75
.long 0xbf553f7b,0xbe483f0e,0x3f55bf7b,0x3e48bf0e
.long 0x3f0ebe48,0x3f7bbf55,0xbf0e3e48,0xbf7b3f55
.long 0xbdc9bef1,0xbf753f22,0x3f7fbf62,0x3e95bf46
.long 0xbf7f3f62,0xbe953f46,0xbdc9bef1,0xbf753f22
.long 0x3f6dbec4,0x3ec4bf6d,0x3f6dbec4,0x3ec4bf6d
.long 0x3ec4bf6d,0xbf6d3ec4,0x3ec4bf6d,0xbf6d3ec4
.long 0xbf463f75,0x3f62bdc9,0x3f223e95,0x3ef1bf7f
.long 0x3f223e95,0x3ef1bf7f,0x3f46bf75,0xbf623dc9
.long 0xbe48bf55,0xbf0e3f7b,0x3e483f55,0x3f0ebf7b
.long 0xbf7b3f0e,0x3f553e48,0x3f7bbf0e,0xbf55be48
.long 0x3f753dc9,0xbf46bef1,0xbe953f7f,0x3f22bf62
.long 0x3e95bf7f,0xbf223f62,0x3f753dc9,0xbf46bef1
.long 0xbf353f35,0x3f35bf35,0xbf353f35,0x3f35bf35
.long 0x3f353f35,0xbf35bf35,0x3f353f35,0xbf35bf35
.long 0xbe95bf7f,0x3f223f62,0xbf753dc9,0x3f46bef1
.long 0xbf753dc9,0x3f46bef1,0x3e953f7f,0xbf22bf62
.long 0x3f7b3f0e,0xbf553e48,0xbf7bbf0e,0x3f55be48
.long 0x3e48bf55,0x3f0e3f7b,0xbe483f55,0xbf0ebf7b
.long 0xbf223e95,0xbef1bf7f,0xbf46bf75,0x3f623dc9
.long 0x3f463f75,0xbf62bdc9,0xbf223e95,0xbef1bf7f
.long 0xbec4bf6d,0x3f6d3ec4,0xbec4bf6d,0x3f6d3ec4
.long 0xbf6dbec4,0xbec4bf6d,0xbf6dbec4,0xbec4bf6d
.long 0x3f7f3f62,0x3e953f46,0x3dc9bef1,0x3f753f22
.long 0x3dc9bef1,0x3f753f22,0xbf7fbf62,0xbe95bf46
.long 0xbf0ebe48,0xbf7bbf55,0x3f0e3e48,0x3f7b3f55
.long 0x3f553f7b,0x3e483f0e,0xbf55bf7b,0xbe48bf0e
.long 0xbef1bf22,0xbdc9be95,0x3f623f46,0x3f7f3f75
.long 0xbf62bf46,0xbf7fbf75,0xbef1bf22,0xbdc9be95
.p2align 12
L_body:
    s_waitcnt vmcnt(5)
    ds_read_b128 v[64:67], v160 offset:0
    ds_read_b128 v[68:71], v161 offset:0
    ds_read_b128 v[72:75], v162 offset:0
    ds_read_b128 v[76:79], v163 offset:0
    ds_read_b128 v[80:83], v164 offset:0
    ds_read_b128 v[84:87], v165 offset:0
    ds_read_b128 v[88:91], v166 offset:0
    ds_read_b128 v[92:95], v167 offset:0
    ds_read_b128 v[96:99], v160 offset:8192
    ds_read_b128 v[100:103], v161 offset:8192
    ds_read_b128 v[104:107], v162 offset:8192
    ds_read_b128 v[108:111], v163 offset:8192
    ds_read_b128 v[112:115], v164 offset:8192
    ds_read_b128 v[116:119], v165 offset:8192
    ds_read_b128 v[120:123], v166 offset:8192
    ds_read_b128 v[124:127], v167 offset:8192
    s_waitcnt lgkmcnt(0)
    v_dot2c_f32_bf16 v180, s43, v64
    v_dot2c_f32_bf16 v181, v64, v64
    v_dot2c_f32_bf16 v180, s43, v65
    v_dot2c_f32_bf16 v181, v65, v65
    v_dot2c_f32_bf16 v180, s43, v66
    v_dot2c_f32_bf16 v181, v66, v66
    v_dot2c_f32_bf16 v180, s43, v67
    v_dot2c_f32_bf16 v181, v67, v67
    v_dot2c_f32_bf16 v180, s43, v68
    v_dot2c_f32_bf16 v181, v68, v68
    v_dot2c_f32_bf16 v180, s43, v69
    v_dot2c_f32_bf16 v181, v69, v69
    v_dot2c_f32_bf16 v180, s43, v70
    v_dot2c_f32_bf16 v181, v70, v70
    v_dot2c_f32_bf16 v180, s43, v71
    v_dot2c_f32_bf16 v181, v71, v71
    v_dot2c_f32_bf16 v180, s43, v72
    v_dot2c_f32_bf16 v181, v72, v72
    v_dot2c_f32_bf16 v180, s43, v73
    v_dot2c_f32_bf16 v181, v73, v73
    v_dot2c_f32_bf16 v180, s43, v74
    v_dot2c_f32_bf16 v181, v74, v74
    v_dot2c_f32_bf16 v180, s43, v75
    v_dot2c_f32_bf16 v181, v75, v75
    v_dot2c_f32_bf16 v180, s43, v76
    v_dot2c_f32_bf16 v181, v76, v76
    v_dot2c_f32_bf16 v180, s43, v77
    v_dot2c_f32_bf16 v181, v77, v77
    v_dot2c_f32_bf16 v180, s43, v78
    v_dot2c_f32_bf16 v181, v78, v78
    v_dot2c_f32_bf16 v180, s43, v79
    v_dot2c_f32_bf16 v181, v79, v79
    v_dot2c_f32_bf16 v180, s43, v80
    v_dot2c_f32_bf16 v181, v80, v80
    v_dot2c_f32_bf16 v180, s43, v81
    v_dot2c_f32_bf16 v181, v81, v81
    v_dot2c_f32_bf16 v180, s43, v82
    v_dot2c_f32_bf16 v181, v82, v82
    v_dot2c_f32_bf16 v180, s43, v83
    v_dot2c_f32_bf16 v181, v83, v83
    v_dot2c_f32_bf16 v180, s43, v84
    v_dot2c_f32_bf16 v181, v84, v84
    v_dot2c_f32_bf16 v180, s43, v85
    v_dot2c_f32_bf16 v181, v85, v85
    v_dot2c_f32_bf16 v180, s43, v86
    v_dot2c_f32_bf16 v181, v86, v86
    v_dot2c_f32_bf16 v180, s43, v87
    v_dot2c_f32_bf16 v181, v87, v87
    v_dot2c_f32_bf16 v180, s43, v88
    v_dot2c_f32_bf16 v181, v88, v88
    v_dot2c_f32_bf16 v180, s43, v89
    v_dot2c_f32_bf16 v181, v89, v89
    v_dot2c_f32_bf16 v180, s43, v90
    v_dot2c_f32_bf16 v181, v90, v90
    v_dot2c_f32_bf16 v180, s43, v91
    v_dot2c_f32_bf16 v181, v91, v91
    v_dot2c_f32_bf16 v180, s43, v92
    v_dot2c_f32_bf16 v181, v92, v92
    v_dot2c_f32_bf16 v180, s43, v93
    v_dot2c_f32_bf16 v181, v93, v93
    v_dot2c_f32_bf16 v180, s43, v94
    v_dot2c_f32_bf16 v181, v94, v94
    v_dot2c_f32_bf16 v180, s43, v95
    v_dot2c_f32_bf16 v181, v95, v95
    s_barrier
    ds_read_b128 v[160:163], v174
    ds_read_b128 v[164:167], v175
    v_mfma_f32_32x32x16_bf16 v[0:15], v[64:67], v[184:187], 0
    s_xor_b32 s69, s34, 0
    s_mul_i32 s69, s69, 6144
    s_add_u32 s69, s69, 98304
    v_add_u32 v176, s69, v255
    s_xor_b32 s69, s34, 1
    s_mul_i32 s69, s69, 6144
    v_mfma_f32_32x32x16_bf16 v[16:31], v[64:67], v[216:219], 0
    s_add_u32 s69, s69, 98304
    v_add_u32 v177, s69, v255
    s_xor_b32 s69, s34, 2
    s_mul_i32 s69, s69, 6144
    s_add_u32 s69, s69, 100352
    v_add_u32 v178, s69, v255
    v_mfma_f32_32x32x16_bf16 v[0:15], v[68:71], v[188:191], v[0:15]
    s_xor_b32 s69, s34, 3
    s_mul_i32 s69, s69, 6144
    s_add_u32 s69, s69, 102400
    v_add_u32 v179, s69, v255
    s_lshl_b32 s69, s34, 10
    s_add_u32 s69, s69, 152064
    v_mfma_f32_32x32x16_bf16 v[16:31], v[68:71], v[220:223], v[16:31]
    v_add_u32 v168, s69, v255
    v_add_u32 v169, 152064, v255
    v_and_b32 v36, 1, v254
    v_add_u32 v36, -1, v36
    v_and_b32 v36, 0x80008000, v36
    s_nop 1
    v_mfma_f32_32x32x16_bf16 v[0:15], v[72:75], v[192:195], v[0:15]
    v_xor_b32_dpp v136, v128, v36 quad_perm:[1,0,3,2] row_mask:0xf bank_mask:0xf
    v_xor_b32_dpp v137, v129, v36 quad_perm:[1,0,3,2] row_mask:0xf bank_mask:0xf
    v_xor_b32_dpp v138, v130, v36 quad_perm:[1,0,3,2] row_mask:0xf bank_mask:0xf
    v_xor_b32_dpp v139, v131, v36 quad_perm:[1,0,3,2] row_mask:0xf bank_mask:0xf
    v_xor_b32_dpp v140, v132, v36 quad_perm:[1,0,3,2] row_mask:0xf bank_mask:0xf
    v_xor_b32_dpp v141, v133, v36 quad_perm:[1,0,3,2] row_mask:0xf bank_mask:0xf
    v_mfma_f32_32x32x16_bf16 v[16:31], v[72:75], v[224:227], v[16:31]
    v_xor_b32_dpp v142, v134, v36 quad_perm:[1,0,3,2] row_mask:0xf bank_mask:0xf
    v_xor_b32_dpp v143, v135, v36 quad_perm:[1,0,3,2] row_mask:0xf bank_mask:0xf
    v_xor_b32_dpp v152, v144, v36 quad_perm:[1,0,3,2] row_mask:0xf bank_mask:0xf
    v_xor_b32_dpp v153, v145, v36 quad_perm:[1,0,3,2] row_mask:0xf bank_mask:0xf
    v_xor_b32_dpp v154, v146, v36 quad_perm:[1,0,3,2] row_mask:0xf bank_mask:0xf
    v_xor_b32_dpp v155, v147, v36 quad_perm:[1,0,3,2] row_mask:0xf bank_mask:0xf
    v_mfma_f32_32x32x16_bf16 v[0:15], v[76:79], v[196:199], v[0:15]
    v_xor_b32_dpp v156, v148, v36 quad_perm:[1,0,3,2] row_mask:0xf bank_mask:0xf
    v_xor_b32_dpp v157, v149, v36 quad_perm:[1,0,3,2] row_mask:0xf bank_mask:0xf
    v_xor_b32_dpp v158, v150, v36 quad_perm:[1,0,3,2] row_mask:0xf bank_mask:0xf
    v_xor_b32_dpp v159, v151, v36 quad_perm:[1,0,3,2] row_mask:0xf bank_mask:0xf
    s_and_b32 s68, s34, 1
    s_lshl_b32 s68, s68, 5
    v_mfma_f32_32x32x16_bf16 v[16:31], v[76:79], v[228:231], v[16:31]
    s_add_u32 s68, s68, s39
    v_lshl_add_u32 v38, v254, 6, s68
    s_lshr_b32 s68, s34, 1
    s_lshl_b32 s68, s68, 31
    s_xor_b32 s68, s68, 0x3a000000
    v_cvt_f32_u32 v38, v38
    v_mfma_f32_32x32x16_bf16 v[0:15], v[80:83], v[200:203], v[0:15]
    v_cvt_f32_u32 v39, v253
    v_mul_f32 v38, s68, v38
    v_mul_f32 v39, 4.0, v39
    v_mul_f32 v39, v38, v39
    v_fmamk_f32 v40, v38, 0x0, v39
    v_fmamk_f32 v41, v38, 0x3f800000, v39
    v_mfma_f32_32x32x16_bf16 v[16:31], v[80:83], v[232:235], v[16:31]
    v_fmamk_f32 v42, v38, 0x40000000, v39
    v_fmamk_f32 v43, v38, 0x40400000, v39
    v_cos_f32 v44, v40
    v_sin_f32 v48, v40
    v_mfma_f32_32x32x16_bf16 v[0:15], v[84:87], v[204:207], v[0:15]
    v_cos_f32 v45, v41
    v_sin_f32 v49, v41
    v_cos_f32 v46, v42
    v_mfma_f32_32x32x16_bf16 v[16:31], v[84:87], v[236:239], v[16:31]
    v_sin_f32 v50, v42
    v_cos_f32 v47, v43
    v_sin_f32 v51, v43
    v_mfma_f32_32x32x16_bf16 v[0:15], v[88:91], v[208:211], v[0:15]
    v_cvt_pk_bf16_f32 v44, v44, v48
    v_cvt_pk_bf16_f32 v45, v45, v49
    v_cvt_pk_bf16_f32 v46, v46, v50
    v_cvt_pk_bf16_f32 v47, v47, v51
    v_accvgpr_write_b32 a224, v44
    v_accvgpr_write_b32 a225, v45
    v_mfma_f32_32x32x16_bf16 v[16:31], v[88:91], v[240:243], v[16:31]
    v_accvgpr_write_b32 a226, v46
    v_accvgpr_write_b32 a227, v47
    v_fmamk_f32 v40, v38, 0x41000000, v39
    v_fmamk_f32 v41, v38, 0x41100000, v39
    v_fmamk_f32 v42, v38, 0x41200000, v39
    v_fmamk_f32 v43, v38, 0x41300000, v39
    v_mfma_f32_32x32x16_bf16 v[0:15], v[92:95], v[212:215], v[0:15]
    v_cos_f32 v44, v40
    v_sin_f32 v48, v40
    v_cos_f32 v45, v41
    v_mfma_f32_32x32x16_bf16 v[16:31], v[92:95], v[244:247], v[16:31]
    v_sin_f32 v49, v41
    v_cos_f32 v46, v42
    v_sin_f32 v50, v42
    v_cos_f32 v47, v43
    v_sin_f32 v51, v43
    v_cvt_pk_bf16_f32 v44, v44, v48
    v_cvt_pk_bf16_f32 v45, v45, v49
    v_cvt_pk_bf16_f32 v46, v46, v50
    v_cvt_pk_bf16_f32 v47, v47, v51
    v_accvgpr_write_b32 a228, v44
    v_accvgpr_write_b32 a229, v45
    v_accvgpr_write_b32 a230, v46
    v_accvgpr_write_b32 a231, v47
    v_fmamk_f32 v40, v38, 0x41800000, v39
    v_fmamk_f32 v41, v38, 0x41880000, v39
    v_fmamk_f32 v42, v38, 0x41900000, v39
    v_fmamk_f32 v43, v38, 0x41980000, v39
    v_cos_f32 v44, v40
    v_sin_f32 v48, v40
    v_cos_f32 v45, v41
    v_sin_f32 v49, v41
    v_cos_f32 v46, v42
    v_sin_f32 v50, v42
    s_bfm_b64 exec, 48, 0
    s_add_u32 s86, s89, 1
    s_and_b32 s86, s86, 7
    s_mul_i32 s87, s86, 12288
    s_mul_i32 s88, s86, 176128
    s_add_u32 s87, s87, s80
    s_add_u32 s88, s88, s85
    s_add_u32 m0, s87, 0
    s_add_u32 s86, s88, 0
    buffer_load_dwordx4 v170, s[8:11], s86 offen lds
    s_mov_b64 exec, -1
    v_cos_f32 v47, v43
    v_sin_f32 v51, v43
    v_cvt_pk_bf16_f32 v44, v44, v48
    v_cvt_pk_bf16_f32 v45, v45, v49
    v_cvt_pk_bf16_f32 v46, v46, v50
    v_cvt_pk_bf16_f32 v47, v47, v51
    v_accvgpr_write_b32 a232, v44
    v_accvgpr_write_b32 a233, v45
    v_accvgpr_write_b32 a234, v46
    v_accvgpr_write_b32 a235, v47
    v_fmamk_f32 v40, v38, 0x41c00000, v39
    v_fmamk_f32 v41, v38, 0x41c80000, v39
    v_fmamk_f32 v42, v38, 0x41d00000, v39
    v_fmamk_f32 v43, v38, 0x41d80000, v39
    v_cos_f32 v44, v40
    v_sin_f32 v48, v40
    v_cos_f32 v45, v41
    v_sin_f32 v49, v41
    v_cos_f32 v46, v42
    v_sin_f32 v50, v42
    s_bfm_b64 exec, 48, 0
    s_add_u32 m0, s87, 768
    s_add_u32 s86, s88, 22016
    buffer_load_dwordx4 v170, s[8:11], s86 offen lds
    s_mov_b64 exec, -1
    v_cos_f32 v47, v43
    v_sin_f32 v51, v43
    v_cvt_pk_bf16_f32 v44, v44, v48
    v_cvt_pk_bf16_f32 v45, v45, v49
    v_cvt_pk_bf16_f32 v46, v46, v50
    v_cvt_pk_bf16_f32 v47, v47, v51
    v_accvgpr_write_b32 a236, v44
    v_accvgpr_write_b32 a237, v45
    v_accvgpr_write_b32 a238, v46
    v_accvgpr_write_b32 a239, v47
    v_dot2c_f32_bf16 v182, s43, v96
    v_dot2c_f32_bf16 v183, v96, v96
    v_dot2c_f32_bf16 v182, s43, v97
    v_dot2c_f32_bf16 v183, v97, v97
    v_dot2c_f32_bf16 v182, s43, v98
    v_dot2c_f32_bf16 v183, v98, v98
    v_dot2c_f32_bf16 v182, s43, v99
    v_dot2c_f32_bf16 v183, v99, v99
    v_dot2c_f32_bf16 v182, s43, v100
    v_dot2c_f32_bf16 v183, v100, v100
    v_dot2c_f32_bf16 v182, s43, v101
    v_dot2c_f32_bf16 v183, v101, v101
    v_dot2c_f32_bf16 v182, s43, v102
    v_dot2c_f32_bf16 v183, v102, v102
    v_dot2c_f32_bf16 v182, s43, v103
    v_dot2c_f32_bf16 v183, v103, v103
    v_dot2c_f32_bf16 v182, s43, v104
    v_dot2c_f32_bf16 v183, v104, v104
    s_bfm_b64 exec, 48, 0
    s_add_u32 m0, s87, 1536
    s_add_u32 s86, s88, 0
    buffer_load_dwordx4 v170, s[12:15], s86 offen lds
    s_mov_b64 exec, -1
    v_dot2c_f32_bf16 v182, s43, v105
    v_dot2c_f32_bf16 v183, v105, v105
    v_dot2c_f32_bf16 v182, s43, v106
    v_dot2c_f32_bf16 v183, v106, v106
    v_dot2c_f32_bf16 v182, s43, v107
    v_dot2c_f32_bf16 v183, v107, v107
    v_dot2c_f32_bf16 v182, s43, v108
    v_dot2c_f32_bf16 v183, v108, v108
    v_dot2c_f32_bf16 v182, s43, v109
    v_dot2c_f32_bf16 v183, v109, v109
    v_dot2c_f32_bf16 v182, s43, v110
    v_dot2c_f32_bf16 v183, v110, v110
    v_dot2c_f32_bf16 v182, s43, v111
    v_dot2c_f32_bf16 v183, v111, v111
    v_dot2c_f32_bf16 v182, s43, v112
    v_dot2c_f32_bf16 v183, v112, v112
    v_dot2c_f32_bf16 v182, s43, v113
    v_dot2c_f32_bf16 v183, v113, v113
    v_dot2c_f32_bf16 v182, s43, v114
    v_dot2c_f32_bf16 v183, v114, v114
    v_dot2c_f32_bf16 v182, s43, v115
    v_dot2c_f32_bf16 v183, v115, v115
    v_dot2c_f32_bf16 v182, s43, v116
    v_dot2c_f32_bf16 v183, v116, v116
    v_dot2c_f32_bf16 v182, s43, v117
    v_dot2c_f32_bf16 v183, v117, v117
    v_dot2c_f32_bf16 v182, s43, v118
    v_dot2c_f32_bf16 v183, v118, v118
    v_dot2c_f32_bf16 v182, s43, v119
    v_dot2c_f32_bf16 v183, v119, v119
    s_bfm_b64 exec, 48, 0
    s_add_u32 m0, s87, 2304
    s_add_u32 s86, s88, 22016
    buffer_load_dwordx4 v170, s[12:15], s86 offen lds
    s_mov_b64 exec, -1
    v_dot2c_f32_bf16 v182, s43, v120
    v_dot2c_f32_bf16 v183, v120, v120
    v_dot2c_f32_bf16 v182, s43, v121
    v_dot2c_f32_bf16 v183, v121, v121
    v_dot2c_f32_bf16 v182, s43, v122
    v_dot2c_f32_bf16 v183, v122, v122
    v_dot2c_f32_bf16 v182, s43, v123
    v_dot2c_f32_bf16 v183, v123, v123
    v_dot2c_f32_bf16 v182, s43, v124
    v_dot2c_f32_bf16 v183, v124, v124
    v_dot2c_f32_bf16 v182, s43, v125
    v_dot2c_f32_bf16 v183, v125, v125
    v_dot2c_f32_bf16 v182, s43, v126
    v_dot2c_f32_bf16 v183, v126, v126
    v_dot2c_f32_bf16 v182, s43, v127
    v_dot2c_f32_bf16 v183, v127, v127
    s_waitcnt lgkmcnt(0)
    s_barrier
    s_mov_b32 m0, s82
    s_nop 0
    buffer_load_dwordx4 v171, s[16:19], s83 offen lds
    s_add_u32 m0, s82, 1024
    s_nop 0
    buffer_load_dwordx4 v171, s[16:19], s84 offen lds
    s_bfm_b64 exec, 48, 0
    s_add_u32 s86, s89, 2
    s_and_b32 s86, s86, 7
    s_mul_i32 s87, s86, 12288
    s_mul_i32 s88, s86, 176128
    s_add_u32 s87, s87, s80
    s_add_u32 s88, s88, s85
    s_add_u32 m0, s87, 0
    s_add_u32 s86, s88, 0
    buffer_load_dwordx4 v170, s[8:11], s86 offen lds
    s_mov_b64 exec, -1
    v_mfma_f32_32x32x16_bf16 v[32:47], v[96:99], v[184:187], 0
    ds_write_b64 v173, v[180:181]
    s_add_u32 s56, s32, s41
    s_add_u32 s56, s56, 8
    v_mov_b32 v174, s56
    v_mov_b32 v175, s33
    v_subrev_u32 v171, 4096, v249
    v_mfma_f32_32x32x16_bf16 v[48:63], v[96:99], v[216:219], 0
    ds_write_b64 v173, v[182:183] offset:2048
    s_bfm_b64 exec, 48, 0
    s_add_u32 m0, s87, 768
    s_add_u32 s86, s88, 22016
    buffer_load_dwordx4 v170, s[8:11], s86 offen lds
    s_mov_b64 exec, -1
    v_mfma_f32_32x32x16_bf16 v[32:47], v[100:103], v[188:191], v[32:47]
    ds_write_b128 v177, v[8:11] offset:0
    buffer_store_dwordx2 v[174:175], v171, s[24:27], 0 offen sc1
    s_lshl_b32 s57, s38, 5
    s_add_u32 s58, s57, s39
    s_lshl_b32 s58, s58, 3
    s_add_u32 s58, s58, 12288
    v_mfma_f32_32x32x16_bf16 v[48:63], v[100:103], v[220:223], v[48:63]
    ds_write_b128 v177, v[12:15] offset:1024
    s_add_u32 s56, s32, 1
    v_mov_b32 v174, s56
    v_and_b32 v171, 1073741824, v249
    v_mfma_f32_32x32x16_bf16 v[32:47], v[104:107], v[192:195], v[32:47]
    ds_write_b128 v178, v[16:19] offset:0
    v_mfma_f32_32x32x16_bf16 v[48:63], v[104:107], v[224:227], v[48:63]
    ds_write_b128 v178, v[20:23] offset:1024
    s_bfm_b64 exec, 48, 0
    s_add_u32 m0, s87, 1536
    s_add_u32 s86, s88, 0
    buffer_load_dwordx4 v170, s[12:15], s86 offen lds
    s_mov_b64 exec, -1
    v_mfma_f32_32x32x16_bf16 v[48:63], v[108:111], v[228:231], v[48:63]
    ds_write_b128 v179, v[24:27] offset:0
    v_mfma_f32_32x32x16_bf16 v[48:63], v[112:115], v[232:235], v[48:63]
    ds_write_b128 v179, v[28:31] offset:1024
    v_mfma_f32_32x32x16_bf16 v[48:63], v[116:119], v[236:239], v[48:63]
    v_mfma_f32_32x32x16_bf16 v[48:63], v[120:123], v[240:243], v[48:63]
    s_bfm_b64 exec, 48, 0
    s_add_u32 m0, s87, 2304
    s_add_u32 s86, s88, 22016
    buffer_load_dwordx4 v170, s[12:15], s86 offen lds
    s_mov_b64 exec, -1
    v_mfma_f32_32x32x16_bf16 v[48:63], v[124:127], v[244:247], v[48:63]
    s_waitcnt lgkmcnt(0)
    s_barrier
    buffer_store_dwordx2 v[174:175], v171, s[24:27], s58 offen sc1
    ds_read_b128 v[64:67], v172 offset:0
    ds_read_b128 v[68:71], v172 offset:16
    ds_read_b128 v[72:75], v172 offset:32
    v_mfma_f32_32x32x16_bf16 v[32:47], v[108:111], v[196:199], v[32:47]
    ds_read_b128 v[76:79], v172 offset:48
    ds_read_b128 v[16:19], v176 offset:2048
    ds_read_b128 v[20:23], v176 offset:3072
    ds_read_b128 v[24:27], v176 offset:4096
    ds_read_b128 v[28:31], v176 offset:5120
    ds_read_b128 v[8:11], v176 offset:0
    v_mfma_f32_32x32x16_bf16 v[32:47], v[112:115], v[200:203], v[32:47]
    ds_read_b128 v[12:15], v176 offset:1024
    s_waitcnt lgkmcnt(9)
    v_add_f32 v64, v64, v66
    v_add_f32 v65, v65, v67
    s_waitcnt lgkmcnt(8)
    v_add_f32 v64, v64, v68
    v_add_f32 v65, v65, v69
    v_add_f32 v64, v64, v70
    v_mfma_f32_32x32x16_bf16 v[32:47], v[116:119], v[204:207], v[32:47]
    s_bfm_b64 exec, 48, 0
    s_add_u32 s86, s89, 3
    s_and_b32 s86, s86, 7
    s_mul_i32 s87, s86, 12288
    s_mul_i32 s88, s86, 176128
    s_add_u32 s87, s87, s80
    s_add_u32 s88, s88, s85
    s_add_u32 m0, s87, 0
    s_add_u32 s86, s88, 0
    buffer_load_dwordx4 v170, s[8:11], s86 offen lds
    s_mov_b64 exec, -1
    ds_write_b128 v178, v[48:51] offset:24576
    v_mfma_f32_32x32x16_bf16 v[32:47], v[120:123], v[208:211], v[32:47]
    ds_write_b128 v178, v[52:55] offset:25600
    v_add_f32 v65, v65, v71
    s_waitcnt lgkmcnt(9)
    v_add_f32 v64, v64, v72
    v_add_f32 v65, v65, v73
    v_add_f32 v64, v64, v74
    v_add_f32 v65, v65, v75
    v_mfma_f32_32x32x16_bf16 v[32:47], v[124:127], v[212:215], v[32:47]
    ds_write_b128 v179, v[56:59] offset:24576
    s_waitcnt lgkmcnt(9)
    v_add_f32 v64, v64, v76
    v_add_f32 v65, v65, v77
    v_add_f32 v64, v64, v78
    v_add_f32 v65, v65, v79
    v_mul_f32 v64, s45, v64
    ds_write_b128 v179, v[60:63] offset:25600
    v_mul_f32 v66, v64, v64
    v_fma_f32 v65, v65, s45, -v66
    v_max_f32 v65, 0, v65
    v_add_f32 v65, 0x3727c5ac, v65
    v_rsq_f32 v65, v65
    s_lshl_b32 s69, s34, 7
    s_add_u32 s69, s69, 151552
    v_and_b32 v66, 15, v254
    v_lshl_add_u32 v67, v253, 4, s69
    v_lshl_add_u32 v66, v66, 2, s69
    ds_write_b32 v66, v65
    ds_read_b128 v[80:83], v67 offset:0
    ds_read_b128 v[84:87], v67 offset:32
    s_bfm_b64 exec, 48, 0
    s_add_u32 m0, s87, 768
    s_add_u32 s86, s88, 22016
    buffer_load_dwordx4 v170, s[8:11], s86 offen lds
    s_mov_b64 exec, -1
    ds_write_b128 v177, v[40:43] offset:24576
    s_waitcnt lgkmcnt(9)
    v_add_f32 v0, v0, v8
    v_add_f32 v1, v1, v9
    v_add_f32 v2, v2, v10
    v_add_f32 v3, v3, v11
    s_waitcnt lgkmcnt(8)
    v_add_f32 v4, v4, v12
    v_add_f32 v5, v5, v13
    v_add_f32 v6, v6, v14
    v_add_f32 v7, v7, v15
    v_add_f32 v0, v0, v16
    v_add_f32 v1, v1, v17
    v_add_f32 v2, v2, v18
    v_add_f32 v3, v3, v19
    v_add_f32 v4, v4, v20
    v_add_f32 v5, v5, v21
    ds_write_b128 v177, v[44:47] offset:25600
    v_add_f32 v6, v6, v22
    v_add_f32 v7, v7, v23
    v_add_f32 v0, v0, v24
    v_add_f32 v1, v1, v25
    v_add_f32 v2, v2, v26
    v_add_f32 v3, v3, v27
    v_add_f32 v4, v4, v28
    v_add_f32 v5, v5, v29
    v_add_f32 v6, v6, v30
    v_add_f32 v7, v7, v31
    s_waitcnt lgkmcnt(3)
    v_mul_f32 v0, v0, v80
    v_mul_f32 v1, v1, v81
    v_mul_f32 v2, v2, v82
    v_mul_f32 v3, v3, v83
    s_bfm_b64 exec, 48, 0
    s_add_u32 m0, s87, 1536
    s_add_u32 s86, s88, 0
    buffer_load_dwordx4 v170, s[12:15], s86 offen lds
    s_mov_b64 exec, -1
    s_waitcnt lgkmcnt(2)
    v_mul_f32 v4, v4, v84
    v_mul_f32 v5, v5, v85
    v_mul_f32 v6, v6, v86
    v_mul_f32 v7, v7, v87
    v_cvt_pk_bf16_f32 v8, v0, v1
    v_cvt_pk_bf16_f32 v9, v2, v3
    v_cvt_pk_bf16_f32 v10, v4, v5
    v_cvt_pk_bf16_f32 v11, v6, v7
    ds_write_b128 v168, v[8:11] offset:0
    ds_read_b128 v[64:67], v172 offset:2048
    ds_read_b128 v[68:71], v172 offset:2064
    ds_read_b128 v[72:75], v172 offset:2080
    ds_read_b128 v[76:79], v172 offset:2096
    s_waitcnt lgkmcnt(3)
    v_add_f32 v64, v64, v66
    v_add_f32 v65, v65, v67
    s_waitcnt lgkmcnt(2)
    v_add_f32 v64, v64, v68
    v_add_f32 v65, v65, v69
    s_bfm_b64 exec, 48, 0
    s_add_u32 m0, s87, 2304
    s_add_u32 s86, s88, 22016
    buffer_load_dwordx4 v170, s[12:15], s86 offen lds
    s_mov_b64 exec, -1
    v_add_f32 v64, v64, v70
    v_add_f32 v65, v65, v71
    s_waitcnt lgkmcnt(1)
    v_add_f32 v64, v64, v72
    v_add_f32 v65, v65, v73
    v_add_f32 v64, v64, v74
    v_add_f32 v65, v65, v75
    s_waitcnt lgkmcnt(0)
    v_add_f32 v64, v64, v76
    v_add_f32 v65, v65, v77
    v_add_f32 v64, v64, v78
    v_add_f32 v65, v65, v79
    v_mul_f32 v64, s45, v64
    v_mul_f32 v66, v64, v64
    v_fma_f32 v65, v65, s45, -v66
    v_max_f32 v65, 0, v65
    v_add_f32 v65, 0x3727c5ac, v65
    v_rsq_f32 v65, v65
    s_lshl_b32 s69, s34, 7
    s_add_u32 s69, s69, 151616
    v_and_b32 v66, 15, v254
    v_lshl_add_u32 v67, v253, 4, s69
    v_lshl_add_u32 v66, v66, 2, s69
    ds_write_b32 v66, v65
    ds_read_b128 v[88:91], v67 offset:0
    ds_read_b128 v[92:95], v67 offset:32
    s_waitcnt lgkmcnt(0)
    s_barrier
    ds_read_b128 v[48:51], v176 offset:26624
    ds_read_b128 v[52:55], v176 offset:27648
    s_bfm_b64 exec, 48, 0
    s_add_u32 s86, s89, 4
    s_and_b32 s86, s86, 7
    s_mul_i32 s87, s86, 12288
    s_mul_i32 s88, s86, 176128
    s_add_u32 s87, s87, s80
    s_add_u32 s88, s88, s85
    s_add_u32 m0, s87, 0
    s_add_u32 s86, s88, 0
    buffer_load_dwordx4 v170, s[8:11], s86 offen lds
    s_mov_b64 exec, -1
    ds_read_b128 v[56:59], v176 offset:28672
    ds_read_b128 v[60:63], v176 offset:29696
    ds_read_b128 v[40:43], v176 offset:24576
    ds_read_b128 v[44:47], v176 offset:25600
    ds_read_b128 v[64:67], v169 offset:0
    ds_read_b128 v[68:71], v169 offset:1024
    ds_read_b128 v[72:75], v169 offset:2048
    ds_read_b128 v[76:79], v169 offset:3072
    s_bfm_b64 exec, 48, 0
    s_add_u32 m0, s87, 768
    s_add_u32 s86, s88, 22016
    buffer_load_dwordx4 v170, s[8:11], s86 offen lds
    s_mov_b64 exec, -1
    s_waitcnt lgkmcnt(5)
    v_add_f32 v32, v32, v40
    v_add_f32 v33, v33, v41
    v_add_f32 v34, v34, v42
    v_add_f32 v35, v35, v43
    s_waitcnt lgkmcnt(4)
    v_add_f32 v36, v36, v44
    v_add_f32 v37, v37, v45
    v_add_f32 v38, v38, v46
    v_add_f32 v39, v39, v47
    v_add_f32 v32, v32, v48
    v_add_f32 v33, v33, v49
    v_add_f32 v34, v34, v50
    v_add_f32 v35, v35, v51
    v_add_f32 v36, v36, v52
    v_add_f32 v37, v37, v53
    v_add_f32 v38, v38, v54
    v_add_f32 v39, v39, v55
    s_waitcnt lgkmcnt(3)
    v_mfma_f32_32x32x16_bf16 v[0:15], v[128:131], v[64:67], 0
    v_add_f32 v32, v32, v56
    v_add_f32 v33, v33, v57
    v_add_f32 v34, v34, v58
    v_add_f32 v35, v35, v59
    v_add_f32 v36, v36, v60
    v_add_f32 v37, v37, v61
    s_waitcnt lgkmcnt(2)
    v_mfma_f32_32x32x16_bf16 v[0:15], v[132:135], v[68:71], v[0:15]
    v_add_f32 v38, v38, v62
    v_add_f32 v39, v39, v63
    v_mul_f32 v32, v32, v88
    v_mul_f32 v33, v33, v89
    v_mul_f32 v34, v34, v90
    v_mul_f32 v35, v35, v91
    s_waitcnt lgkmcnt(1)
    v_mfma_f32_32x32x16_bf16 v[0:15], v[136:139], v[72:75], v[0:15]
    v_mul_f32 v36, v36, v92
    v_mul_f32 v37, v37, v93
    v_mul_f32 v38, v38, v94
    v_mul_f32 v39, v39, v95
    v_cvt_pk_bf16_f32 v40, v32, v33
    v_cvt_pk_bf16_f32 v41, v34, v35
    s_bfm_b64 exec, 48, 0
    s_add_u32 m0, s87, 1536
    s_add_u32 s86, s88, 0
    buffer_load_dwordx4 v170, s[12:15], s86 offen lds
    s_mov_b64 exec, -1
    s_waitcnt lgkmcnt(0)
    v_mfma_f32_32x32x16_bf16 v[0:15], v[140:143], v[76:79], v[0:15]
    v_cvt_pk_bf16_f32 v42, v36, v37
    v_cvt_pk_bf16_f32 v43, v38, v39
    ds_write_b128 v168, v[40:43] offset:4096
    s_bfm_b64 exec, 48, 0
    s_add_u32 m0, s87, 2304
    s_add_u32 s86, s88, 22016
    buffer_load_dwordx4 v170, s[12:15], s86 offen lds
    s_mov_b64 exec, -1
    v_lshlrev_b32 v168, 2, v254
    v_lshl_add_u32 v168, v253, 16, v168
    s_add_u32 s57, s47, 12582912
    s_waitcnt lgkmcnt(0)
    s_barrier
    ds_read_b128 v[80:83], v169 offset:4096
    ds_read_b128 v[84:87], v169 offset:5120
    ds_read_b128 v[88:91], v169 offset:6144
    ds_read_b128 v[92:95], v169 offset:7168
    s_waitcnt lgkmcnt(3)
    v_mfma_f32_32x32x16_bf16 v[0:15], v[144:147], v[80:83], v[0:15]
    s_waitcnt lgkmcnt(2)
    v_mfma_f32_32x32x16_bf16 v[0:15], v[148:151], v[84:87], v[0:15]
    s_waitcnt lgkmcnt(1)
    v_mfma_f32_32x32x16_bf16 v[0:15], v[152:155], v[88:91], v[0:15]
    s_waitcnt lgkmcnt(0)
    v_mfma_f32_32x32x16_bf16 v[0:15], v[156:159], v[92:95], v[0:15]
    s_add_u32 s58, s57, 0
    s_nop 10
    v_cvt_pk_bf16_f32 v16, v0, v1
    buffer_store_dword v16, v168, s[24:27], s58 offen sc1
    s_add_u32 s58, s57, 32768
    v_cvt_pk_bf16_f32 v17, v2, v3
    buffer_store_dword v17, v168, s[24:27], s58 offen sc1
    s_add_u32 s58, s57, 131072
    v_cvt_pk_bf16_f32 v18, v4, v5
    buffer_store_dword v18, v168, s[24:27], s58 offen sc1
    s_add_u32 s58, s57, 163840
    v_cvt_pk_bf16_f32 v19, v6, v7
    buffer_store_dword v19, v168, s[24:27], s58 offen sc1
    s_add_u32 s58, s57, 262144
    v_cvt_pk_bf16_f32 v20, v8, v9
    buffer_store_dword v20, v168, s[24:27], s58 offen sc1
    s_add_u32 s58, s57, 294912
    v_cvt_pk_bf16_f32 v21, v10, v11
    buffer_store_dword v21, v168, s[24:27], s58 offen sc1
    s_add_u32 s58, s57, 393216
    v_cvt_pk_bf16_f32 v22, v12, v13
    buffer_store_dword v22, v168, s[24:27], s58 offen sc1
    s_add_u32 s58, s57, 425984
    v_cvt_pk_bf16_f32 v23, v14, v15
    buffer_store_dword v23, v168, s[24:27], s58 offen sc1
    s_sub_u32 s66, s46, 4096
    v_lshl_add_u32 v104, v254, 3, s66
    s_lshl_b32 s67, s38, 5
    v_add_u32 v105, s67, v248
    v_and_b32 v105, 255, v105
    v_lshlrev_b32 v105, 3, v105
    v_add_u32 v105, 12288, v105
    buffer_load_dwordx2 v[106:107], v104, s[24:27], 0 offen sc1
    buffer_load_dwordx2 v[108:109], v105, s[24:27], 0 offen sc1
    s_barrier
    s_bfm_b64 exec, 48, 0
    s_add_u32 s86, s89, 5
    s_and_b32 s86, s86, 7
    s_mul_i32 s87, s86, 12288
    s_mul_i32 s88, s86, 176128
    s_add_u32 s87, s87, s80
    s_add_u32 s88, s88, s85
    s_add_u32 m0, s87, 0
    s_add_u32 s86, s88, 0
    buffer_load_dwordx4 v170, s[8:11], s86 offen lds
    s_add_u32 m0, s87, 768
    s_add_u32 s86, s88, 22016
    buffer_load_dwordx4 v170, s[8:11], s86 offen lds
    s_add_u32 m0, s87, 1536
    s_add_u32 s86, s88, 0
    buffer_load_dwordx4 v170, s[12:15], s86 offen lds
    s_add_u32 m0, s87, 2304
    s_add_u32 s86, s88, 22016
    buffer_load_dwordx4 v170, s[12:15], s86 offen lds
    s_mov_b64 exec, -1
    v_accvgpr_write_b32 a176, v128
    v_accvgpr_write_b32 a177, v129
    v_accvgpr_write_b32 a178, v130
    v_accvgpr_write_b32 a179, v131
    v_accvgpr_write_b32 a180, v132
    v_accvgpr_write_b32 a181, v133
    v_accvgpr_write_b32 a182, v134
    v_accvgpr_write_b32 a183, v135
    v_accvgpr_write_b32 a184, v136
    v_accvgpr_write_b32 a185, v137
    v_accvgpr_write_b32 a186, v138
    v_accvgpr_write_b32 a187, v139
    v_accvgpr_write_b32 a188, v140
    v_accvgpr_write_b32 a189, v141
    v_accvgpr_write_b32 a190, v142
    v_accvgpr_write_b32 a191, v143
    v_accvgpr_write_b32 a192, v144
    v_accvgpr_write_b32 a193, v145
    v_accvgpr_write_b32 a194, v146
    v_accvgpr_write_b32 a195, v147
    v_accvgpr_write_b32 a196, v148
    v_accvgpr_write_b32 a197, v149
    v_accvgpr_write_b32 a198, v150
    v_accvgpr_write_b32 a199, v151
    v_accvgpr_write_b32 a200, v152
    v_accvgpr_write_b32 a201, v153
    v_accvgpr_write_b32 a202, v154
    v_accvgpr_write_b32 a203, v155
    v_accvgpr_write_b32 a204, v156
    v_accvgpr_write_b32 a205, v157
    v_accvgpr_write_b32 a206, v158
    v_accvgpr_write_b32 a207, v159
    s_and_b32 s56, s34, 1
    s_lshl_b32 s56, s56, 8
    v_xor_b32 v150, s56, v255
    s_and_b32 s56, s34, 1
    s_lshl_b32 s57, s56, 5
    s_add_u32 s48, s39, s57
    s_lshr_b32 s63, s34, 1
    s_sub_u32 s58, 15, s38
    s_sub_u32 s59, 64, s48
    s_and_b32 s59, s59, 63
    s_cmp_lg_u32 s63, 0
    s_cselect_b32 s49, s58, s38
    s_cselect_b32 s59, s59, s48
    s_cselect_b64 vcc, -1, 0
    s_lshl_b32 s50, s59, 15
    s_add_u32 s50, s50, 12582912
    s_add_u32 s51, s44, s56
    v_lshrrev_b32 v2, 4, v254
    v_bfe_u32 v3, v254, 2, 1
    v_bfe_u32 v4, v254, 3, 1
    v_and_b32 v5, 3, v254
    v_lshl_add_u32 v5, v2, 4, v5
    v_lshl_add_u32 v5, v3, 3, v5
    v_lshl_add_u32 v5, v4, 2, v5
    s_lshl_b32 s61, s49, 5
    v_add_u32 v5, s61, v5
    v_sub_u32 v6, 512, v5
    v_and_b32 v6, 255, v6
    v_cndmask_b32 v6, v5, v6, vcc
    v_lshlrev_b32 v6, 2, v6
    v_lshl_add_u32 v6, v253, 12, v6
    v_cmp_eq_u32 vcc, 0, v5
    v_mov_b32 v7, 1073741824
    s_nop 0
    v_cndmask_b32 v168, v6, v7, vcc
    s_lshl_b32 s52, s51, 15
    s_lshl_b32 s62, s49, 11
    s_add_u32 s52, s52, s62
    v_bfe_u32 v8, v248, 2, 2
    v_lshl_add_u32 v8, v253, 3, v8
    v_mul_u32_u24 v8, 96, v8
    v_bfe_u32 v9, v248, 4, 1
    v_mul_u32_u24 v9, 1536, v9
    v_and_b32 v10, 3, v248
    v_lshl_add_u32 v8, v10, 3, v8
    v_add3_u32 v8, v8, v9, s80
    v_add_u32 v10, s80, v255
    v_mov_b32 v12, s43
    v_mov_b32 v13, s43
    v_mov_b32 v14, s43
    v_mov_b32 v15, s43
    s_add_u32 s56, s89, 0
    s_and_b32 s56, s56, 7
    s_mul_i32 s56, s56, 12288
    v_add_u32 v9, s56, v8
    v_add_u32 v16, s56, v10
    s_waitcnt vmcnt(34)
    ds_read_b64_tr_b16 v[80:81], v9 offset:0
    ds_read_b64_tr_b16 v[82:83], v9 offset:384
    ds_read_b64_tr_b16 v[84:85], v9 offset:32
    ds_read_b64_tr_b16 v[86:87], v9 offset:416
    ds_read_b64_tr_b16 v[88:89], v9 offset:64
    ds_read_b64_tr_b16 v[90:91], v9 offset:448
    s_waitcnt lgkmcnt(0)
    s_add_u32 s56, s89, 1
    s_and_b32 s56, s56, 7
    s_mul_i32 s56, s56, 12288
    v_add_u32 v9, s56, v8
    v_add_u32 v17, s56, v10
    s_waitcnt vmcnt(30)
    ds_read_b64_tr_b16 v[92:93], v9 offset:0
    ds_read_b64_tr_b16 v[94:95], v9 offset:384
    ds_read_b64_tr_b16 v[96:97], v9 offset:32
    ds_read_b64_tr_b16 v[98:99], v9 offset:416
    ds_read_b64_tr_b16 v[100:101], v9 offset:64
    ds_read_b64_tr_b16 v[102:103], v9 offset:448
    ds_write_b128 v16, v[80:83] offset:0
    v_mfma_f32_32x32x16_bf16 v[32:47], v[12:15], v[80:83], 0
    ds_write_b128 v16, v[84:87] offset:1024
    v_mfma_f32_32x32x16_bf16 v[48:63], v[12:15], v[84:87], 0
    ds_write_b128 v16, v[88:91] offset:2048
    v_mfma_f32_32x32x16_bf16 v[64:79], v[12:15], v[88:91], 0
    s_waitcnt lgkmcnt(0)
    ds_write_b128 v17, v[92:95] offset:0
    v_mfma_f32_32x32x16_bf16 v[32:47], v[12:15], v[92:95], v[32:47]
    ds_write_b128 v17, v[96:99] offset:1024
    v_mfma_f32_32x32x16_bf16 v[48:63], v[12:15], v[96:99], v[48:63]
    ds_write_b128 v17, v[100:103] offset:2048
    v_mfma_f32_32x32x16_bf16 v[64:79], v[12:15], v[100:103], v[64:79]
    s_mov_b32 s74, 0
    s_add_u32 s56, s32, 8
    s_add_u32 s57, s32, 1
    s_waitcnt vmcnt(5)
    v_subrev_u32 v110, s56, v106
    s_waitcnt vmcnt(4)
    v_xor_b32 v111, s57, v108
    v_lshrrev_b32 v110, 3, v110
    v_xor_b32 v112, s33, v107
    v_xor_b32 v113, s33, v109
    v_or3_b32 v110, v110, v111, v112
    v_or_b32 v110, v110, v113
    v_cmp_ne_u32 vcc, 0, v110
    s_nop 0
    s_cbranch_vccnz L_flags_retry
L_flags_ok:
    s_add_u32 s56, s56, s41
    v_cmp_ne_u32 vcc, s56, v106
    s_nop 0
    s_cmp_lg_u64 vcc, 0
    s_cselect_b32 s40, 1, 0
    s_add_u32 s56, s50, 0
    buffer_load_dword v184, v168, s[24:27], s56 offen offset:0 sc1
    buffer_load_dword v185, v168, s[24:27], s56 offen offset:1024 sc1
    buffer_load_dword v186, v168, s[24:27], s56 offen offset:2048 sc1
    buffer_load_dword v187, v168, s[24:27], s56 offen offset:3072 sc1
    s_add_u32 s56, s50, 8192
    buffer_load_dword v188, v168, s[24:27], s56 offen offset:0 sc1
    buffer_load_dword v189, v168, s[24:27], s56 offen offset:1024 sc1
    buffer_load_dword v190, v168, s[24:27], s56 offen offset:2048 sc1
    buffer_load_dword v191, v168, s[24:27], s56 offen offset:3072 sc1
    s_add_u32 s56, s50, 16384
    buffer_load_dword v192, v168, s[24:27], s56 offen offset:0 sc1
    buffer_load_dword v193, v168, s[24:27], s56 offen offset:1024 sc1
    buffer_load_dword v194, v168, s[24:27], s56 offen offset:2048 sc1
    buffer_load_dword v195, v168, s[24:27], s56 offen offset:3072 sc1
    s_add_u32 s56, s50, 24576
    buffer_load_dword v196, v168, s[24:27], s56 offen offset:0 sc1
    buffer_load_dword v197, v168, s[24:27], s56 offen offset:1024 sc1
    buffer_load_dword v198, v168, s[24:27], s56 offen offset:2048 sc1
    buffer_load_dword v199, v168, s[24:27], s56 offen offset:3072 sc1
    v_bfe_u32 v3, v248, 2, 2
    v_lshl_add_u32 v3, v253, 2, v3
    v_lshlrev_b32 v3, 7, v3
    v_bfe_u32 v4, v248, 4, 1
    v_lshl_add_u32 v3, v4, 5, v3
    v_and_b32 v4, 1, v248
    v_lshl_add_u32 v3, v4, 4, v3
    v_bfe_u32 v4, v248, 1, 1
    v_lshl_add_u32 v3, v4, 3, v3
    v_add_u32 v208, s82, v3
    ds_read_b64_tr_b16 v[200:201], v208 offset:0
    ds_read_b64_tr_b16 v[202:203], v208 offset:1024
    ds_read_b64_tr_b16 v[204:205], v208 offset:64
    ds_read_b64_tr_b16 v[206:207], v208 offset:1088
    v_lshrrev_b32 v214, 3, v248
    v_and_b32 v215, 7, v248
    v_lshlrev_b32 v214, 15, v214
    v_lshl_add_u32 v214, v215, 4, v214
    v_mov_b32 v210, -1
    v_mov_b32 v211, -1
    v_mov_b32 v212, -1
    v_mov_b32 v213, -1
    s_add_u32 s58, s47, 14680064
    buffer_store_dwordx4 v[210:213], v214, s[24:27], s58 offen sc1
    s_add_u32 s58, s47, 14942208
    buffer_store_dwordx4 v[210:213], v214, s[24:27], s58 offen sc1
    s_lshl_b32 s56, s38, 7
    s_add_u32 s56, s56, s81
    s_lshl_b32 s56, s56, 11
    s_add_u32 s56, s56, 16777216
    s_waitcnt lgkmcnt(2)
    buffer_store_dwordx4 v[200:203], v255, s[24:27], s56 offen offset:0 sc1
    s_waitcnt lgkmcnt(0)
    buffer_store_dwordx4 v[204:207], v255, s[24:27], s56 offen offset:1024 sc1
    v_bfe_u32 v8, v248, 2, 2
    v_lshl_add_u32 v8, v253, 3, v8
    v_mul_u32_u24 v8, 96, v8
    v_bfe_u32 v9, v248, 4, 1
    v_mul_u32_u24 v9, 1536, v9
    v_and_b32 v10, 3, v248
    v_lshl_add_u32 v8, v10, 3, v8
    v_add3_u32 v8, v8, v9, s80
    v_add_u32 v10, s80, v255
    v_mov_b32 v12, s43
    v_mov_b32 v13, s43
    v_mov_b32 v14, s43
    v_mov_b32 v15, s43
    s_add_u32 s56, s89, 2
    s_and_b32 s56, s56, 7
    s_mul_i32 s56, s56, 12288
    v_add_u32 v9, s56, v8
    v_add_u32 v16, s56, v10
    ds_read_b64_tr_b16 v[80:81], v9 offset:0
    ds_read_b64_tr_b16 v[82:83], v9 offset:384
    ds_read_b64_tr_b16 v[84:85], v9 offset:32
    ds_read_b64_tr_b16 v[86:87], v9 offset:416
    ds_read_b64_tr_b16 v[88:89], v9 offset:64
    ds_read_b64_tr_b16 v[90:91], v9 offset:448
    s_waitcnt lgkmcnt(0)
    s_add_u32 s56, s89, 3
    s_and_b32 s56, s56, 7
    s_mul_i32 s56, s56, 12288
    v_add_u32 v9, s56, v8
    v_add_u32 v17, s56, v10
    ds_read_b64_tr_b16 v[92:93], v9 offset:0
    ds_read_b64_tr_b16 v[94:95], v9 offset:384
    ds_read_b64_tr_b16 v[96:97], v9 offset:32
    ds_read_b64_tr_b16 v[98:99], v9 offset:416
    ds_read_b64_tr_b16 v[100:101], v9 offset:64
    ds_read_b64_tr_b16 v[102:103], v9 offset:448
    ds_write_b128 v16, v[80:83] offset:0
    v_mfma_f32_32x32x16_bf16 v[32:47], v[12:15], v[80:83], v[32:47]
    ds_write_b128 v16, v[84:87] offset:1024
    v_mfma_f32_32x32x16_bf16 v[48:63], v[12:15], v[84:87], v[48:63]
    ds_write_b128 v16, v[88:91] offset:2048
    v_mfma_f32_32x32x16_bf16 v[64:79], v[12:15], v[88:91], v[64:79]
    s_waitcnt lgkmcnt(0)
    ds_write_b128 v17, v[92:95] offset:0
    v_mfma_f32_32x32x16_bf16 v[32:47], v[12:15], v[92:95], v[32:47]
    ds_write_b128 v17, v[96:99] offset:1024
    v_mfma_f32_32x32x16_bf16 v[48:63], v[12:15], v[96:99], v[48:63]
    ds_write_b128 v17, v[100:103] offset:2048
    v_mfma_f32_32x32x16_bf16 v[64:79], v[12:15], v[100:103], v[64:79]
    v_lshlrev_b32 v0, 16, v160
    v_and_b32 v1, 0xffff0000, v160
    v_lshlrev_b32 v2, 16, v161
    v_and_b32 v3, 0xffff0000, v161
    v_lshlrev_b32 v4, 16, v162
    v_and_b32 v5, 0xffff0000, v162
    v_lshlrev_b32 v6, 16, v163
    v_and_b32 v7, 0xffff0000, v163
    v_lshlrev_b32 v8, 16, v164
    v_and_b32 v9, 0xffff0000, v164
    v_lshlrev_b32 v10, 16, v165
    v_and_b32 v11, 0xffff0000, v165
    v_lshlrev_b32 v12, 16, v166
    v_and_b32 v13, 0xffff0000, v166
    v_lshlrev_b32 v14, 16, v167
    v_and_b32 v15, 0xffff0000, v167
    s_lshl_b32 s57, s51, 12
    s_lshl_b32 s58, s38, 9
    s_add_u32 s57, s57, s58
    s_lshr_b32 s58, s34, 1
    s_lshl_b32 s58, s58, 3
    s_add_u32 s57, s57, s58
    s_add_u32 s57, s57, 5242880
    s_mov_b32 s74, 0
    s_waitcnt vmcnt(17)
    v_max3_u32 v16, v184, v185, v186
    s_waitcnt vmcnt(14)
    v_max3_u32 v17, v187, v188, v189
    s_waitcnt vmcnt(11)
    v_max3_u32 v18, v190, v191, v192
    s_waitcnt vmcnt(8)
    v_max3_u32 v19, v193, v194, v195
    s_waitcnt vmcnt(5)
    v_max3_u32 v20, v196, v197, v198
    v_max3_u32 v16, v16, v17, v18
    s_waitcnt vmcnt(4)
    v_max3_u32 v19, v19, v20, v199
    v_max_u32 v16, v16, v19
    v_cmp_eq_u32 vcc, -1, v16
    s_nop 0
    s_cbranch_vccnz L_z0_retry
L_z0_ok:
    s_add_u32 s56, s52, 1048576
    v_mfma_f32_32x32x16_bf16 v[0:15], v[184:187], a[224:227], v[0:15]
    v_mfma_f32_32x32x16_bf16 v[0:15], v[188:191], a[228:231], v[0:15]
    v_mfma_f32_32x32x16_bf16 v[0:15], v[192:195], a[232:235], v[0:15]
    v_mfma_f32_32x32x16_bf16 v[0:15], v[196:199], a[236:239], v[0:15]
    s_nop 11
    v_cvt_pk_bf16_f32 v16, v0, v1
    v_cvt_pk_bf16_f32 v17, v2, v3
    v_cvt_pk_bf16_f32 v18, v4, v5
    v_cvt_pk_bf16_f32 v19, v6, v7
    buffer_store_dwordx4 v[16:19], v255, s[24:27], s56 offen offset:0 sc1
    v_cvt_pk_bf16_f32 v20, v8, v9
    v_cvt_pk_bf16_f32 v21, v10, v11
    v_cvt_pk_bf16_f32 v22, v12, v13
    v_cvt_pk_bf16_f32 v23, v14, v15
    buffer_store_dwordx4 v[20:23], v255, s[24:27], s56 offen offset:1024 sc1
    v_pk_add_f32 v[24:25], v[0:1], v[2:3]
    v_pk_mul_f32 v[26:27], v[0:1], v[0:1]
    v_pk_fma_f32 v[26:27], v[2:3], v[2:3], v[26:27]
    v_pk_add_f32 v[24:25], v[24:25], v[4:5]
    v_pk_fma_f32 v[26:27], v[4:5], v[4:5], v[26:27]
    v_pk_add_f32 v[24:25], v[24:25], v[6:7]
    v_pk_fma_f32 v[26:27], v[6:7], v[6:7], v[26:27]
    v_pk_add_f32 v[24:25], v[24:25], v[8:9]
    v_pk_fma_f32 v[26:27], v[8:9], v[8:9], v[26:27]
    v_pk_add_f32 v[24:25], v[24:25], v[10:11]
    v_pk_fma_f32 v[26:27], v[10:11], v[10:11], v[26:27]
    v_pk_add_f32 v[24:25], v[24:25], v[12:13]
    v_pk_fma_f32 v[26:27], v[12:13], v[12:13], v[26:27]
    v_pk_add_f32 v[24:25], v[24:25], v[14:15]
    v_pk_fma_f32 v[26:27], v[14:15], v[14:15], v[26:27]
    v_add_f32 v24, v24, v25
    v_add_f32 v25, v26, v27
    v_mov_b32 v26, v24
    v_mov_b32 v27, v25
    v_lshlrev_b32 v28, 4, v254
    v_lshl_add_u32 v28, v253, 30, v28
    v_permlane32_swap_b32 v24, v26
    v_permlane32_swap_b32 v25, v27
    v_add_f32 v24, v24, v26
    v_add_f32 v25, v25, v27
    buffer_store_dwordx2 v[24:25], v28, s[24:27], s57 offen
    s_add_u32 s56, s32, 1
    v_mov_b32 v2, s56
    v_mov_b32 v3, s33
    s_cmp_lg_u32 s40, 0
    s_waitcnt vmcnt(0)
    s_barrier
    s_cbranch_scc1 L_interleave_layers__spectral_fnet__swiglu_ffn__prompt_pb_1_slow
    buffer_store_dwordx2 v[2:3], v249, s[24:27], 0 offen
L_interleave_layers__spectral_fnet__swiglu_ffn__prompt_pb_1_back:
    s_lshl_b32 s57, s38, 5
    s_add_u32 s57, s57, s39
    s_lshl_b32 s57, s57, 3
    s_add_u32 s57, s57, 16384
    v_and_b32 v4, 1073741824, v249
    buffer_store_dwordx2 v[2:3], v4, s[24:27], s57 offen sc1
    s_bfm_b64 exec, 48, 0
    s_add_u32 s86, s89, 6
    s_and_b32 s86, s86, 7
    s_mul_i32 s87, s86, 12288
    s_mul_i32 s88, s86, 176128
    s_add_u32 s87, s87, s80
    s_add_u32 s88, s88, s85
    s_add_u32 m0, s87, 0
    s_add_u32 s86, s88, 0
    buffer_load_dwordx4 v170, s[8:11], s86 offen lds
    s_add_u32 m0, s87, 768
    s_add_u32 s86, s88, 22016
    buffer_load_dwordx4 v170, s[8:11], s86 offen lds
    s_add_u32 m0, s87, 1536
    s_add_u32 s86, s88, 0
    buffer_load_dwordx4 v170, s[12:15], s86 offen lds
    s_add_u32 m0, s87, 2304
    s_add_u32 s86, s88, 22016
    buffer_load_dwordx4 v170, s[12:15], s86 offen lds
    s_add_u32 s86, s89, 7
    s_and_b32 s86, s86, 7
    s_mul_i32 s87, s86, 12288
    s_mul_i32 s88, s86, 176128
    s_add_u32 s87, s87, s80
    s_add_u32 s88, s88, s85
    s_add_u32 m0, s87, 0
    s_add_u32 s86, s88, 0
    buffer_load_dwordx4 v170, s[8:11], s86 offen lds
    s_mov_b64 exec, -1
    s_mov_b64 exec, 0
    s_cmp_eq_u32 s34, 0
    s_cbranch_scc1 L_pad0
    s_cmp_eq_u32 s34, 1
    s_cbranch_scc1 L_pad1
    s_cmp_eq_u32 s34, 2
    s_cbranch_scc1 L_pad2
    s_branch L_pad3
L_chain_ret:
    s_mov_b64 exec, -1
    s_lshl_b32 s56, s38, 7
    s_mul_i32 s57, s34, 22
    s_add_u32 s56, s56, s57
    s_lshl_b32 s56, s56, 11
    s_add_u32 s56, s56, 16777216
    s_lshr_b32 s57, s34, 1
    s_lshl_b32 s57, s57, 10
    s_add_u32 s81, s56, s57
    s_xor_b32 s57, s57, 1024
    s_add_u32 s82, s56, s57
    s_lshl_b32 s60, s35, 2
    s_add_u32 s60, s60, s34
    s_lshl_b32 s60, s60, 16
    s_add_u32 s60, s60, 1048576
    s_add_u32 s60, s60, s28
    s_lshl_b32 s57, s35, 2
    s_add_u32 s57, s57, s34
    s_lshl_b32 s57, s57, 1
    s_mul_i32 s58, s57, 86
    s_add_u32 s58, s58, s42
    s_lshl_b32 s58, s58, 10
    s_add_u32 s58, s58, 6291456
    s_add_u32 s58, s58, s28
    s_add_u32 s59, s58, 88064
    s_add_u32 s62, s57, 1
    v_lshlrev_b32 v151, 4, v254
    v_lshl_add_u32 v151, v253, 11, v151
    s_mul_i32 s48, s44, 86
    s_mul_i32 s50, s34, 22
    s_add_u32 s48, s48, s50
    s_lshl_b32 s48, s48, 10
    s_add_u32 s48, s48, 6291456
    s_add_u32 s49, s48, 88064
    s_lshr_b32 s50, s34, 1
    s_and_b32 s50, s50, s34
    s_mul_i32 s50, s50, 1073721344
    s_add_u32 s50, s50, 20480
    s_lshl_b32 s52, s38, 2
    s_add_u32 s52, s52, s34
    s_lshl_b32 s51, s44, 5
    s_add_u32 s51, s51, s52
    s_lshl_b32 s51, s51, 10
    s_add_u32 s51, s51, 1048576
    v_bfe_u32 v8, v248, 2, 2
    v_lshl_add_u32 v8, v253, 3, v8
    v_mul_u32_u24 v8, 96, v8
    v_bfe_u32 v9, v248, 4, 1
    v_mul_u32_u24 v9, 1536, v9
    v_and_b32 v10, 3, v248
    v_lshl_add_u32 v8, v10, 3, v8
    v_add3_u32 v8, v8, v9, s80
    v_add_u32 v10, s80, v255
    v_mov_b32 v12, s43
    v_mov_b32 v13, s43
    v_mov_b32 v14, s43
    v_mov_b32 v15, s43
    s_add_u32 s56, s89, 4
    s_and_b32 s56, s56, 7
    s_mul_i32 s56, s56, 12288
    v_add_u32 v9, s56, v8
    v_add_u32 v16, s56, v10
    ds_read_b64_tr_b16 v[80:81], v9 offset:0
    ds_read_b64_tr_b16 v[82:83], v9 offset:384
    ds_read_b64_tr_b16 v[84:85], v9 offset:32
    ds_read_b64_tr_b16 v[86:87], v9 offset:416
    ds_read_b64_tr_b16 v[88:89], v9 offset:64
    ds_read_b64_tr_b16 v[90:91], v9 offset:448
    s_waitcnt lgkmcnt(0)
    ds_write_b128 v16, v[80:83] offset:0
    v_mfma_f32_32x32x16_bf16 v[32:47], v[12:15], v[80:83], v[32:47]
    ds_write_b128 v16, v[84:87] offset:1024
    v_mfma_f32_32x32x16_bf16 v[48:63], v[12:15], v[84:87], v[48:63]
    ds_write_b128 v16, v[88:91] offset:2048
    v_mfma_f32_32x32x16_bf16 v[64:79], v[12:15], v[88:91], v[64:79]
    s_bfm_b64 exec, 48, 0
    s_add_u32 m0, s87, 768
    s_add_u32 s86, s88, 22016
    buffer_load_dwordx4 v170, s[8:11], s86 offen lds
    s_add_u32 m0, s87, 1536
    s_add_u32 s86, s88, 0
    buffer_load_dwordx4 v170, s[12:15], s86 offen lds
    s_add_u32 m0, s87, 2304
    s_add_u32 s86, s88, 22016
    buffer_load_dwordx4 v170, s[12:15], s86 offen lds
    s_mov_b64 exec, -1
    s_add_u32 s56, s89, 5
    s_and_b32 s56, s56, 7
    s_mul_i32 s56, s56, 12288
    v_add_u32 v9, s56, v8
    v_add_u32 v17, s56, v10
    ds_read_b64_tr_b16 v[92:93], v9 offset:0
    ds_read_b64_tr_b16 v[94:95], v9 offset:384
    ds_read_b64_tr_b16 v[96:97], v9 offset:32
    ds_read_b64_tr_b16 v[98:99], v9 offset:416
    ds_read_b64_tr_b16 v[100:101], v9 offset:64
    ds_read_b64_tr_b16 v[102:103], v9 offset:448
    s_waitcnt lgkmcnt(0)
    ds_write_b128 v17, v[92:95] offset:0
    v_mfma_f32_32x32x16_bf16 v[32:47], v[12:15], v[92:95], v[32:47]
    ds_write_b128 v17, v[96:99] offset:1024
    v_mfma_f32_32x32x16_bf16 v[48:63], v[12:15], v[96:99], v[48:63]
    ds_write_b128 v17, v[100:103] offset:2048
    v_mfma_f32_32x32x16_bf16 v[64:79], v[12:15], v[100:103], v[64:79]
    s_add_u32 s56, s89, 6
    s_and_b32 s56, s56, 7
    s_mul_i32 s56, s56, 12288
    v_add_u32 v9, s56, v8
    v_add_u32 v16, s56, v10
    s_waitcnt vmcnt(4)
    ds_read_b64_tr_b16 v[80:81], v9 offset:0
    ds_read_b64_tr_b16 v[82:83], v9 offset:384
    ds_read_b64_tr_b16 v[84:85], v9 offset:32
    ds_read_b64_tr_b16 v[86:87], v9 offset:416
    ds_read_b64_tr_b16 v[88:89], v9 offset:64
    ds_read_b64_tr_b16 v[90:91], v9 offset:448
    s_waitcnt lgkmcnt(0)
    ds_write_b128 v16, v[80:83] offset:0
    v_mfma_f32_32x32x16_bf16 v[32:47], v[12:15], v[80:83], v[32:47]
    ds_write_b128 v16, v[84:87] offset:1024
    v_mfma_f32_32x32x16_bf16 v[48:63], v[12:15], v[84:87], v[48:63]
    ds_write_b128 v16, v[88:91] offset:2048
    v_mfma_f32_32x32x16_bf16 v[64:79], v[12:15], v[88:91], v[64:79]
    v_lshl_add_u32 v4, v254, 3, s46
    s_andn2_b32 s71, 1073741824, s72
    buffer_load_dwordx2 v[6:7], v4, s[24:27], s71 offen sc1
    s_add_u32 s56, s89, 7
    s_and_b32 s56, s56, 7
    s_mul_i32 s56, s56, 12288
    v_add_u32 v9, s56, v8
    v_add_u32 v17, s56, v10
    s_waitcnt vmcnt(1)
    ds_read_b64_tr_b16 v[92:93], v9 offset:0
    ds_read_b64_tr_b16 v[94:95], v9 offset:384
    ds_read_b64_tr_b16 v[96:97], v9 offset:32
    ds_read_b64_tr_b16 v[98:99], v9 offset:416
    ds_read_b64_tr_b16 v[100:101], v9 offset:64
    ds_read_b64_tr_b16 v[102:103], v9 offset:448
    s_waitcnt lgkmcnt(0)
    ds_write_b128 v17, v[92:95] offset:0
    v_mfma_f32_32x32x16_bf16 v[32:47], v[12:15], v[92:95], v[32:47]
    ds_write_b128 v17, v[96:99] offset:1024
    v_mfma_f32_32x32x16_bf16 v[48:63], v[12:15], v[96:99], v[48:63]
    ds_write_b128 v17, v[100:103] offset:2048
    v_mfma_f32_32x32x16_bf16 v[64:79], v[12:15], v[100:103], v[64:79]
    s_lshl_b32 s56, s34, 2
    s_add_u32 s56, s56, 159744
    v_lshl_add_u32 v8, v254, 4, s56
    v_lshlrev_b32 v9, 4, v254
    v_add_u32 v9, 159744, v9
    s_nop 2
    ds_write_b32 v8, v32 offset:0
    s_nop 0
    ds_write_b32 v8, v48 offset:512
    s_nop 0
    ds_write_b32 v8, v64 offset:1024
    s_waitcnt lgkmcnt(0)
    s_add_u32 s70, s32, 1
    s_waitcnt vmcnt(0)
    v_subrev_u32 v6, s70, v6
    v_xor_b32 v7, s33, v7
    v_lshrrev_b32 v6, 3, v6
    v_or_b32 v6, v6, v7
    v_cmp_ne_u32 vcc, 0, v6
    s_nop 0
    s_or_b32 vcc_lo, vcc_lo, s40
    s_and_b64 vcc, vcc, s[72:73]
    s_cbranch_vccnz L_interleave_layers__spectral_fnet__swiglu_ffn__prompt_cf_2_retry
L_interleave_layers__spectral_fnet__swiglu_ffn__prompt_cf_2_ok:
    s_barrier
    s_cmp_lg_u32 s28, 0
    s_cbranch_scc1 L_idle0
    s_add_u32 s61, s60, 0
    buffer_load_dwordx4 v[152:155], v255, s[24:27], s61 offen offset:0 sc1
    buffer_load_dwordx4 v[156:159], v255, s[24:27], s61 offen offset:1024 sc1
    buffer_load_dwordx4 v[160:163], v255, s[24:27], s61 offen offset:2048 sc1
    buffer_load_dwordx4 v[164:167], v255, s[24:27], s61 offen offset:3072 sc1
    s_add_u32 s61, s60, 4096
    buffer_load_dwordx4 v[168:171], v255, s[24:27], s61 offen offset:0 sc1
    buffer_load_dwordx4 v[172:175], v255, s[24:27], s61 offen offset:1024 sc1
    ds_read_b128 v[80:83], v255 offset:0
    ds_read_b128 v[84:87], v255 offset:1024
    ds_read_b128 v[88:91], v255 offset:2048
    ds_read_b128 v[92:95], v255 offset:3072
    ds_read_b128 v[96:99], v255 offset:4096
    ds_read_b128 v[100:103], v255 offset:5120
    ds_read_b128 v[128:131], v9 offset:0
    ds_read_b128 v[132:135], v9 offset:512
    ds_read_b128 v[136:139], v9 offset:1024
    v_cmp_eq_u32 vcc, 0, v253
    s_waitcnt lgkmcnt(2)
    v_add_f32 v128, v128, v129
    v_add_f32 v130, v130, v131
    v_add_f32 v128, v128, v130
    v_cvt_pk_bf16_f32 v129, v128, 0
    v_lshlrev_b32 v130, 16, v129
    v_sub_f32 v130, v128, v130
    v_cvt_pk_bf16_f32 v130, v128, v130
    v_cndmask_b32 v129, 0, v129, vcc
    v_cndmask_b32 v130, 0, v130, vcc
    v_accvgpr_write_b32 a208, v130
    v_accvgpr_write_b32 a209, v129
    v_accvgpr_write_b32 a210, 0
    v_accvgpr_write_b32 a211, 0
    s_waitcnt lgkmcnt(1)
    v_add_f32 v132, v132, v133
    v_add_f32 v134, v134, v135
    v_add_f32 v132, v132, v134
    v_cvt_pk_bf16_f32 v133, v132, 0
    v_lshlrev_b32 v134, 16, v133
    v_sub_f32 v134, v132, v134
    v_cvt_pk_bf16_f32 v134, v132, v134
    v_cndmask_b32 v133, 0, v133, vcc
    v_cndmask_b32 v134, 0, v134, vcc
    v_accvgpr_write_b32 a212, v134
    v_accvgpr_write_b32 a213, v133
    v_accvgpr_write_b32 a214, 0
    v_accvgpr_write_b32 a215, 0
    s_waitcnt lgkmcnt(0)
    v_add_f32 v136, v136, v137
    v_add_f32 v138, v138, v139
    v_add_f32 v136, v136, v138
    v_cvt_pk_bf16_f32 v137, v136, 0
    v_lshlrev_b32 v138, 16, v137
    v_sub_f32 v138, v136, v138
    v_cvt_pk_bf16_f32 v138, v136, v138
    v_cndmask_b32 v137, 0, v137, vcc
    v_cndmask_b32 v138, 0, v138, vcc
    v_accvgpr_write_b32 a216, v138
    v_accvgpr_write_b32 a217, v137
    v_accvgpr_write_b32 a218, 0
    v_accvgpr_write_b32 a219, 0
    s_waitcnt vmcnt(5)
    v_mfma_f32_32x32x16_bf16 v[0:15], v[80:83], v[152:155], 0
    ds_read_b128 v[104:107], v255 offset:6144
    v_mfma_f32_32x32x16_bf16 v[16:31], v[84:87], v[152:155], 0
    ds_read_b128 v[108:111], v255 offset:7168
    s_waitcnt vmcnt(4)
    v_mfma_f32_32x32x16_bf16 v[32:47], v[88:91], v[152:155], 0
    ds_read_b128 v[80:83], v255 offset:8192
    buffer_load_dwordx4 v[176:179], v255, s[24:27], s61 offen offset:2048 sc1
    v_mfma_f32_32x32x16_bf16 v[0:15], v[92:95], v[156:159], v[0:15]
    ds_read_b128 v[84:87], v255 offset:9216
    v_mfma_f32_32x32x16_bf16 v[16:31], v[96:99], v[156:159], v[16:31]
    ds_read_b128 v[88:91], v255 offset:10240
    buffer_load_dwordx4 v[180:183], v255, s[24:27], s61 offen offset:3072 sc1
    v_mfma_f32_32x32x16_bf16 v[32:47], v[100:103], v[156:159], v[32:47]
    ds_read_b128 v[92:95], v255 offset:11264
    s_waitcnt vmcnt(5) lgkmcnt(4)
    v_mfma_f32_32x32x16_bf16 v[0:15], v[104:107], v[160:163], v[0:15]
    ds_read_b128 v[96:99], v255 offset:12288
    v_mfma_f32_32x32x16_bf16 v[16:31], v[108:111], v[160:163], v[16:31]
    ds_read_b128 v[100:103], v255 offset:13312
    s_add_u32 s61, s60, 8192
    buffer_load_dwordx4 v[184:187], v255, s[24:27], s61 offen offset:0 sc1
    s_waitcnt vmcnt(5) lgkmcnt(4)
    v_mfma_f32_32x32x16_bf16 v[32:47], v[80:83], v[160:163], v[32:47]
    ds_read_b128 v[104:107], v255 offset:14336
    v_mfma_f32_32x32x16_bf16 v[0:15], v[84:87], v[164:167], v[0:15]
    ds_read_b128 v[108:111], v255 offset:15360
    buffer_load_dwordx4 v[188:191], v255, s[24:27], s61 offen offset:1024 sc1
    s_waitcnt lgkmcnt(4)
    v_mfma_f32_32x32x16_bf16 v[16:31], v[88:91], v[164:167], v[16:31]
    ds_read_b128 v[80:83], v255 offset:16384
    v_mfma_f32_32x32x16_bf16 v[32:47], v[92:95], v[164:167], v[32:47]
    ds_read_b128 v[84:87], v255 offset:17408
    s_lshl_b32 s63, s57, 12
    s_add_u32 s63, s63, 5242880
    buffer_load_dwordx4 v[112:115], v151, s[24:27], s63 offen offset:0 sc1
    s_waitcnt vmcnt(6) lgkmcnt(4)
    v_mfma_f32_32x32x16_bf16 v[0:15], v[96:99], v[168:171], v[0:15]
    ds_read_b128 v[88:91], v255 offset:18432
    buffer_load_dwordx4 v[192:195], v255, s[24:27], s61 offen offset:2048 sc1
    v_mfma_f32_32x32x16_bf16 v[16:31], v[100:103], v[168:171], v[16:31]
    ds_read_b128 v[92:95], v255 offset:19456
    buffer_load_dwordx4 v[116:119], v151, s[24:27], s63 offen offset:512 sc1
    s_waitcnt vmcnt(7) lgkmcnt(4)
    v_mfma_f32_32x32x16_bf16 v[32:47], v[104:107], v[168:171], v[32:47]
    ds_read_b128 v[96:99], v255 offset:20480
    buffer_load_dwordx4 v[196:199], v255, s[24:27], s61 offen offset:3072 sc1
    v_mfma_f32_32x32x16_bf16 v[0:15], v[108:111], v[172:175], v[0:15]
    ds_read_b128 v[100:103], v255 offset:21504
    buffer_load_dwordx4 v[120:123], v151, s[24:27], s63 offen offset:1024 sc1
    s_waitcnt lgkmcnt(4)
    v_mfma_f32_32x32x16_bf16 v[16:31], v[80:83], v[172:175], v[16:31]
    ds_read_b128 v[104:107], v255 offset:22528
    s_add_u32 s61, s60, 12288
    buffer_load_dwordx4 v[200:203], v255, s[24:27], s61 offen offset:0 sc1
    v_mfma_f32_32x32x16_bf16 v[32:47], v[84:87], v[172:175], v[32:47]
L_pad0:
    s_cbranch_execz L_pad4
    ds_read_b128 v[108:111], v255 offset:23552
    buffer_load_dwordx4 v[124:127], v151, s[24:27], s63 offen offset:1536 sc1
    s_waitcnt vmcnt(10) lgkmcnt(4)
    v_mfma_f32_32x32x16_bf16 v[0:15], v[88:91], v[176:179], v[0:15]
    ds_read_b128 v[80:83], v255 offset:24576
    v_mfma_f32_32x32x16_bf16 v[16:31], v[92:95], v[176:179], v[16:31]
    ds_read_b128 v[84:87], v255 offset:25600
    buffer_load_dwordx4 v[204:207], v255, s[24:27], s61 offen offset:1024 sc1
    s_waitcnt vmcnt(10) lgkmcnt(4)
    v_mfma_f32_32x32x16_bf16 v[32:47], v[96:99], v[176:179], v[32:47]
    ds_read_b128 v[88:91], v255 offset:26624
    s_lshl_b32 s64, s38, 5
    v_add_u32 v48, s64, v248
    v_and_b32 v48, 255, v48
    v_lshlrev_b32 v48, 3, v48
    v_add_u32 v48, 16384, v48
    buffer_load_dwordx2 v[50:51], v48, s[24:27], 0 offen sc1
    v_mfma_f32_32x32x16_bf16 v[0:15], v[100:103], v[180:183], v[0:15]
    ds_read_b128 v[92:95], v255 offset:27648
    buffer_load_dwordx4 v[208:211], v255, s[24:27], s61 offen offset:2048 sc1
    s_waitcnt lgkmcnt(4)
    v_mfma_f32_32x32x16_bf16 v[16:31], v[104:107], v[180:183], v[16:31]
    ds_read_b128 v[96:99], v255 offset:28672
    v_mfma_f32_32x32x16_bf16 v[32:47], v[108:111], v[180:183], v[32:47]
    ds_read_b128 v[100:103], v255 offset:29696
    s_waitcnt vmcnt(11) lgkmcnt(4)
    v_mfma_f32_32x32x16_bf16 v[0:15], v[80:83], v[184:187], v[0:15]
    ds_read_b128 v[104:107], v255 offset:30720
    buffer_load_dwordx4 v[212:215], v255, s[24:27], s61 offen offset:3072 sc1
    v_mfma_f32_32x32x16_bf16 v[16:31], v[84:87], v[184:187], v[16:31]
    ds_read_b128 v[108:111], v255 offset:31744
    s_waitcnt vmcnt(11) lgkmcnt(4)
    v_mfma_f32_32x32x16_bf16 v[32:47], v[88:91], v[184:187], v[32:47]
    ds_read_b128 v[80:83], v255 offset:32768
    s_add_u32 s61, s60, 16384
    buffer_load_dwordx4 v[216:219], v255, s[24:27], s61 offen offset:0 sc1
    v_mfma_f32_32x32x16_bf16 v[0:15], v[92:95], v[188:191], v[0:15]
    ds_read_b128 v[84:87], v255 offset:33792
    s_waitcnt lgkmcnt(4)
    v_mfma_f32_32x32x16_bf16 v[16:31], v[96:99], v[188:191], v[16:31]
    ds_read_b128 v[88:91], v255 offset:34816
    buffer_load_dwordx4 v[220:223], v255, s[24:27], s61 offen offset:1024 sc1
    v_mfma_f32_32x32x16_bf16 v[32:47], v[100:103], v[188:191], v[32:47]
    ds_read_b128 v[92:95], v255 offset:35840
    s_waitcnt vmcnt(11) lgkmcnt(4)
    v_mfma_f32_32x32x16_bf16 v[0:15], v[104:107], v[192:195], v[0:15]
    ds_read_b128 v[96:99], v255 offset:36864
    v_mfma_f32_32x32x16_bf16 v[16:31], v[108:111], v[192:195], v[16:31]
    ds_read_b128 v[100:103], v255 offset:37888
    buffer_load_dwordx4 v[224:227], v255, s[24:27], s61 offen offset:2048 sc1
    s_waitcnt vmcnt(10) lgkmcnt(4)
    v_mfma_f32_32x32x16_bf16 v[32:47], v[80:83], v[192:195], v[32:47]
    ds_read_b128 v[104:107], v255 offset:38912
    v_mfma_f32_32x32x16_bf16 v[0:15], v[84:87], v[196:199], v[0:15]
    ds_read_b128 v[108:111], v255 offset:39936
    buffer_load_dwordx4 v[228:231], v255, s[24:27], s61 offen offset:3072 sc1
    s_waitcnt lgkmcnt(4)
    v_mfma_f32_32x32x16_bf16 v[16:31], v[88:91], v[196:199], v[16:31]
    ds_read_b128 v[80:83], v255 offset:40960
    v_mfma_f32_32x32x16_bf16 v[32:47], v[92:95], v[196:199], v[32:47]
    ds_read_b128 v[84:87], v255 offset:41984
    s_waitcnt vmcnt(9) lgkmcnt(4)
    v_mfma_f32_32x32x16_bf16 v[0:15], v[96:99], v[200:203], v[0:15]
    ds_read_b128 v[88:91], v255 offset:43008
    s_add_u32 s61, s60, 20480
    buffer_load_dwordx4 v[232:235], v255, s[24:27], s61 offen offset:0 sc1
    v_mfma_f32_32x32x16_bf16 v[16:31], v[100:103], v[200:203], v[16:31]
    ds_read_b128 v[92:95], v255 offset:44032
    s_waitcnt vmcnt(8) lgkmcnt(4)
    v_mfma_f32_32x32x16_bf16 v[32:47], v[104:107], v[200:203], v[32:47]
    ds_read_b128 v[96:99], v255 offset:45056
    buffer_load_dwordx4 v[236:239], v255, s[24:27], s61 offen offset:1024 sc1
    v_mfma_f32_32x32x16_bf16 v[0:15], v[108:111], v[204:207], v[0:15]
    ds_read_b128 v[100:103], v255 offset:46080
    s_waitcnt lgkmcnt(4)
    v_mfma_f32_32x32x16_bf16 v[16:31], v[80:83], v[204:207], v[16:31]
    ds_read_b128 v[104:107], v255 offset:47104
    buffer_load_dwordx4 v[240:243], v255, s[24:27], s61 offen offset:2048 sc1
    s_mov_b32 s74, 0
    s_add_u32 s64, s32, 1
    s_waitcnt vmcnt(9)
    v_xor_b32 v50, s64, v50
    v_xor_b32 v51, s33, v51
    v_or_b32 v50, v50, v51
    v_cmp_ne_u32 vcc, 0, v50
    s_nop 0
    s_cbranch_vccnz L_aux_retry
L_aux_ok:
    s_add_u32 s83, s81, 0
    buffer_load_dwordx4 a[0:3], v150, s[24:27], s83 offen offset:0 sc1
    v_mfma_f32_32x32x16_bf16 v[32:47], v[84:87], v[204:207], v[32:47]
    ds_read_b128 v[108:111], v255 offset:48128
    v_add_f32 v112, v112, v114
    v_add_f32 v113, v113, v115
    v_add_f32 v112, v112, v116
    v_add_f32 v113, v113, v117
    s_waitcnt vmcnt(9) lgkmcnt(4)
    v_mfma_f32_32x32x16_bf16 v[0:15], v[88:91], v[208:211], v[0:15]
    ds_read_b128 v[80:83], v250 offset:0
    v_add_f32 v112, v112, v118
    v_add_f32 v113, v113, v119
    v_add_f32 v112, v112, v120
    v_add_f32 v113, v113, v121
    v_add_f32 v112, v112, v122
    v_mfma_f32_32x32x16_bf16 v[16:31], v[92:95], v[208:211], v[16:31]
    ds_read_b128 v[84:87], v250 offset:1024
    buffer_load_dwordx4 v[244:247], v255, s[24:27], s61 offen offset:3072 sc1
    v_add_f32 v113, v113, v123
    v_add_f32 v112, v112, v124
    v_add_f32 v113, v113, v125
    s_waitcnt vmcnt(9) lgkmcnt(4)
    v_mfma_f32_32x32x16_bf16 v[32:47], v[96:99], v[208:211], v[32:47]
    ds_read_b128 v[88:91], v250 offset:2048
    v_add_f32 v112, v112, v126
    v_add_f32 v113, v113, v127
    v_mov_b32 v114, v112
    v_mov_b32 v115, v113
    s_nop 0
    v_mfma_f32_32x32x16_bf16 v[0:15], v[100:103], v[212:215], v[0:15]
    ds_read_b128 v[92:95], v250 offset:3072
    s_add_u32 s61, s60, 24576
    buffer_load_dwordx4 a[224:227], v255, s[24:27], s61 offen offset:0 sc1
    v_permlane32_swap_b32 v112, v114
    v_permlane32_swap_b32 v113, v115
    s_waitcnt lgkmcnt(4)
    v_mfma_f32_32x32x16_bf16 v[16:31], v[104:107], v[212:215], v[16:31]
    ds_read_b128 v[96:99], v250 offset:4096
    v_add_f32 v112, v112, v114
    v_add_f32 v113, v113, v115
    v_mul_f32 v112, 0xbb000000, v112
    v_mul_f32 v114, v112, v112
    v_fma_f32 v113, v113, s45, -v114
    v_mfma_f32_32x32x16_bf16 v[32:47], v[108:111], v[212:215], v[32:47]
    ds_read_b128 v[100:103], v250 offset:5120
    v_max_f32 v113, 0, v113
    v_add_f32 v128, 0x3727c5ac, v113
    v_rsq_f32 v129, v128
    s_waitcnt vmcnt(9) lgkmcnt(4)
    v_mfma_f32_32x32x16_bf16 v[0:15], v[80:83], v[216:219], v[0:15]
    ds_read_b128 v[104:107], v250 offset:6144
    buffer_load_dwordx4 a[228:231], v255, s[24:27], s61 offen offset:1024 sc1
    v_cvt_pk_bf16_f32 v132, v112, v112
    v_mul_f32 v129, 0xbfb8aa3b, v129
    v_lshlrev_b32 v114, 16, v132
    v_sub_f32 v114, v112, v114
    v_mfma_f32_32x32x16_bf16 v[16:31], v[84:87], v[216:219], v[16:31]
    ds_read_b128 v[108:111], v250 offset:7168
    v_cvt_pk_bf16_f32 v133, v114, 0
    v_mov_b32 v134, 0
    v_mov_b32 v135, 0
    s_waitcnt vmcnt(9) lgkmcnt(4)
    v_mfma_f32_32x32x16_bf16 v[32:47], v[88:91], v[216:219], v[32:47]
    ds_read_b128 v[80:83], v250 offset:8192
    buffer_load_dwordx4 a[232:235], v255, s[24:27], s61 offen offset:2048 sc1
    v_mfma_f32_32x32x16_bf16 v[0:15], v[92:95], v[220:223], v[0:15]
    ds_read_b128 v[84:87], v250 offset:9216
    s_waitcnt lgkmcnt(4)
    v_mfma_f32_32x32x16_bf16 v[16:31], v[96:99], v[220:223], v[16:31]
    ds_read_b128 v[88:91], v250 offset:10240
    buffer_load_dwordx4 a[236:239], v255, s[24:27], s61 offen offset:3072 sc1
    v_mfma_f32_32x32x16_bf16 v[32:47], v[100:103], v[220:223], v[32:47]
    ds_read_b128 v[92:95], v250 offset:11264
    s_waitcnt vmcnt(10) lgkmcnt(4)
    v_mfma_f32_32x32x16_bf16 v[0:15], v[104:107], v[224:227], v[0:15]
    ds_read_b128 v[96:99], v250 offset:12288
    v_mfma_f32_32x32x16_bf16 v[16:31], v[108:111], v[224:227], v[16:31]
    ds_read_b128 v[100:103], v250 offset:13312
    s_add_u32 s61, s60, 28672
    buffer_load_dwordx4 a[240:243], v255, s[24:27], s61 offen offset:0 sc1
    s_add_u32 s84, s82, 0
    buffer_load_dwordx4 a[4:7], v150, s[24:27], s84 offen offset:0 sc1
    s_waitcnt vmcnt(11) lgkmcnt(4)
    v_mfma_f32_32x32x16_bf16 v[32:47], v[80:83], v[224:227], v[32:47]
    ds_read_b128 v[104:107], v250 offset:14336
    v_mfma_f32_32x32x16_bf16 v[0:15], v[84:87], v[228:231], v[0:15]
    ds_read_b128 v[108:111], v250 offset:15360
    buffer_load_dwordx4 a[244:247], v255, s[24:27], s61 offen offset:1024 sc1
    s_waitcnt lgkmcnt(4)
    v_mfma_f32_32x32x16_bf16 v[16:31], v[88:91], v[228:231], v[16:31]
    ds_read_b128 v[80:83], v250 offset:16384
    v_mfma_f32_32x32x16_bf16 v[32:47], v[92:95], v[228:231], v[32:47]
    ds_read_b128 v[84:87], v250 offset:17408
    s_waitcnt vmcnt(11) lgkmcnt(4)
    v_mfma_f32_32x32x16_bf16 v[0:15], v[96:99], v[232:235], v[0:15]
    ds_read_b128 v[88:91], v250 offset:18432
    buffer_load_dwordx4 a[248:251], v255, s[24:27], s61 offen offset:2048 sc1
    v_mfma_f32_32x32x16_bf16 v[16:31], v[100:103], v[232:235], v[16:31]
    ds_read_b128 v[92:95], v250 offset:19456
    s_waitcnt vmcnt(11) lgkmcnt(4)
    v_mfma_f32_32x32x16_bf16 v[32:47], v[104:107], v[232:235], v[32:47]
    ds_read_b128 v[96:99], v250 offset:20480
    buffer_load_dwordx4 a[252:255], v255, s[24:27], s61 offen offset:3072 sc1
    v_mfma_f32_32x32x16_bf16 v[0:15], v[108:111], v[236:239], v[0:15]
    ds_read_b128 v[100:103], v250 offset:21504
    s_lshl_b32 s63, s62, 12
    s_add_u32 s63, s63, 5242880
    buffer_load_dwordx4 v[112:115], v151, s[24:27], s63 offen offset:0 sc1
    s_waitcnt lgkmcnt(4)
    v_mfma_f32_32x32x16_bf16 v[16:31], v[80:83], v[236:239], v[16:31]
    ds_read_b128 v[104:107], v250 offset:22528
    s_add_u32 s61, s60, 32768
    buffer_load_dwordx4 v[152:155], v255, s[24:27], s61 offen offset:0 sc1
    v_mfma_f32_32x32x16_bf16 v[32:47], v[84:87], v[236:239], v[32:47]
    ds_read_b128 v[108:111], v250 offset:23552
    buffer_load_dwordx4 v[116:119], v151, s[24:27], s63 offen offset:512 sc1
    s_waitcnt vmcnt(14) lgkmcnt(4)
    v_mfma_f32_32x32x16_bf16 v[0:15], v[88:91], v[240:243], v[0:15]
    ds_read_b128 v[80:83], v250 offset:24576
    v_mfma_f32_32x32x16_bf16 v[16:31], v[92:95], v[240:243], v[16:31]
    ds_read_b128 v[84:87], v250 offset:25600
    buffer_load_dwordx4 v[156:159], v255, s[24:27], s61 offen offset:1024 sc1
    s_waitcnt vmcnt(13) lgkmcnt(4)
    v_mfma_f32_32x32x16_bf16 v[32:47], v[96:99], v[240:243], v[32:47]
    ds_read_b128 v[88:91], v250 offset:26624
    v_mfma_f32_32x32x16_bf16 v[0:15], v[100:103], v[244:247], v[0:15]
    ds_read_b128 v[92:95], v250 offset:27648
    buffer_load_dwordx4 v[160:163], v255, s[24:27], s61 offen offset:2048 sc1
    s_waitcnt lgkmcnt(4)
    v_mfma_f32_32x32x16_bf16 v[16:31], v[104:107], v[244:247], v[16:31]
    ds_read_b128 v[96:99], v250 offset:28672
    buffer_load_dwordx4 a[8:11], v150, s[24:27], s83 offen offset:2048 sc1
    v_mfma_f32_32x32x16_bf16 v[32:47], v[108:111], v[244:247], v[32:47]
    ds_read_b128 v[100:103], v250 offset:29696
    buffer_load_dwordx4 v[120:123], v151, s[24:27], s63 offen offset:1024 sc1
    s_waitcnt vmcnt(15) lgkmcnt(4)
    v_mfma_f32_32x32x16_bf16 v[0:15], v[80:83], a[224:227], v[0:15]
    ds_read_b128 v[104:107], v250 offset:30720
    buffer_load_dwordx4 v[164:167], v255, s[24:27], s61 offen offset:3072 sc1
    v_mfma_f32_32x32x16_bf16 v[16:31], v[84:87], a[224:227], v[16:31]
    ds_read_b128 v[108:111], v250 offset:31744
    buffer_load_dwordx4 v[124:127], v151, s[24:27], s63 offen offset:1536 sc1
    s_waitcnt vmcnt(16) lgkmcnt(4)
    v_mfma_f32_32x32x16_bf16 v[32:47], v[88:91], a[224:227], v[32:47]
    ds_read_b128 v[80:83], v250 offset:32768
    s_add_u32 s61, s60, 36864
    buffer_load_dwordx4 v[168:171], v255, s[24:27], s61 offen offset:0 sc1
    v_mfma_f32_32x32x16_bf16 v[0:15], v[92:95], a[228:231], v[0:15]
    ds_read_b128 v[84:87], v250 offset:33792
    s_waitcnt lgkmcnt(4)
    v_mfma_f32_32x32x16_bf16 v[16:31], v[96:99], a[228:231], v[16:31]
    ds_read_b128 v[88:91], v250 offset:34816
    buffer_load_dwordx4 v[172:175], v255, s[24:27], s61 offen offset:1024 sc1
    v_mfma_f32_32x32x16_bf16 v[32:47], v[100:103], a[228:231], v[32:47]
    ds_read_b128 v[92:95], v250 offset:35840
    s_waitcnt vmcnt(17) lgkmcnt(4)
    v_mfma_f32_32x32x16_bf16 v[0:15], v[104:107], a[232:235], v[0:15]
    ds_read_b128 v[96:99], v250 offset:36864
    v_mfma_f32_32x32x16_bf16 v[16:31], v[108:111], a[232:235], v[16:31]
    ds_read_b128 v[100:103], v250 offset:37888
    buffer_load_dwordx4 v[176:179], v255, s[24:27], s61 offen offset:2048 sc1
    s_waitcnt vmcnt(17) lgkmcnt(4)
    v_mfma_f32_32x32x16_bf16 v[32:47], v[80:83], a[232:235], v[32:47]
    ds_read_b128 v[104:107], v250 offset:38912
    v_mfma_f32_32x32x16_bf16 v[0:15], v[84:87], a[236:239], v[0:15]
    ds_read_b128 v[108:111], v250 offset:39936
    buffer_load_dwordx4 v[180:183], v255, s[24:27], s61 offen offset:3072 sc1
    s_waitcnt lgkmcnt(4)
    v_mfma_f32_32x32x16_bf16 v[16:31], v[88:91], a[236:239], v[16:31]
    ds_read_b128 v[80:83], v250 offset:40960
    v_mfma_f32_32x32x16_bf16 v[32:47], v[92:95], a[236:239], v[32:47]
    ds_read_b128 v[84:87], v250 offset:41984
    s_waitcnt vmcnt(17) lgkmcnt(4)
    v_mfma_f32_32x32x16_bf16 v[0:15], v[96:99], a[240:243], v[0:15]
    ds_read_b128 v[88:91], v250 offset:43008
    s_add_u32 s61, s60, 40960
    buffer_load_dwordx4 v[184:187], v255, s[24:27], s61 offen offset:0 sc1
    s_waitcnt vmcnt(13)
    v_add_f32 v112, v112, v114
    v_add_f32 v113, v113, v115
    s_waitcnt vmcnt(11)
    v_add_f32 v112, v112, v116
    v_mfma_f32_32x32x16_bf16 v[16:31], v[100:103], a[240:243], v[16:31]
    ds_read_b128 v[92:95], v250 offset:44032
    buffer_load_dwordx4 a[12:15], v150, s[24:27], s84 offen offset:2048 sc1
    v_add_f32 v113, v113, v117
    v_add_f32 v112, v112, v118
    v_add_f32 v113, v113, v119
    s_waitcnt lgkmcnt(4)
    v_mfma_f32_32x32x16_bf16 v[32:47], v[104:107], a[240:243], v[32:47]
    ds_read_b128 v[96:99], v250 offset:45056
    buffer_load_dwordx4 v[188:191], v255, s[24:27], s61 offen offset:1024 sc1
    s_waitcnt vmcnt(9)
    v_add_f32 v112, v112, v120
    v_add_f32 v113, v113, v121
    v_add_f32 v112, v112, v122
    v_add_f32 v113, v113, v123
    v_mfma_f32_32x32x16_bf16 v[0:15], v[108:111], a[244:247], v[0:15]
    ds_read_b128 v[100:103], v250 offset:46080
    s_waitcnt vmcnt(7)
    v_add_f32 v112, v112, v124
    v_add_f32 v113, v113, v125
    v_add_f32 v112, v112, v126
    v_add_f32 v113, v113, v127
    s_waitcnt lgkmcnt(4)
    v_mfma_f32_32x32x16_bf16 v[16:31], v[80:83], a[244:247], v[16:31]
    ds_read_b128 v[104:107], v250 offset:47104
    buffer_load_dwordx4 v[192:195], v255, s[24:27], s61 offen offset:2048 sc1
    v_mov_b32 v114, v112
    v_mov_b32 v115, v113
    s_nop 0
    v_permlane32_swap_b32 v112, v114
    v_mfma_f32_32x32x16_bf16 v[32:47], v[84:87], a[244:247], v[32:47]
    ds_read_b128 v[108:111], v250 offset:48128
    v_permlane32_swap_b32 v113, v115
    v_add_f32 v112, v112, v114
    v_add_f32 v113, v113, v115
    v_mul_f32 v112, 0xbb000000, v112
    s_waitcnt lgkmcnt(4)
    v_mfma_f32_32x32x16_bf16 v[0:15], v[88:91], a[248:251], v[0:15]
    ds_read_b128 v[80:83], v255 offset:0
    v_mul_f32 v114, v112, v112
    v_fma_f32 v113, v113, s45, -v114
    v_max_f32 v113, 0, v113
    v_add_f32 v130, 0x3727c5ac, v113
    v_mfma_f32_32x32x16_bf16 v[16:31], v[92:95], a[248:251], v[16:31]
    ds_read_b128 v[84:87], v255 offset:1024
    buffer_load_dwordx4 v[196:199], v255, s[24:27], s61 offen offset:3072 sc1
    v_rsq_f32 v131, v130
    v_cvt_pk_bf16_f32 v136, v112, v112
    s_waitcnt lgkmcnt(4)
    v_mfma_f32_32x32x16_bf16 v[32:47], v[96:99], a[248:251], v[32:47]
    ds_read_b128 v[88:91], v255 offset:3072
    v_mul_f32 v131, 0xbfb8aa3b, v131
    v_lshlrev_b32 v114, 16, v136
    v_sub_f32 v114, v112, v114
    v_cvt_pk_bf16_f32 v137, v114, 0
    v_mov_b32 v138, 0
    v_mfma_f32_32x32x16_bf16 v[0:15], v[100:103], a[252:255], v[0:15]
    ds_read_b128 v[92:95], v255 offset:4096
    s_add_u32 s61, s60, 45056
    buffer_load_dwordx4 v[200:203], v255, s[24:27], s61 offen offset:0 sc1
    v_mfma_f32_32x32x16_bf16 v[0:15], a[208:211], v[132:135], v[0:15]
    v_mov_b32 v139, 0
    s_waitcnt lgkmcnt(4)
    v_mfma_f32_32x32x16_bf16 v[16:31], v[104:107], a[252:255], v[16:31]
    ds_read_b128 v[96:99], v255 offset:6144
    v_mfma_f32_32x32x16_bf16 v[16:31], a[212:215], v[132:135], v[16:31]
    v_mfma_f32_32x32x16_bf16 v[32:47], v[108:111], a[252:255], v[32:47]
    ds_read_b128 v[100:103], v255 offset:7168
    v_mfma_f32_32x32x16_bf16 v[32:47], a[216:219], v[132:135], v[32:47]
    s_waitcnt lgkmcnt(4)
    v_mfma_f32_32x32x16_bf16 v[48:63], v[80:83], v[152:155], 0
    ds_read_b128 v[104:107], v255 offset:9216
    buffer_load_dwordx4 v[204:207], v255, s[24:27], s61 offen offset:1024 sc1
    v_mfma_f32_32x32x16_bf16 v[64:79], v[84:87], v[152:155], 0
    ds_read_b128 v[108:111], v255 offset:10240
    s_waitcnt lgkmcnt(4)
    v_mfma_f32_32x32x16_bf16 v[48:63], v[88:91], v[156:159], v[48:63]
    ds_read_b128 v[80:83], v255 offset:12288
    buffer_load_dwordx4 v[208:211], v255, s[24:27], s61 offen offset:2048 sc1
    v_mul_f32 v140, v0, v129
    v_mul_f32 v141, v1, v129
    v_mul_f32 v142, v2, v129
    v_mul_f32 v143, v3, v129
    v_mfma_f32_32x32x16_bf16 v[64:79], v[92:95], v[156:159], v[64:79]
    ds_read_b128 v[84:87], v255 offset:13312
    v_exp_f32 v140, v140
    v_mul_f32 v0, v0, v8
    s_waitcnt lgkmcnt(4)
    v_mfma_f32_32x32x16_bf16 v[48:63], v[96:99], v[160:163], v[48:63]
    ds_read_b128 v[88:91], v255 offset:15360
    buffer_load_dwordx4 v[212:215], v255, s[24:27], s61 offen offset:3072 sc1
    s_add_u32 s83, s81, 4096
    buffer_load_dwordx4 a[16:19], v150, s[24:27], s83 offen offset:0 sc1
    v_exp_f32 v141, v141
    v_mfma_f32_32x32x16_bf16 v[64:79], v[100:103], v[160:163], v[64:79]
    ds_read_b128 v[92:95], v255 offset:16384
    v_mul_f32 v1, v1, v9
    v_exp_f32 v142, v142
    v_mul_f32 v2, v2, v10
    s_waitcnt lgkmcnt(4)
    v_mfma_f32_32x32x16_bf16 v[48:63], v[104:107], v[164:167], v[48:63]
    ds_read_b128 v[96:99], v255 offset:18432
    v_exp_f32 v143, v143
    v_mul_f32 v3, v3, v11
    v_fma_f32 v140, v140, v128, v128
    v_fma_f32 v141, v141, v128, v128
    v_mfma_f32_32x32x16_bf16 v[64:79], v[108:111], v[164:167], v[64:79]
    ds_read_b128 v[100:103], v255 offset:19456
    s_add_u32 s61, s60, 49152
    buffer_load_dwordx4 v[216:219], v255, s[24:27], s61 offen offset:0 sc1
    v_fma_f32 v142, v142, v128, v128
    v_fma_f32 v143, v143, v128, v128
    s_waitcnt vmcnt(14) lgkmcnt(4)
    v_mfma_f32_32x32x16_bf16 v[48:63], v[80:83], v[168:171], v[48:63]
    ds_read_b128 v[104:107], v255 offset:21504
    v_rcp_f32 v140, v140
    v_rcp_f32 v141, v141
    v_mfma_f32_32x32x16_bf16 v[64:79], v[84:87], v[168:171], v[64:79]
    ds_read_b128 v[108:111], v255 offset:22528
    buffer_load_dwordx4 v[220:223], v255, s[24:27], s61 offen offset:1024 sc1
    v_rcp_f32 v142, v142
    s_waitcnt vmcnt(14) lgkmcnt(4)
    v_mfma_f32_32x32x16_bf16 v[48:63], v[88:91], v[172:175], v[48:63]
    ds_read_b128 v[80:83], v255 offset:24576
    v_rcp_f32 v143, v143
    v_mul_f32 v0, v0, v140
    v_mul_f32 v1, v1, v141
    v_mul_f32 v2, v2, v142
    v_mfma_f32_32x32x16_bf16 v[64:79], v[92:95], v[172:175], v[64:79]
    ds_read_b128 v[84:87], v255 offset:25600
    v_mul_f32 v3, v3, v143
    v_cvt_pk_bf16_f32 v144, v0, v1
    v_cvt_pk_bf16_f32 v145, v2, v3
    v_mul_f32 v140, v4, v129
    s_waitcnt vmcnt(13) lgkmcnt(4)
    v_mfma_f32_32x32x16_bf16 v[48:63], v[96:99], v[176:179], v[48:63]
    ds_read_b128 v[88:91], v255 offset:27648
    buffer_load_dwordx4 v[224:227], v255, s[24:27], s61 offen offset:2048 sc1
    v_mul_f32 v141, v5, v129
    v_mul_f32 v142, v6, v129
    v_mul_f32 v143, v7, v129
    v_mfma_f32_32x32x16_bf16 v[64:79], v[100:103], v[176:179], v[64:79]
    ds_read_b128 v[92:95], v255 offset:28672
    v_exp_f32 v140, v140
    v_mul_f32 v4, v4, v12
    s_waitcnt vmcnt(13) lgkmcnt(4)
    v_mfma_f32_32x32x16_bf16 v[48:63], v[104:107], v[180:183], v[48:63]
    ds_read_b128 v[96:99], v255 offset:30720
    buffer_load_dwordx4 v[228:231], v255, s[24:27], s61 offen offset:3072 sc1
    v_exp_f32 v141, v141
    v_mul_f32 v5, v5, v13
    v_mfma_f32_32x32x16_bf16 v[64:79], v[108:111], v[180:183], v[64:79]
    ds_read_b128 v[100:103], v255 offset:31744
    v_exp_f32 v142, v142
    v_mul_f32 v6, v6, v14
    s_waitcnt vmcnt(13) lgkmcnt(4)
    v_mfma_f32_32x32x16_bf16 v[48:63], v[80:83], v[184:187], v[48:63]
    ds_read_b128 v[104:107], v255 offset:33792
    s_add_u32 s61, s60, 53248
    buffer_load_dwordx4 v[232:235], v255, s[24:27], s61 offen offset:0 sc1
    v_exp_f32 v143, v143
    v_mul_f32 v7, v7, v15
    v_mfma_f32_32x32x16_bf16 v[64:79], v[84:87], v[184:187], v[64:79]
    ds_read_b128 v[108:111], v255 offset:34816
    v_fma_f32 v140, v140, v128, v128
    v_fma_f32 v141, v141, v128, v128
    v_fma_f32 v142, v142, v128, v128
    v_fma_f32 v143, v143, v128, v128
    s_waitcnt vmcnt(12) lgkmcnt(4)
    v_mfma_f32_32x32x16_bf16 v[48:63], v[88:91], v[188:191], v[48:63]
    ds_read_b128 v[80:83], v255 offset:36864
    v_rcp_f32 v140, v140
    v_rcp_f32 v141, v141
    v_mfma_f32_32x32x16_bf16 v[64:79], v[92:95], v[188:191], v[64:79]
    ds_read_b128 v[84:87], v255 offset:37888
    buffer_load_dwordx4 v[236:239], v255, s[24:27], s61 offen offset:1024 sc1
    s_add_u32 s84, s82, 4096
    buffer_load_dwordx4 a[20:23], v150, s[24:27], s84 offen offset:0 sc1
    s_waitcnt vmcnt(13) lgkmcnt(4)
    v_mfma_f32_32x32x16_bf16 v[48:63], v[96:99], v[192:195], v[48:63]
    ds_read_b128 v[88:91], v255 offset:39936
    v_rcp_f32 v142, v142
    v_rcp_f32 v143, v143
    v_mul_f32 v4, v4, v140
    v_mfma_f32_32x32x16_bf16 v[64:79], v[100:103], v[192:195], v[64:79]
    ds_read_b128 v[92:95], v255 offset:40960
    buffer_load_dwordx4 v[240:243], v255, s[24:27], s61 offen offset:2048 sc1
    v_mul_f32 v5, v5, v141
    v_mul_f32 v6, v6, v142
    v_mul_f32 v7, v7, v143
    s_waitcnt vmcnt(13) lgkmcnt(4)
    v_mfma_f32_32x32x16_bf16 v[48:63], v[104:107], v[196:199], v[48:63]
    ds_read_b128 v[96:99], v255 offset:43008
    v_cvt_pk_bf16_f32 v146, v4, v5
    v_cvt_pk_bf16_f32 v147, v6, v7
    buffer_store_dwordx4 v[144:147], v255, s[24:27], s58 offen offset:0 sc1
    v_mul_f32 v140, v16, v129
    v_mul_f32 v141, v17, v129
    v_mfma_f32_32x32x16_bf16 v[64:79], v[108:111], v[196:199], v[64:79]
    ds_read_b128 v[100:103], v255 offset:44032
    v_mul_f32 v142, v18, v129
    v_mul_f32 v143, v19, v129
    v_exp_f32 v140, v140
    s_waitcnt vmcnt(13) lgkmcnt(4)
    v_mfma_f32_32x32x16_bf16 v[48:63], v[80:83], v[200:203], v[48:63]
    ds_read_b128 v[104:107], v255 offset:46080
    buffer_load_dwordx4 v[244:247], v255, s[24:27], s61 offen offset:3072 sc1
    v_mul_f32 v16, v16, v24
    v_exp_f32 v141, v141
    v_mul_f32 v17, v17, v25
    v_mfma_f32_32x32x16_bf16 v[64:79], v[84:87], v[200:203], v[64:79]
    ds_read_b128 v[108:111], v255 offset:47104
    v_exp_f32 v142, v142
    v_mul_f32 v18, v18, v26
    s_waitcnt vmcnt(13) lgkmcnt(4)
    v_mfma_f32_32x32x16_bf16 v[48:63], v[88:91], v[204:207], v[48:63]
    ds_read_b128 v[80:83], v250 offset:0
    s_add_u32 s61, s60, 57344
    buffer_load_dwordx4 a[224:227], v255, s[24:27], s61 offen offset:0 sc1
    v_exp_f32 v143, v143
    v_mul_f32 v19, v19, v27
    v_mfma_f32_32x32x16_bf16 v[64:79], v[92:95], v[204:207], v[64:79]
    ds_read_b128 v[84:87], v250 offset:1024
    v_fma_f32 v140, v140, v128, v128
    v_fma_f32 v141, v141, v128, v128
    v_fma_f32 v142, v142, v128, v128
    v_fma_f32 v143, v143, v128, v128
    s_waitcnt vmcnt(13) lgkmcnt(4)
    v_mfma_f32_32x32x16_bf16 v[48:63], v[96:99], v[208:211], v[48:63]
    ds_read_b128 v[88:91], v250 offset:3072
    buffer_load_dwordx4 a[228:231], v255, s[24:27], s61 offen offset:1024 sc1
    v_rcp_f32 v140, v140
    v_rcp_f32 v141, v141
    v_mfma_f32_32x32x16_bf16 v[64:79], v[100:103], v[208:211], v[64:79]
    ds_read_b128 v[92:95], v250 offset:4096
    v_rcp_f32 v142, v142
    v_rcp_f32 v143, v143
    s_waitcnt vmcnt(13) lgkmcnt(4)
    v_mfma_f32_32x32x16_bf16 v[48:63], v[104:107], v[212:215], v[48:63]
    ds_read_b128 v[96:99], v250 offset:6144
    v_mul_f32 v16, v16, v140
    v_mul_f32 v17, v17, v141
    v_mul_f32 v18, v18, v142
    v_mul_f32 v19, v19, v143
    v_cvt_pk_bf16_f32 v144, v16, v17
    v_mfma_f32_32x32x16_bf16 v[64:79], v[108:111], v[212:215], v[64:79]
    ds_read_b128 v[100:103], v250 offset:7168
    buffer_load_dwordx4 a[232:235], v255, s[24:27], s61 offen offset:2048 sc1
    v_cvt_pk_bf16_f32 v145, v18, v19
    v_mul_f32 v140, v20, v129
    v_mul_f32 v141, v21, v129
    s_waitcnt vmcnt(12) lgkmcnt(4)
    v_mfma_f32_32x32x16_bf16 v[48:63], v[80:83], v[216:219], v[48:63]
    ds_read_b128 v[104:107], v250 offset:9216
    v_mul_f32 v142, v22, v129
    v_mul_f32 v143, v23, v129
    v_exp_f32 v140, v140
    v_mul_f32 v20, v20, v28
    v_mfma_f32_32x32x16_bf16 v[64:79], v[84:87], v[216:219], v[64:79]
    ds_read_b128 v[108:111], v250 offset:10240
    buffer_load_dwordx4 a[236:239], v255, s[24:27], s61 offen offset:3072 sc1
    v_exp_f32 v141, v141
    v_mul_f32 v21, v21, v29
    s_waitcnt vmcnt(12) lgkmcnt(4)
    v_mfma_f32_32x32x16_bf16 v[48:63], v[88:91], v[220:223], v[48:63]
    ds_read_b128 v[80:83], v250 offset:12288
    v_exp_f32 v142, v142
    v_mul_f32 v22, v22, v30
    v_exp_f32 v143, v143
    v_mfma_f32_32x32x16_bf16 v[64:79], v[92:95], v[220:223], v[64:79]
    ds_read_b128 v[84:87], v250 offset:13312
    v_mul_f32 v23, v23, v31
    v_fma_f32 v140, v140, v128, v128
    v_fma_f32 v141, v141, v128, v128
    v_fma_f32 v142, v142, v128, v128
    s_waitcnt vmcnt(11) lgkmcnt(4)
    v_mfma_f32_32x32x16_bf16 v[48:63], v[96:99], v[224:227], v[48:63]
    ds_read_b128 v[88:91], v250 offset:15360
    s_add_u32 s61, s60, 61440
    buffer_load_dwordx4 a[240:243], v255, s[24:27], s61 offen offset:0 sc1
    v_fma_f32 v143, v143, v128, v128
    v_rcp_f32 v140, v140
    v_mfma_f32_32x32x16_bf16 v[64:79], v[100:103], v[224:227], v[64:79]
    ds_read_b128 v[92:95], v250 offset:16384
    v_rcp_f32 v141, v141
    v_rcp_f32 v142, v142
    s_waitcnt vmcnt(11) lgkmcnt(4)
    v_mfma_f32_32x32x16_bf16 v[48:63], v[104:107], v[228:231], v[48:63]
    ds_read_b128 v[96:99], v250 offset:18432
    buffer_load_dwordx4 a[244:247], v255, s[24:27], s61 offen offset:1024 sc1
    v_rcp_f32 v143, v143
    v_mul_f32 v20, v20, v140
    v_mul_f32 v21, v21, v141
    v_mfma_f32_32x32x16_bf16 v[64:79], v[108:111], v[228:231], v[64:79]
    ds_read_b128 v[100:103], v250 offset:19456
    v_mul_f32 v22, v22, v142
    v_mul_f32 v23, v23, v143
    v_cvt_pk_bf16_f32 v146, v20, v21
    v_cvt_pk_bf16_f32 v147, v22, v23
    s_waitcnt vmcnt(11) lgkmcnt(4)
    v_mfma_f32_32x32x16_bf16 v[48:63], v[80:83], v[232:235], v[48:63]
    ds_read_b128 v[104:107], v250 offset:21504
    buffer_load_dwordx4 a[248:251], v255, s[24:27], s61 offen offset:2048 sc1
    buffer_store_dwordx4 v[144:147], v255, s[24:27], s58 offen offset:1024 sc1
    v_mul_f32 v140, v32, v129
    v_mul_f32 v141, v33, v129
    v_mul_f32 v142, v34, v129
    v_mfma_f32_32x32x16_bf16 v[64:79], v[84:87], v[232:235], v[64:79]
    ds_read_b128 v[108:111], v250 offset:22528
    v_mul_f32 v143, v35, v129
    v_exp_f32 v140, v140
    v_mul_f32 v32, v32, v40
    s_waitcnt vmcnt(12) lgkmcnt(4)
    v_mfma_f32_32x32x16_bf16 v[48:63], v[88:91], v[236:239], v[48:63]
    ds_read_b128 v[80:83], v250 offset:24576
    v_exp_f32 v141, v141
    v_mul_f32 v33, v33, v41
    v_exp_f32 v142, v142
    v_mfma_f32_32x32x16_bf16 v[64:79], v[92:95], v[236:239], v[64:79]
    ds_read_b128 v[84:87], v250 offset:25600
    buffer_load_dwordx4 a[252:255], v255, s[24:27], s61 offen offset:3072 sc1
    v_mul_f32 v34, v34, v42
    v_exp_f32 v143, v143
    s_waitcnt vmcnt(11) lgkmcnt(4)
    v_mfma_f32_32x32x16_bf16 v[48:63], v[96:99], v[240:243], v[48:63]
    ds_read_b128 v[88:91], v250 offset:27648
    v_mul_f32 v35, v35, v43
    v_fma_f32 v140, v140, v128, v128
    v_fma_f32 v141, v141, v128, v128
    v_fma_f32 v142, v142, v128, v128
    v_fma_f32 v143, v143, v128, v128
    v_mfma_f32_32x32x16_bf16 v[64:79], v[100:103], v[240:243], v[64:79]
    ds_read_b128 v[92:95], v250 offset:28672
    buffer_load_dwordx4 a[24:27], v150, s[24:27], s83 offen offset:2048 sc1
    v_rcp_f32 v140, v140
    s_waitcnt vmcnt(10) lgkmcnt(4)
    v_mfma_f32_32x32x16_bf16 v[48:63], v[104:107], v[244:247], v[48:63]
    ds_read_b128 v[96:99], v250 offset:30720
    v_rcp_f32 v141, v141
    v_rcp_f32 v142, v142
    v_mfma_f32_32x32x16_bf16 v[64:79], v[108:111], v[244:247], v[64:79]
    ds_read_b128 v[100:103], v250 offset:31744
    buffer_load_dwordx4 a[28:31], v150, s[24:27], s84 offen offset:2048 sc1
    v_rcp_f32 v143, v143
    v_mul_f32 v32, v32, v140
    s_waitcnt vmcnt(10) lgkmcnt(4)
    v_mfma_f32_32x32x16_bf16 v[48:63], v[80:83], a[224:227], v[48:63]
    ds_read_b128 v[104:107], v250 offset:33792
    v_mul_f32 v33, v33, v141
    v_mul_f32 v34, v34, v142
    v_mul_f32 v35, v35, v143
    v_cvt_pk_bf16_f32 v144, v32, v33
    v_cvt_pk_bf16_f32 v145, v34, v35
    v_mfma_f32_32x32x16_bf16 v[64:79], v[84:87], a[224:227], v[64:79]
    ds_read_b128 v[108:111], v250 offset:34816
    s_add_u32 s83, s81, 8192
    buffer_load_dwordx4 a[32:35], v150, s[24:27], s83 offen offset:0 sc1
    v_mul_f32 v140, v36, v129
    v_mul_f32 v141, v37, v129
    s_waitcnt vmcnt(10) lgkmcnt(4)
    v_mfma_f32_32x32x16_bf16 v[48:63], v[88:91], a[228:231], v[48:63]
    ds_read_b128 v[80:83], v250 offset:36864
    v_mul_f32 v142, v38, v129
L_pad1:
    s_cbranch_execz L_pad5
    v_mul_f32 v143, v39, v129
    v_exp_f32 v140, v140
    v_mul_f32 v36, v36, v44
    v_mfma_f32_32x32x16_bf16 v[64:79], v[92:95], a[228:231], v[64:79]
    ds_read_b128 v[84:87], v250 offset:37888
    s_add_u32 s84, s82, 8192
    buffer_load_dwordx4 a[36:39], v150, s[24:27], s84 offen offset:0 sc1
    v_exp_f32 v141, v141
    s_waitcnt vmcnt(10) lgkmcnt(4)
    v_mfma_f32_32x32x16_bf16 v[48:63], v[96:99], a[232:235], v[48:63]
    ds_read_b128 v[88:91], v250 offset:39936
    v_mul_f32 v37, v37, v45
    v_exp_f32 v142, v142
    v_mul_f32 v38, v38, v46
    v_mfma_f32_32x32x16_bf16 v[64:79], v[100:103], a[232:235], v[64:79]
    ds_read_b128 v[92:95], v250 offset:40960
    v_exp_f32 v143, v143
    v_mul_f32 v39, v39, v47
    v_fma_f32 v140, v140, v128, v128
    s_waitcnt vmcnt(9) lgkmcnt(4)
    v_mfma_f32_32x32x16_bf16 v[48:63], v[104:107], a[236:239], v[48:63]
    ds_read_b128 v[96:99], v250 offset:43008
    buffer_load_dwordx4 a[40:43], v150, s[24:27], s83 offen offset:2048 sc1
    v_fma_f32 v141, v141, v128, v128
    v_fma_f32 v142, v142, v128, v128
    v_fma_f32 v143, v143, v128, v128
    v_mfma_f32_32x32x16_bf16 v[64:79], v[108:111], a[236:239], v[64:79]
    ds_read_b128 v[100:103], v250 offset:44032
    v_rcp_f32 v140, v140
    v_rcp_f32 v141, v141
    s_waitcnt vmcnt(9) lgkmcnt(4)
    v_mfma_f32_32x32x16_bf16 v[48:63], v[80:83], a[240:243], v[48:63]
    ds_read_b128 v[104:107], v250 offset:46080
    buffer_load_dwordx4 a[44:47], v150, s[24:27], s84 offen offset:2048 sc1
    v_rcp_f32 v142, v142
    v_rcp_f32 v143, v143
    v_mfma_f32_32x32x16_bf16 v[64:79], v[84:87], a[240:243], v[64:79]
    ds_read_b128 v[108:111], v250 offset:47104
    v_mul_f32 v36, v36, v140
    v_mul_f32 v37, v37, v141
    v_mul_f32 v38, v38, v142
    v_mul_f32 v39, v39, v143
    s_waitcnt vmcnt(9) lgkmcnt(4)
    v_mfma_f32_32x32x16_bf16 v[48:63], v[88:91], a[244:247], v[48:63]
    ds_read_b128 v[80:83], v255 offset:2048
    s_add_u32 s83, s81, 12288
    buffer_load_dwordx4 a[48:51], v150, s[24:27], s83 offen offset:0 sc1
    v_cvt_pk_bf16_f32 v146, v36, v37
    v_cvt_pk_bf16_f32 v147, v38, v39
    buffer_store_dwordx4 v[144:147], v255, s[24:27], s58 offen offset:2048 sc1
    v_mfma_f32_32x32x16_bf16 v[64:79], v[92:95], a[244:247], v[64:79]
    ds_read_b128 v[84:87], v255 offset:5120
    s_waitcnt vmcnt(10) lgkmcnt(4)
    v_mfma_f32_32x32x16_bf16 v[48:63], v[96:99], a[248:251], v[48:63]
    ds_read_b128 v[88:91], v255 offset:8192
    v_mfma_f32_32x32x16_bf16 v[64:79], v[100:103], a[248:251], v[64:79]
    ds_read_b128 v[92:95], v255 offset:11264
    s_add_u32 s84, s82, 12288
    buffer_load_dwordx4 a[52:55], v150, s[24:27], s84 offen offset:0 sc1
    s_waitcnt vmcnt(9) lgkmcnt(4)
    v_mfma_f32_32x32x16_bf16 v[48:63], v[104:107], a[252:255], v[48:63]
    ds_read_b128 v[96:99], v255 offset:14336
    v_mfma_f32_32x32x16_bf16 v[48:63], a[208:211], v[136:139], v[48:63]
    v_mfma_f32_32x32x16_bf16 v[64:79], v[108:111], a[252:255], v[64:79]
    ds_read_b128 v[100:103], v255 offset:17408
    buffer_load_dwordx4 a[56:59], v150, s[24:27], s83 offen offset:2048 sc1
    v_mfma_f32_32x32x16_bf16 v[64:79], a[212:215], v[136:139], v[64:79]
    s_waitcnt lgkmcnt(4)
    v_mfma_f32_32x32x16_bf16 v[0:15], v[80:83], v[152:155], 0
    ds_read_b128 v[104:107], v255 offset:20480
    v_mfma_f32_32x32x16_bf16 v[0:15], v[84:87], v[156:159], v[0:15]
    ds_read_b128 v[108:111], v255 offset:23552
    buffer_load_dwordx4 a[60:63], v150, s[24:27], s84 offen offset:2048 sc1
    s_waitcnt lgkmcnt(4)
    v_mfma_f32_32x32x16_bf16 v[0:15], v[88:91], v[160:163], v[0:15]
    ds_read_b128 v[80:83], v255 offset:26624
    v_mul_f32 v140, v48, v131
    v_mul_f32 v141, v49, v131
    v_mul_f32 v142, v50, v131
    v_mul_f32 v143, v51, v131
    v_mfma_f32_32x32x16_bf16 v[0:15], v[92:95], v[164:167], v[0:15]
    ds_read_b128 v[84:87], v255 offset:29696
    v_exp_f32 v140, v140
    v_mul_f32 v48, v48, v56
    s_waitcnt lgkmcnt(4)
    v_mfma_f32_32x32x16_bf16 v[0:15], v[96:99], v[168:171], v[0:15]
    ds_read_b128 v[88:91], v255 offset:32768
    s_add_u32 s83, s81, 16384
    buffer_load_dwordx4 a[64:67], v150, s[24:27], s83 offen offset:0 sc1
    v_exp_f32 v141, v141
    v_mul_f32 v49, v49, v57
    v_mfma_f32_32x32x16_bf16 v[0:15], v[100:103], v[172:175], v[0:15]
    ds_read_b128 v[92:95], v255 offset:35840
    v_exp_f32 v142, v142
    v_mul_f32 v50, v50, v58
    s_waitcnt lgkmcnt(4)
    v_mfma_f32_32x32x16_bf16 v[0:15], v[104:107], v[176:179], v[0:15]
    ds_read_b128 v[96:99], v255 offset:38912
    s_add_u32 s84, s82, 16384
    buffer_load_dwordx4 a[68:71], v150, s[24:27], s84 offen offset:0 sc1
    v_exp_f32 v143, v143
    v_mul_f32 v51, v51, v59
    v_mfma_f32_32x32x16_bf16 v[0:15], v[108:111], v[180:183], v[0:15]
    ds_read_b128 v[100:103], v255 offset:41984
    v_fma_f32 v140, v140, v130, v130
    v_fma_f32 v141, v141, v130, v130
    v_fma_f32 v142, v142, v130, v130
    v_fma_f32 v143, v143, v130, v130
    s_waitcnt lgkmcnt(4)
    v_mfma_f32_32x32x16_bf16 v[0:15], v[80:83], v[184:187], v[0:15]
    ds_read_b128 v[104:107], v255 offset:45056
    buffer_load_dwordx4 a[72:75], v150, s[24:27], s83 offen offset:2048 sc1
    v_rcp_f32 v140, v140
    v_rcp_f32 v141, v141
    v_mfma_f32_32x32x16_bf16 v[0:15], v[84:87], v[188:191], v[0:15]
    ds_read_b128 v[108:111], v255 offset:48128
    v_rcp_f32 v142, v142
    v_rcp_f32 v143, v143
    s_waitcnt lgkmcnt(4)
    v_mfma_f32_32x32x16_bf16 v[0:15], v[88:91], v[192:195], v[0:15]
    ds_read_b128 v[80:83], v250 offset:2048
    buffer_load_dwordx4 a[76:79], v150, s[24:27], s84 offen offset:2048 sc1
    v_mul_f32 v48, v48, v140
    v_mul_f32 v49, v49, v141
    v_mul_f32 v50, v50, v142
    v_mul_f32 v51, v51, v143
    v_mfma_f32_32x32x16_bf16 v[0:15], v[92:95], v[196:199], v[0:15]
    ds_read_b128 v[84:87], v250 offset:5120
    v_cvt_pk_bf16_f32 v120, v48, v49
    v_cvt_pk_bf16_f32 v121, v50, v51
    v_mul_f32 v140, v52, v131
    v_mul_f32 v141, v53, v131
    s_waitcnt lgkmcnt(4)
    v_mfma_f32_32x32x16_bf16 v[0:15], v[96:99], v[200:203], v[0:15]
    ds_read_b128 v[88:91], v250 offset:8192
    v_mul_f32 v142, v54, v131
    v_mul_f32 v143, v55, v131
    v_exp_f32 v140, v140
    v_mul_f32 v52, v52, v60
    v_mfma_f32_32x32x16_bf16 v[0:15], v[100:103], v[204:207], v[0:15]
    ds_read_b128 v[92:95], v250 offset:11264
    s_add_u32 s83, s81, 20480
    buffer_load_dwordx4 a[80:83], v150, s[24:27], s83 offen offset:0 sc1
    v_exp_f32 v141, v141
    s_waitcnt lgkmcnt(4)
    v_mfma_f32_32x32x16_bf16 v[0:15], v[104:107], v[208:211], v[0:15]
    ds_read_b128 v[96:99], v250 offset:14336
    v_mul_f32 v53, v53, v61
    v_exp_f32 v142, v142
    v_mul_f32 v54, v54, v62
    v_mfma_f32_32x32x16_bf16 v[0:15], v[108:111], v[212:215], v[0:15]
    ds_read_b128 v[100:103], v250 offset:17408
    s_add_u32 s84, s82, 20480
    buffer_load_dwordx4 a[84:87], v150, s[24:27], s84 offen offset:0 sc1
    v_exp_f32 v143, v143
    s_waitcnt lgkmcnt(4)
    v_mfma_f32_32x32x16_bf16 v[0:15], v[80:83], v[216:219], v[0:15]
    ds_read_b128 v[104:107], v250 offset:20480
    v_mul_f32 v55, v55, v63
    v_fma_f32 v140, v140, v130, v130
    v_fma_f32 v141, v141, v130, v130
    v_fma_f32 v142, v142, v130, v130
    v_fma_f32 v143, v143, v130, v130
    v_mfma_f32_32x32x16_bf16 v[0:15], v[84:87], v[220:223], v[0:15]
    ds_read_b128 v[108:111], v250 offset:23552
    buffer_load_dwordx4 a[88:91], v150, s[24:27], s83 offen offset:2048 sc1
    v_rcp_f32 v140, v140
    s_waitcnt lgkmcnt(4)
    v_mfma_f32_32x32x16_bf16 v[0:15], v[88:91], v[224:227], v[0:15]
    ds_read_b128 v[80:83], v250 offset:26624
    s_add_u32 s56, s32, 2
    v_mov_b32 v112, s56
    v_mov_b32 v113, s33
    s_cmp_lg_u32 s40, 0
    s_waitcnt vmcnt(10)
    s_barrier
    s_cbranch_scc1 L_interleave_layers__spectral_fnet__swiglu_ffn__prompt_pb_3_slow
    buffer_store_dwordx2 v[112:113], v249, s[24:27], 0 offen
L_interleave_layers__spectral_fnet__swiglu_ffn__prompt_pb_3_back:
    v_mfma_f32_32x32x16_bf16 v[0:15], v[92:95], v[228:231], v[0:15]
    ds_read_b128 v[84:87], v250 offset:29696
    v_rcp_f32 v141, v141
    v_rcp_f32 v142, v142
    s_waitcnt lgkmcnt(4)
    v_mfma_f32_32x32x16_bf16 v[0:15], v[96:99], v[232:235], v[0:15]
    ds_read_b128 v[88:91], v250 offset:32768
    buffer_load_dwordx4 a[92:95], v150, s[24:27], s84 offen offset:2048 sc1
    v_rcp_f32 v143, v143
    v_mul_f32 v52, v52, v140
    v_mul_f32 v53, v53, v141
    v_mfma_f32_32x32x16_bf16 v[0:15], v[100:103], v[236:239], v[0:15]
    ds_read_b128 v[92:95], v250 offset:35840
    v_mul_f32 v54, v54, v142
    v_mul_f32 v55, v55, v143
    v_cvt_pk_bf16_f32 v122, v52, v53
    v_cvt_pk_bf16_f32 v123, v54, v55
    s_waitcnt lgkmcnt(4)
    v_mfma_f32_32x32x16_bf16 v[0:15], v[104:107], v[240:243], v[0:15]
    ds_read_b128 v[96:99], v250 offset:38912
    s_add_u32 s83, s81, 24576
    buffer_load_dwordx4 a[96:99], v150, s[24:27], s83 offen offset:0 sc1
    buffer_store_dwordx4 v[120:123], v255, s[24:27], s59 offen offset:0 sc1
    v_mul_f32 v140, v64, v131
    v_mul_f32 v141, v65, v131
    v_mfma_f32_32x32x16_bf16 v[0:15], v[108:111], v[244:247], v[0:15]
    ds_read_b128 v[100:103], v250 offset:41984
    v_mul_f32 v142, v66, v131
    v_mul_f32 v143, v67, v131
    v_exp_f32 v140, v140
    s_waitcnt lgkmcnt(4)
    v_mfma_f32_32x32x16_bf16 v[0:15], v[80:83], a[224:227], v[0:15]
    ds_read_b128 v[104:107], v250 offset:45056
    s_add_u32 s84, s82, 24576
    buffer_load_dwordx4 a[100:103], v150, s[24:27], s84 offen offset:0 sc1
    v_mul_f32 v64, v64, v72
    v_exp_f32 v141, v141
    v_mfma_f32_32x32x16_bf16 v[0:15], v[84:87], a[228:231], v[0:15]
    ds_read_b128 v[108:111], v250 offset:48128
    v_mul_f32 v65, v65, v73
    v_exp_f32 v142, v142
    v_mul_f32 v66, v66, v74
    s_waitcnt lgkmcnt(4)
    v_mfma_f32_32x32x16_bf16 v[0:15], v[88:91], a[232:235], v[0:15]
    v_exp_f32 v143, v143
    v_mul_f32 v67, v67, v75
    v_fma_f32 v140, v140, v130, v130
    v_fma_f32 v141, v141, v130, v130
    v_fma_f32 v142, v142, v130, v130
    v_mfma_f32_32x32x16_bf16 v[0:15], v[92:95], a[236:239], v[0:15]
    buffer_load_dwordx4 a[104:107], v150, s[24:27], s83 offen offset:2048 sc1
    v_fma_f32 v143, v143, v130, v130
    v_rcp_f32 v140, v140
    s_waitcnt lgkmcnt(2)
    v_mfma_f32_32x32x16_bf16 v[0:15], v[96:99], a[240:243], v[0:15]
    v_rcp_f32 v141, v141
    v_rcp_f32 v142, v142
    v_rcp_f32 v143, v143
    v_mfma_f32_32x32x16_bf16 v[0:15], v[100:103], a[244:247], v[0:15]
    buffer_load_dwordx4 a[108:111], v150, s[24:27], s84 offen offset:2048 sc1
    v_mul_f32 v64, v64, v140
    v_mul_f32 v65, v65, v141
    v_mul_f32 v66, v66, v142
    v_mul_f32 v67, v67, v143
    s_waitcnt lgkmcnt(0)
    v_mfma_f32_32x32x16_bf16 v[0:15], v[104:107], a[248:251], v[0:15]
    v_cvt_pk_bf16_f32 v124, v64, v65
    v_cvt_pk_bf16_f32 v125, v66, v67
    v_mul_f32 v140, v68, v131
    v_mul_f32 v141, v69, v131
    v_mul_f32 v142, v70, v131
    v_mul_f32 v143, v71, v131
    v_mfma_f32_32x32x16_bf16 v[0:15], v[108:111], a[252:255], v[0:15]
    s_add_u32 s83, s81, 28672
    buffer_load_dwordx4 a[112:115], v150, s[24:27], s83 offen offset:0 sc1
    v_mfma_f32_32x32x16_bf16 v[0:15], a[216:219], v[136:139], v[0:15]
    v_exp_f32 v140, v140
L_idle0_back:
    s_add_u32 s84, s82, 28672
    buffer_load_dwordx4 a[116:119], v150, s[24:27], s84 offen offset:0 sc1
    v_mul_f32 v68, v68, v76
    v_exp_f32 v141, v141
    v_mul_f32 v69, v69, v77
    v_exp_f32 v142, v142
    v_mul_f32 v70, v70, v78
    v_exp_f32 v143, v143
    v_mul_f32 v71, v71, v79
    v_fma_f32 v140, v140, v130, v130
    v_fma_f32 v141, v141, v130, v130
    buffer_load_dwordx4 a[120:123], v150, s[24:27], s83 offen offset:2048 sc1
    v_fma_f32 v142, v142, v130, v130
    v_fma_f32 v143, v143, v130, v130
    v_rcp_f32 v140, v140
    v_rcp_f32 v141, v141
    v_rcp_f32 v142, v142
    v_rcp_f32 v143, v143
    v_mul_f32 v68, v68, v140
    v_mul_f32 v69, v69, v141
    buffer_load_dwordx4 a[124:127], v150, s[24:27], s84 offen offset:2048 sc1
    v_mul_f32 v70, v70, v142
    v_mul_f32 v71, v71, v143
    v_cvt_pk_bf16_f32 v126, v68, v69
    v_cvt_pk_bf16_f32 v127, v70, v71
    buffer_store_dwordx4 v[124:127], v255, s[24:27], s59 offen offset:1024 sc1
    v_pk_mul_f32 v[140:141], v[0:1], v[130:131] op_sel:[0,1] op_sel_hi:[1,1]
    v_pk_mul_f32 v[142:143], v[2:3], v[130:131] op_sel:[0,1] op_sel_hi:[1,1]
    v_exp_f32 v140, v140
    v_exp_f32 v141, v141
    s_add_u32 s83, s81, 32768
    buffer_load_dwordx4 a[128:131], v150, s[24:27], s83 offen offset:0 sc1
    v_exp_f32 v142, v142
    v_exp_f32 v143, v143
    v_pk_mul_f32 v[0:1], v[0:1], v[8:9]
    v_pk_mul_f32 v[2:3], v[2:3], v[10:11]
    v_pk_fma_f32 v[140:141], v[140:141], v[130:131], v[130:131] op_sel:[0,0,0] op_sel_hi:[1,0,0]
    v_pk_fma_f32 v[142:143], v[142:143], v[130:131], v[130:131] op_sel:[0,0,0] op_sel_hi:[1,0,0]
    v_rcp_f32 v140, v140
    v_rcp_f32 v141, v141
    s_add_u32 s84, s82, 32768
    buffer_load_dwordx4 a[132:135], v150, s[24:27], s84 offen offset:0 sc1
    v_rcp_f32 v142, v142
    v_rcp_f32 v143, v143
    v_pk_mul_f32 v[0:1], v[0:1], v[140:141]
    v_pk_mul_f32 v[2:3], v[2:3], v[142:143]
    v_cvt_pk_bf16_f32 v144, v0, v1
    v_cvt_pk_bf16_f32 v145, v2, v3
    v_pk_mul_f32 v[140:141], v[4:5], v[130:131] op_sel:[0,1] op_sel_hi:[1,1]
    v_pk_mul_f32 v[142:143], v[6:7], v[130:131] op_sel:[0,1] op_sel_hi:[1,1]
    v_exp_f32 v140, v140
    buffer_load_dwordx4 a[136:139], v150, s[24:27], s83 offen offset:2048 sc1
    v_exp_f32 v141, v141
    v_exp_f32 v142, v142
    v_exp_f32 v143, v143
    v_pk_mul_f32 v[4:5], v[4:5], v[12:13]
    v_pk_mul_f32 v[6:7], v[6:7], v[14:15]
    v_pk_fma_f32 v[140:141], v[140:141], v[130:131], v[130:131] op_sel:[0,0,0] op_sel_hi:[1,0,0]
    v_pk_fma_f32 v[142:143], v[142:143], v[130:131], v[130:131] op_sel:[0,0,0] op_sel_hi:[1,0,0]
    v_rcp_f32 v140, v140
    buffer_load_dwordx4 a[140:143], v150, s[24:27], s84 offen offset:2048 sc1
    v_rcp_f32 v141, v141
    v_rcp_f32 v142, v142
    v_rcp_f32 v143, v143
    v_pk_mul_f32 v[4:5], v[4:5], v[140:141]
    v_pk_mul_f32 v[6:7], v[6:7], v[142:143]
    v_cvt_pk_bf16_f32 v146, v4, v5
    v_cvt_pk_bf16_f32 v147, v6, v7
    buffer_store_dwordx4 v[144:147], v255, s[24:27], s59 offen offset:2048 sc1
    v_lshl_add_u32 v114, v254, 3, s46
    s_andn2_b32 s71, 1073741824, s72
    buffer_load_dwordx2 v[116:117], v114, s[24:27], s71 offen sc1
    s_add_u32 s83, s81, 36864
    buffer_load_dwordx4 a[144:147], v150, s[24:27], s83 offen offset:0 sc1
    s_lshl_b32 s68, s38, 5
    v_add_u32 v8, s68, v254
    v_cmp_eq_u32 vcc, 0, v8
    v_mov_b32 v9, 256
    s_lshl_b32 s68, s34, 4
    v_cndmask_b32 v8, v8, v9, vcc
    v_add_u32 v9, s68, v253
    v_cvt_f32_u32 v8, v8
    v_cvt_f32_u32 v9, v9
    v_mul_f32 v8, 0xbb000000, v8
    v_mul_f32 v9, 0x41000000, v9
    s_lshr_b32 s68, s34, 1
    v_mul_f32 v9, v8, v9
    v_cvt_f32_u32 v11, s68
    v_fract_f32 v9, v9
    v_mul_f32 v11, 0x3e800000, v11
    s_add_u32 s84, s82, 36864
    buffer_load_dwordx4 a[148:151], v150, s[24:27], s84 offen offset:0 sc1
    v_sub_f32 v10, v9, v11
    v_add_f32 v11, v9, v11
    v_add_f32 v11, 0xbe800000, v11
    s_lshl_b32 s68, s68, 31
    s_xor_b32 s68, s68, 0x41800000
    v_mul_f32 v29, s68, v8
    v_mov_b32 v12, v10
    v_mov_b32 v20, v11
    v_cos_f32 v28, v29
    v_sin_f32 v29, v29
    v_add_f32 v13, v8, v12
    v_add_f32 v21, v8, v20
    v_add_f32 v14, v8, v13
    v_add_f32 v22, v8, v21
    buffer_load_dwordx4 a[152:155], v150, s[24:27], s83 offen offset:2048 sc1
    v_add_f32 v15, v8, v14
    v_add_f32 v23, v8, v22
    v_add_f32 v16, v8, v15
    v_add_f32 v24, v8, v23
    v_add_f32 v17, v8, v16
    v_add_f32 v25, v8, v24
    v_add_f32 v18, v8, v17
    v_add_f32 v26, v8, v25
    v_add_f32 v19, v8, v18
    v_add_f32 v27, v8, v26
    v_cos_f32 v12, v12
    v_cos_f32 v13, v13
    v_cos_f32 v14, v14
    buffer_load_dwordx4 a[156:159], v150, s[24:27], s84 offen offset:2048 sc1
    v_cos_f32 v15, v15
    v_cos_f32 v16, v16
    v_cos_f32 v17, v17
    v_cos_f32 v18, v18
    v_cos_f32 v19, v19
    v_cos_f32 v20, v20
    v_cos_f32 v21, v21
    v_cos_f32 v22, v22
    s_add_u32 s83, s81, 40960
    buffer_load_dwordx4 a[160:163], v150, s[24:27], s83 offen offset:0 sc1
    v_cos_f32 v23, v23
    v_cos_f32 v24, v24
    v_cos_f32 v25, v25
    v_cos_f32 v26, v26
    v_cos_f32 v27, v27
    v_pk_mov_b32 v[48:49], v[12:13], v[12:13] op_sel:[0,1]
    v_pk_mov_b32 v[50:51], v[14:15], v[14:15] op_sel:[0,1]
    v_pk_mov_b32 v[52:53], v[16:17], v[16:17] op_sel:[0,1]
    v_pk_mov_b32 v[54:55], v[18:19], v[18:19] op_sel:[0,1]
    v_pk_mov_b32 v[56:57], v[20:21], v[20:21] op_sel:[0,1]
    v_pk_mov_b32 v[58:59], v[22:23], v[22:23] op_sel:[0,1]
    s_add_u32 s84, s82, 40960
    buffer_load_dwordx4 a[164:167], v150, s[24:27], s84 offen offset:0 sc1
    v_pk_mov_b32 v[60:61], v[24:25], v[24:25] op_sel:[0,1]
    v_pk_mov_b32 v[62:63], v[26:27], v[26:27] op_sel:[0,1]
    v_pk_mul_f32 v[32:33], v[56:57], v[28:29] op_sel:[0,1] op_sel_hi:[1,1]
    v_pk_mul_f32 v[34:35], v[48:49], v[28:29] op_sel:[0,1] op_sel_hi:[1,1]
    v_pk_fma_f32 v[48:49], v[48:49], v[28:29], v[32:33] op_sel_hi:[1,0,1] neg_lo:[0,0,1] neg_hi:[0,0,1]
    v_pk_fma_f32 v[56:57], v[56:57], v[28:29], v[34:35] op_sel_hi:[1,0,1]
    v_pk_mul_f32 v[36:37], v[58:59], v[28:29] op_sel:[0,1] op_sel_hi:[1,1]
    v_pk_mul_f32 v[38:39], v[50:51], v[28:29] op_sel:[0,1] op_sel_hi:[1,1]
    v_pk_fma_f32 v[50:51], v[50:51], v[28:29], v[36:37] op_sel_hi:[1,0,1] neg_lo:[0,0,1] neg_hi:[0,0,1]
    v_pk_fma_f32 v[58:59], v[58:59], v[28:29], v[38:39] op_sel_hi:[1,0,1]
    v_pk_mul_f32 v[32:33], v[60:61], v[28:29] op_sel:[0,1] op_sel_hi:[1,1]
    v_pk_mul_f32 v[34:35], v[52:53], v[28:29] op_sel:[0,1] op_sel_hi:[1,1]
    v_pk_fma_f32 v[52:53], v[52:53], v[28:29], v[32:33] op_sel_hi:[1,0,1] neg_lo:[0,0,1] neg_hi:[0,0,1]
    v_pk_fma_f32 v[60:61], v[60:61], v[28:29], v[34:35] op_sel_hi:[1,0,1]
    v_pk_mul_f32 v[36:37], v[62:63], v[28:29] op_sel:[0,1] op_sel_hi:[1,1]
    v_pk_mul_f32 v[38:39], v[54:55], v[28:29] op_sel:[0,1] op_sel_hi:[1,1]
    buffer_load_dwordx4 a[168:171], v150, s[24:27], s83 offen offset:2048 sc1
    v_pk_fma_f32 v[54:55], v[54:55], v[28:29], v[36:37] op_sel_hi:[1,0,1] neg_lo:[0,0,1] neg_hi:[0,0,1]
    v_pk_fma_f32 v[62:63], v[62:63], v[28:29], v[38:39] op_sel_hi:[1,0,1]
    v_add_f32 v28, v28, v28
    v_cvt_pk_bf16_f32 v184, v12, v13
    v_cvt_pk_bf16_f32 v185, v14, v15
    v_cvt_pk_bf16_f32 v186, v16, v17
    v_cvt_pk_bf16_f32 v187, v18, v19
    v_cvt_pk_bf16_f32 v216, v20, v21
    v_cvt_pk_bf16_f32 v217, v22, v23
    v_cvt_pk_bf16_f32 v218, v24, v25
    v_cvt_pk_bf16_f32 v219, v26, v27
    v_pk_fma_f32 v[12:13], v[48:49], v[28:29], v[12:13] op_sel_hi:[1,0,1] neg_lo:[0,0,1] neg_hi:[0,0,1]
    v_pk_fma_f32 v[14:15], v[50:51], v[28:29], v[14:15] op_sel_hi:[1,0,1] neg_lo:[0,0,1] neg_hi:[0,0,1]
    v_pk_fma_f32 v[16:17], v[52:53], v[28:29], v[16:17] op_sel_hi:[1,0,1] neg_lo:[0,0,1] neg_hi:[0,0,1]
    v_pk_fma_f32 v[18:19], v[54:55], v[28:29], v[18:19] op_sel_hi:[1,0,1] neg_lo:[0,0,1] neg_hi:[0,0,1]
    v_pk_fma_f32 v[20:21], v[56:57], v[28:29], v[20:21] op_sel_hi:[1,0,1] neg_lo:[0,0,1] neg_hi:[0,0,1]
    buffer_load_dwordx4 a[172:175], v150, s[24:27], s84 offen offset:2048 sc1
    s_add_u32 s56, s32, 3
    v_mov_b32 v132, s56
    v_mov_b32 v133, s33
    s_add_u32 s70, s32, 2
    s_waitcnt vmcnt(8)
    v_subrev_u32 v116, s70, v116
    v_xor_b32 v117, s33, v117
    v_lshrrev_b32 v116, 3, v116
    v_or_b32 v116, v116, v117
    v_cmp_ne_u32 vcc, 0, v116
    s_nop 0
    s_or_b32 vcc_lo, vcc_lo, s40
    s_and_b64 vcc, vcc, s[72:73]
    s_cbranch_vccnz L_interleave_layers__spectral_fnet__swiglu_ffn__prompt_cf_4_retry
L_interleave_layers__spectral_fnet__swiglu_ffn__prompt_cf_4_ok:
    s_cmp_lg_u32 s40, 0
    s_barrier
    s_cbranch_scc1 L_interleave_layers__spectral_fnet__swiglu_ffn__prompt_pb_5_slow
    buffer_store_dwordx2 v[132:133], v249, s[24:27], 0 offen
L_interleave_layers__spectral_fnet__swiglu_ffn__prompt_pb_5_back:
    s_add_u32 s53, s48, 0
    buffer_load_dwordx4 v[80:83], v255, s[24:27], s53 offen offset:0 sc1
    v_pk_fma_f32 v[22:23], v[58:59], v[28:29], v[22:23] op_sel_hi:[1,0,1] neg_lo:[0,0,1] neg_hi:[0,0,1]
    v_pk_fma_f32 v[24:25], v[60:61], v[28:29], v[24:25] op_sel_hi:[1,0,1] neg_lo:[0,0,1] neg_hi:[0,0,1]
    v_pk_fma_f32 v[26:27], v[62:63], v[28:29], v[26:27] op_sel_hi:[1,0,1] neg_lo:[0,0,1] neg_hi:[0,0,1]
    v_cvt_pk_bf16_f32 v188, v48, v49
    v_cvt_pk_bf16_f32 v189, v50, v51
    v_cvt_pk_bf16_f32 v190, v52, v53
    v_cvt_pk_bf16_f32 v191, v54, v55
    v_cvt_pk_bf16_f32 v220, v56, v57
    v_cvt_pk_bf16_f32 v221, v58, v59
    v_cvt_pk_bf16_f32 v222, v60, v61
    v_cvt_pk_bf16_f32 v223, v62, v63
    v_pk_fma_f32 v[48:49], v[12:13], v[28:29], v[48:49] op_sel_hi:[1,0,1] neg_lo:[0,0,1] neg_hi:[0,0,1]
    buffer_load_dwordx4 v[84:87], v255, s[24:27], s53 offen offset:1024 sc1
    v_pk_fma_f32 v[50:51], v[14:15], v[28:29], v[50:51] op_sel_hi:[1,0,1] neg_lo:[0,0,1] neg_hi:[0,0,1]
    v_pk_fma_f32 v[52:53], v[16:17], v[28:29], v[52:53] op_sel_hi:[1,0,1] neg_lo:[0,0,1] neg_hi:[0,0,1]
    v_pk_fma_f32 v[54:55], v[18:19], v[28:29], v[54:55] op_sel_hi:[1,0,1] neg_lo:[0,0,1] neg_hi:[0,0,1]
    v_pk_fma_f32 v[56:57], v[20:21], v[28:29], v[56:57] op_sel_hi:[1,0,1] neg_lo:[0,0,1] neg_hi:[0,0,1]
    v_pk_fma_f32 v[58:59], v[22:23], v[28:29], v[58:59] op_sel_hi:[1,0,1] neg_lo:[0,0,1] neg_hi:[0,0,1]
    v_pk_fma_f32 v[60:61], v[24:25], v[28:29], v[60:61] op_sel_hi:[1,0,1] neg_lo:[0,0,1] neg_hi:[0,0,1]
    v_pk_fma_f32 v[62:63], v[26:27], v[28:29], v[62:63] op_sel_hi:[1,0,1] neg_lo:[0,0,1] neg_hi:[0,0,1]
    v_cvt_pk_bf16_f32 v192, v12, v13
    v_cvt_pk_bf16_f32 v193, v14, v15
    v_cvt_pk_bf16_f32 v194, v16, v17
    v_cvt_pk_bf16_f32 v195, v18, v19
    v_cvt_pk_bf16_f32 v224, v20, v21
    buffer_load_dwordx4 v[88:91], v255, s[24:27], s53 offen offset:2048 sc1
    v_cvt_pk_bf16_f32 v225, v22, v23
    v_cvt_pk_bf16_f32 v226, v24, v25
    v_cvt_pk_bf16_f32 v227, v26, v27
    v_pk_fma_f32 v[12:13], v[48:49], v[28:29], v[12:13] op_sel_hi:[1,0,1] neg_lo:[0,0,1] neg_hi:[0,0,1]
    v_pk_fma_f32 v[14:15], v[50:51], v[28:29], v[14:15] op_sel_hi:[1,0,1] neg_lo:[0,0,1] neg_hi:[0,0,1]
    v_pk_fma_f32 v[16:17], v[52:53], v[28:29], v[16:17] op_sel_hi:[1,0,1] neg_lo:[0,0,1] neg_hi:[0,0,1]
    v_pk_fma_f32 v[18:19], v[54:55], v[28:29], v[18:19] op_sel_hi:[1,0,1] neg_lo:[0,0,1] neg_hi:[0,0,1]
    v_pk_fma_f32 v[20:21], v[56:57], v[28:29], v[20:21] op_sel_hi:[1,0,1] neg_lo:[0,0,1] neg_hi:[0,0,1]
    v_pk_fma_f32 v[22:23], v[58:59], v[28:29], v[22:23] op_sel_hi:[1,0,1] neg_lo:[0,0,1] neg_hi:[0,0,1]
    v_pk_fma_f32 v[24:25], v[60:61], v[28:29], v[24:25] op_sel_hi:[1,0,1] neg_lo:[0,0,1] neg_hi:[0,0,1]
    v_pk_fma_f32 v[26:27], v[62:63], v[28:29], v[26:27] op_sel_hi:[1,0,1] neg_lo:[0,0,1] neg_hi:[0,0,1]
    v_cvt_pk_bf16_f32 v196, v48, v49
    buffer_load_dwordx4 v[92:95], v255, s[24:27], s53 offen offset:3072 sc1
    v_cvt_pk_bf16_f32 v197, v50, v51
    v_cvt_pk_bf16_f32 v198, v52, v53
    v_cvt_pk_bf16_f32 v199, v54, v55
    v_cvt_pk_bf16_f32 v228, v56, v57
    v_cvt_pk_bf16_f32 v229, v58, v59
    v_cvt_pk_bf16_f32 v230, v60, v61
    v_cvt_pk_bf16_f32 v231, v62, v63
    v_pk_fma_f32 v[48:49], v[12:13], v[28:29], v[48:49] op_sel_hi:[1,0,1] neg_lo:[0,0,1] neg_hi:[0,0,1]
    v_pk_fma_f32 v[50:51], v[14:15], v[28:29], v[50:51] op_sel_hi:[1,0,1] neg_lo:[0,0,1] neg_hi:[0,0,1]
    v_pk_fma_f32 v[52:53], v[16:17], v[28:29], v[52:53] op_sel_hi:[1,0,1] neg_lo:[0,0,1] neg_hi:[0,0,1]
    v_pk_fma_f32 v[54:55], v[18:19], v[28:29], v[54:55] op_sel_hi:[1,0,1] neg_lo:[0,0,1] neg_hi:[0,0,1]
    v_pk_fma_f32 v[56:57], v[20:21], v[28:29], v[56:57] op_sel_hi:[1,0,1] neg_lo:[0,0,1] neg_hi:[0,0,1]
    s_add_u32 s53, s48, 4096
    buffer_load_dwordx4 v[96:99], v255, s[24:27], s53 offen offset:0 sc1
    v_pk_fma_f32 v[58:59], v[22:23], v[28:29], v[58:59] op_sel_hi:[1,0,1] neg_lo:[0,0,1] neg_hi:[0,0,1]
    v_pk_fma_f32 v[60:61], v[24:25], v[28:29], v[60:61] op_sel_hi:[1,0,1] neg_lo:[0,0,1] neg_hi:[0,0,1]
    v_pk_fma_f32 v[62:63], v[26:27], v[28:29], v[62:63] op_sel_hi:[1,0,1] neg_lo:[0,0,1] neg_hi:[0,0,1]
    v_cvt_pk_bf16_f32 v200, v12, v13
    v_cvt_pk_bf16_f32 v201, v14, v15
    v_cvt_pk_bf16_f32 v202, v16, v17
    v_cvt_pk_bf16_f32 v203, v18, v19
    v_cvt_pk_bf16_f32 v232, v20, v21
    v_cvt_pk_bf16_f32 v233, v22, v23
    v_cvt_pk_bf16_f32 v234, v24, v25
    v_cvt_pk_bf16_f32 v235, v26, v27
    v_pk_fma_f32 v[12:13], v[48:49], v[28:29], v[12:13] op_sel_hi:[1,0,1] neg_lo:[0,0,1] neg_hi:[0,0,1]
    buffer_load_dwordx4 v[100:103], v255, s[24:27], s53 offen offset:1024 sc1
    v_pk_fma_f32 v[14:15], v[50:51], v[28:29], v[14:15] op_sel_hi:[1,0,1] neg_lo:[0,0,1] neg_hi:[0,0,1]
    v_pk_fma_f32 v[16:17], v[52:53], v[28:29], v[16:17] op_sel_hi:[1,0,1] neg_lo:[0,0,1] neg_hi:[0,0,1]
    v_pk_fma_f32 v[18:19], v[54:55], v[28:29], v[18:19] op_sel_hi:[1,0,1] neg_lo:[0,0,1] neg_hi:[0,0,1]
    v_pk_fma_f32 v[20:21], v[56:57], v[28:29], v[20:21] op_sel_hi:[1,0,1] neg_lo:[0,0,1] neg_hi:[0,0,1]
    v_pk_fma_f32 v[22:23], v[58:59], v[28:29], v[22:23] op_sel_hi:[1,0,1] neg_lo:[0,0,1] neg_hi:[0,0,1]
    v_pk_fma_f32 v[24:25], v[60:61], v[28:29], v[24:25] op_sel_hi:[1,0,1] neg_lo:[0,0,1] neg_hi:[0,0,1]
    v_pk_fma_f32 v[26:27], v[62:63], v[28:29], v[26:27] op_sel_hi:[1,0,1] neg_lo:[0,0,1] neg_hi:[0,0,1]
    v_cvt_pk_bf16_f32 v204, v48, v49
    v_cvt_pk_bf16_f32 v205, v50, v51
    v_cvt_pk_bf16_f32 v206, v52, v53
    v_cvt_pk_bf16_f32 v207, v54, v55
    v_cvt_pk_bf16_f32 v236, v56, v57
    buffer_load_dwordx4 v[104:107], v255, s[24:27], s53 offen offset:2048 sc1
    v_cvt_pk_bf16_f32 v237, v58, v59
    v_cvt_pk_bf16_f32 v238, v60, v61
    v_cvt_pk_bf16_f32 v239, v62, v63
    v_pk_fma_f32 v[48:49], v[12:13], v[28:29], v[48:49] op_sel_hi:[1,0,1] neg_lo:[0,0,1] neg_hi:[0,0,1]
    v_pk_fma_f32 v[50:51], v[14:15], v[28:29], v[50:51] op_sel_hi:[1,0,1] neg_lo:[0,0,1] neg_hi:[0,0,1]
    v_pk_fma_f32 v[52:53], v[16:17], v[28:29], v[52:53] op_sel_hi:[1,0,1] neg_lo:[0,0,1] neg_hi:[0,0,1]
    v_pk_fma_f32 v[54:55], v[18:19], v[28:29], v[54:55] op_sel_hi:[1,0,1] neg_lo:[0,0,1] neg_hi:[0,0,1]
    v_pk_fma_f32 v[56:57], v[20:21], v[28:29], v[56:57] op_sel_hi:[1,0,1] neg_lo:[0,0,1] neg_hi:[0,0,1]
    v_pk_fma_f32 v[58:59], v[22:23], v[28:29], v[58:59] op_sel_hi:[1,0,1] neg_lo:[0,0,1] neg_hi:[0,0,1]
    v_pk_fma_f32 v[60:61], v[24:25], v[28:29], v[60:61] op_sel_hi:[1,0,1] neg_lo:[0,0,1] neg_hi:[0,0,1]
    v_pk_fma_f32 v[62:63], v[26:27], v[28:29], v[62:63] op_sel_hi:[1,0,1] neg_lo:[0,0,1] neg_hi:[0,0,1]
    v_cvt_pk_bf16_f32 v208, v12, v13
    buffer_load_dwordx4 v[108:111], v255, s[24:27], s53 offen offset:3072 sc1
    v_cvt_pk_bf16_f32 v209, v14, v15
    v_cvt_pk_bf16_f32 v210, v16, v17
    v_cvt_pk_bf16_f32 v211, v18, v19
    v_cvt_pk_bf16_f32 v240, v20, v21
    v_cvt_pk_bf16_f32 v241, v22, v23
    v_cvt_pk_bf16_f32 v242, v24, v25
    v_cvt_pk_bf16_f32 v243, v26, v27
    v_cvt_pk_bf16_f32 v212, v48, v49
    v_cvt_pk_bf16_f32 v213, v50, v51
    v_cvt_pk_bf16_f32 v214, v52, v53
    v_cvt_pk_bf16_f32 v215, v54, v55
    v_cvt_pk_bf16_f32 v244, v56, v57
    v_cvt_pk_bf16_f32 v245, v58, v59
    v_cvt_pk_bf16_f32 v246, v60, v61
    v_cvt_pk_bf16_f32 v247, v62, v63
    s_add_u32 s54, s51, 32768
    buffer_load_dwordx4 v[0:3], v255, s[24:27], s51 offen sc1
    buffer_load_dwordx4 v[4:7], v255, s[24:27], s54 offen sc1
    s_waitcnt vmcnt(9)
    v_mfma_f32_32x32x16_bf16 v[16:31], a[0:3], v[80:83], 0
    s_add_u32 s53, s48, 8192
    buffer_load_dwordx4 v[152:155], v255, s[24:27], s53 offen offset:0 sc1
    s_lshl_b32 s57, s39, 5
    s_add_u32 s57, s57, s52
    s_lshl_b32 s57, s57, 10
    v_mfma_f32_32x32x16_bf16 v[32:47], a[4:7], v[80:83], 0
    s_add_u32 s57, s57, 12582912
    s_add_u32 s58, s57, 0x100000
    s_lshl_b32 s59, s44, 3
    s_add_u32 s59, s59, s38
    s_lshl_b32 s59, s59, 7
    s_add_u32 s59, s59, s34
    s_waitcnt vmcnt(9)
    v_mfma_f32_32x32x16_bf16 v[16:31], a[8:11], v[84:87], v[16:31]
    buffer_load_dwordx4 v[156:159], v255, s[24:27], s53 offen offset:1024 sc1
    s_lshl_b32 s59, s59, 2
    s_add_u32 s59, s59, 5242880
    s_add_u32 s60, s59, 4096
    s_xor_b32 s69, s34, 0
    v_mfma_f32_32x32x16_bf16 v[32:47], a[12:15], v[84:87], v[32:47]
    s_mul_i32 s69, s69, 6144
    s_add_u32 s69, s69, 98304
    v_add_u32 v144, s69, v255
    s_xor_b32 s69, s34, 1
    s_mul_i32 s69, s69, 6144
    s_add_u32 s69, s69, 98304
    s_waitcnt vmcnt(9)
    v_mfma_f32_32x32x16_bf16 v[16:31], a[16:19], v[88:91], v[16:31]
    buffer_load_dwordx4 v[160:163], v255, s[24:27], s53 offen offset:2048 sc1
    v_add_u32 v145, s69, v255
    s_xor_b32 s69, s34, 2
    s_mul_i32 s69, s69, 6144
    s_add_u32 s69, s69, 100352
    v_mfma_f32_32x32x16_bf16 v[32:47], a[20:23], v[88:91], v[32:47]
    v_add_u32 v146, s69, v255
    s_xor_b32 s69, s34, 3
    s_mul_i32 s69, s69, 6144
    s_add_u32 s69, s69, 102400
    v_add_u32 v147, s69, v255
    s_waitcnt vmcnt(9)
    v_mfma_f32_32x32x16_bf16 v[16:31], a[24:27], v[92:95], v[16:31]
    buffer_load_dwordx4 v[164:167], v255, s[24:27], s53 offen offset:3072 sc1
    s_lshl_b32 s61, s39, 15
    s_lshl_b32 s62, s34, 13
    s_add_u32 s61, s61, s62
    s_add_u32 s66, s61, 12582912
    s_add_u32 s61, s66, 4096
    s_add_u32 s62, s66, 0x100000
    v_mfma_f32_32x32x16_bf16 v[32:47], a[28:31], v[92:95], v[32:47]
    s_add_u32 s63, s61, 0x100000
    s_add_u32 s64, s44, 1
    s_and_b32 s65, s34, 1
    s_lshl_b32 s65, s65, 8
    s_waitcnt vmcnt(9)
    v_mfma_f32_32x32x16_bf16 v[16:31], a[32:35], v[96:99], v[16:31]
    v_lshl_add_u32 v132, v254, 3, s46
    s_andn2_b32 s71, 1073741824, s72
    buffer_load_dwordx2 v[134:135], v132, s[24:27], s71 offen sc1
    s_add_u32 s53, s48, 12288
    buffer_load_dwordx4 v[168:171], v255, s[24:27], s53 offen offset:0 sc1
    v_mfma_f32_32x32x16_bf16 v[32:47], a[36:39], v[96:99], v[32:47]
    s_waitcnt vmcnt(10)
    v_mfma_f32_32x32x16_bf16 v[16:31], a[40:43], v[100:103], v[16:31]
    buffer_load_dwordx4 v[172:175], v255, s[24:27], s53 offen offset:1024 sc1
    v_mfma_f32_32x32x16_bf16 v[32:47], a[44:47], v[100:103], v[32:47]
    s_waitcnt vmcnt(10)
    v_mfma_f32_32x32x16_bf16 v[16:31], a[48:51], v[104:107], v[16:31]
    buffer_load_dwordx4 v[176:179], v255, s[24:27], s53 offen offset:2048 sc1
L_pad2:
    s_cbranch_execz L_pad6
    v_mfma_f32_32x32x16_bf16 v[32:47], a[52:55], v[104:107], v[32:47]
    s_waitcnt vmcnt(10)
    v_mfma_f32_32x32x16_bf16 v[16:31], a[56:59], v[108:111], v[16:31]
    buffer_load_dwordx4 v[180:183], v255, s[24:27], s53 offen offset:3072 sc1
    v_mfma_f32_32x32x16_bf16 v[32:47], a[60:63], v[108:111], v[32:47]
    s_waitcnt vmcnt(8)
    v_mfma_f32_32x32x16_bf16 v[16:31], a[64:67], v[152:155], v[16:31]
    s_add_u32 s53, s48, 16384
    buffer_load_dwordx4 v[112:115], v255, s[24:27], s53 offen offset:0 sc1
    v_mfma_f32_32x32x16_bf16 v[32:47], a[68:71], v[152:155], v[32:47]
    s_waitcnt vmcnt(8)
    v_mfma_f32_32x32x16_bf16 v[16:31], a[72:75], v[156:159], v[16:31]
    buffer_load_dwordx4 v[116:119], v255, s[24:27], s53 offen offset:1024 sc1
    v_mfma_f32_32x32x16_bf16 v[32:47], a[76:79], v[156:159], v[32:47]
    s_waitcnt vmcnt(8)
    v_mfma_f32_32x32x16_bf16 v[16:31], a[80:83], v[160:163], v[16:31]
    buffer_load_dwordx4 v[120:123], v255, s[24:27], s53 offen offset:2048 sc1
    v_mfma_f32_32x32x16_bf16 v[32:47], a[84:87], v[160:163], v[32:47]
    s_waitcnt vmcnt(8)
    v_mfma_f32_32x32x16_bf16 v[16:31], a[88:91], v[164:167], v[16:31]
    buffer_load_dwordx4 v[124:127], v255, s[24:27], s53 offen offset:3072 sc1
    v_mfma_f32_32x32x16_bf16 v[32:47], a[92:95], v[164:167], v[32:47]
    s_waitcnt vmcnt(7)
    v_mfma_f32_32x32x16_bf16 v[16:31], a[96:99], v[168:171], v[16:31]
    s_add_u32 s70, s32, 3
    v_subrev_u32 v134, s70, v134
    v_xor_b32 v135, s33, v135
    v_lshrrev_b32 v134, 3, v134
    v_or_b32 v134, v134, v135
    v_cmp_ne_u32 vcc, 0, v134
    s_nop 0
    s_or_b32 vcc_lo, vcc_lo, s40
    s_and_b64 vcc, vcc, s[72:73]
    s_cbranch_vccnz L_interleave_layers__spectral_fnet__swiglu_ffn__prompt_cf_6_retry
L_interleave_layers__spectral_fnet__swiglu_ffn__prompt_cf_6_ok:
    s_barrier
    s_add_u32 s53, s48, s50
    buffer_load_dwordx4 v[80:83], v255, s[24:27], s53 offen offset:0 sc1
    v_mfma_f32_32x32x16_bf16 v[32:47], a[100:103], v[168:171], v[32:47]
    s_waitcnt vmcnt(7)
    v_mfma_f32_32x32x16_bf16 v[16:31], a[104:107], v[172:175], v[16:31]
    buffer_load_dwordx4 v[84:87], v255, s[24:27], s53 offen offset:1024 sc1
    v_mfma_f32_32x32x16_bf16 v[32:47], a[108:111], v[172:175], v[32:47]
    s_waitcnt vmcnt(7)
    v_mfma_f32_32x32x16_bf16 v[16:31], a[112:115], v[176:179], v[16:31]
    s_add_u32 s53, s49, 0
    buffer_load_dwordx4 v[88:91], v255, s[24:27], s53 offen offset:0 sc1
    v_mfma_f32_32x32x16_bf16 v[32:47], a[116:119], v[176:179], v[32:47]
    s_waitcnt vmcnt(7)
    v_mfma_f32_32x32x16_bf16 v[16:31], a[120:123], v[180:183], v[16:31]
    buffer_load_dwordx4 v[92:95], v255, s[24:27], s53 offen offset:1024 sc1
    v_mfma_f32_32x32x16_bf16 v[32:47], a[124:127], v[180:183], v[32:47]
    s_waitcnt vmcnt(7)
    v_mfma_f32_32x32x16_bf16 v[16:31], a[128:131], v[112:115], v[16:31]
    buffer_load_dwordx4 v[96:99], v255, s[24:27], s53 offen offset:2048 sc1
    v_mfma_f32_32x32x16_bf16 v[32:47], a[132:135], v[112:115], v[32:47]
    s_waitcnt vmcnt(7)
    v_mfma_f32_32x32x16_bf16 v[16:31], a[136:139], v[116:119], v[16:31]
    buffer_load_dwordx4 v[100:103], v255, s[24:27], s53 offen offset:3072 sc1
    v_mfma_f32_32x32x16_bf16 v[32:47], a[140:143], v[116:119], v[32:47]
    s_waitcnt vmcnt(7)
    v_mfma_f32_32x32x16_bf16 v[16:31], a[144:147], v[120:123], v[16:31]
    s_add_u32 s53, s49, 4096
    buffer_load_dwordx4 v[104:107], v255, s[24:27], s53 offen offset:0 sc1
    v_mfma_f32_32x32x16_bf16 v[32:47], a[148:151], v[120:123], v[32:47]
    s_waitcnt vmcnt(7)
    v_mfma_f32_32x32x16_bf16 v[16:31], a[152:155], v[124:127], v[16:31]
    buffer_load_dwordx4 v[108:111], v255, s[24:27], s53 offen offset:1024 sc1
    v_mfma_f32_32x32x16_bf16 v[32:47], a[156:159], v[124:127], v[32:47]
    s_waitcnt vmcnt(7)
    v_mfma_f32_32x32x16_bf16 v[16:31], a[160:163], v[80:83], v[16:31]
    buffer_load_dwordx4 v[152:155], v255, s[24:27], s53 offen offset:2048 sc1
    buffer_load_dwordx4 v[156:159], v255, s[24:27], s53 offen offset:3072 sc1
    v_mfma_f32_32x32x16_bf16 v[32:47], a[164:167], v[80:83], v[32:47]
    s_waitcnt vmcnt(8)
    v_mfma_f32_32x32x16_bf16 v[16:31], a[168:171], v[84:87], v[16:31]
    s_add_u32 s53, s49, 8192
    buffer_load_dwordx4 v[160:163], v255, s[24:27], s53 offen offset:0 sc1
    buffer_load_dwordx4 v[164:167], v255, s[24:27], s53 offen offset:1024 sc1
    v_mfma_f32_32x32x16_bf16 v[32:47], a[172:175], v[84:87], v[32:47]
    s_waitcnt vmcnt(9)
    v_mfma_f32_32x32x16_bf16 v[48:63], a[0:3], v[88:91], 0
    buffer_load_dwordx4 v[168:171], v255, s[24:27], s53 offen offset:2048 sc1
    v_mfma_f32_32x32x16_bf16 v[64:79], a[4:7], v[88:91], 0
    s_waitcnt vmcnt(9)
    v_mfma_f32_32x32x16_bf16 v[48:63], a[8:11], v[92:95], v[48:63]
    buffer_load_dwordx4 v[172:175], v255, s[24:27], s53 offen offset:3072 sc1
    v_mfma_f32_32x32x16_bf16 v[64:79], a[12:15], v[92:95], v[64:79]
    ds_write_b128 v145, v[24:27] offset:0
    s_waitcnt vmcnt(9)
    v_mfma_f32_32x32x16_bf16 v[48:63], a[16:19], v[96:99], v[48:63]
    s_add_u32 s53, s49, 12288
    buffer_load_dwordx4 v[176:179], v255, s[24:27], s53 offen offset:0 sc1
    v_mfma_f32_32x32x16_bf16 v[64:79], a[20:23], v[96:99], v[64:79]
    ds_write_b128 v145, v[28:31] offset:1024
    s_waitcnt vmcnt(9)
    v_mfma_f32_32x32x16_bf16 v[48:63], a[24:27], v[100:103], v[48:63]
    buffer_load_dwordx4 v[180:183], v255, s[24:27], s53 offen offset:1024 sc1
    v_mfma_f32_32x32x16_bf16 v[64:79], a[28:31], v[100:103], v[64:79]
    ds_write_b128 v146, v[32:35] offset:0
    s_waitcnt vmcnt(9)
    v_mfma_f32_32x32x16_bf16 v[48:63], a[32:35], v[104:107], v[48:63]
    buffer_load_dwordx4 v[112:115], v255, s[24:27], s53 offen offset:2048 sc1
    v_mfma_f32_32x32x16_bf16 v[64:79], a[36:39], v[104:107], v[64:79]
    ds_write_b128 v146, v[36:39] offset:1024
    s_waitcnt vmcnt(9)
    v_mfma_f32_32x32x16_bf16 v[48:63], a[40:43], v[108:111], v[48:63]
    buffer_load_dwordx4 v[116:119], v255, s[24:27], s53 offen offset:3072 sc1
    v_mfma_f32_32x32x16_bf16 v[64:79], a[44:47], v[108:111], v[64:79]
    ds_write_b128 v147, v[40:43] offset:0
    s_waitcnt vmcnt(9)
    v_mfma_f32_32x32x16_bf16 v[48:63], a[48:51], v[152:155], v[48:63]
    s_add_u32 s53, s49, 16384
    buffer_load_dwordx4 v[120:123], v255, s[24:27], s53 offen offset:0 sc1
    v_mfma_f32_32x32x16_bf16 v[64:79], a[52:55], v[152:155], v[64:79]
    ds_write_b128 v147, v[44:47] offset:1024
    s_waitcnt vmcnt(9)
    v_mfma_f32_32x32x16_bf16 v[48:63], a[56:59], v[156:159], v[48:63]
    buffer_load_dwordx4 v[124:127], v255, s[24:27], s53 offen offset:1024 sc1
    v_mfma_f32_32x32x16_bf16 v[64:79], a[60:63], v[156:159], v[64:79]
    s_waitcnt vmcnt(9)
    v_mfma_f32_32x32x16_bf16 v[48:63], a[64:67], v[160:163], v[48:63]
    buffer_load_dwordx4 v[80:83], v255, s[24:27], s53 offen offset:2048 sc1
    s_waitcnt lgkmcnt(0)
    s_barrier
    ds_read_b128 v[32:35], v144 offset:2048
    ds_read_b128 v[36:39], v144 offset:3072
    v_mfma_f32_32x32x16_bf16 v[64:79], a[68:71], v[160:163], v[64:79]
    ds_read_b128 v[40:43], v144 offset:4096
    ds_read_b128 v[44:47], v144 offset:5120
    ds_read_b128 v[24:27], v144 offset:0
    ds_read_b128 v[28:31], v144 offset:1024
    v_lshlrev_b32 v12, 16, v0
    v_and_b32 v13, 0xffff0000, v0
    s_waitcnt vmcnt(9)
    v_mfma_f32_32x32x16_bf16 v[48:63], a[72:75], v[164:167], v[48:63]
    buffer_load_dwordx4 v[84:87], v255, s[24:27], s53 offen offset:3072 sc1
    v_add_f32 v16, v16, v12
    v_add_f32 v17, v17, v13
    v_lshlrev_b32 v12, 16, v1
    v_and_b32 v13, 0xffff0000, v1
    v_mfma_f32_32x32x16_bf16 v[64:79], a[76:79], v[164:167], v[64:79]
    v_add_f32 v18, v18, v12
    v_add_f32 v19, v19, v13
    v_lshlrev_b32 v12, 16, v2
    v_and_b32 v13, 0xffff0000, v2
    v_add_f32 v20, v20, v12
    v_add_f32 v21, v21, v13
    s_waitcnt vmcnt(9)
    v_mfma_f32_32x32x16_bf16 v[48:63], a[80:83], v[168:171], v[48:63]
    s_add_u32 s53, s49, s50
    buffer_load_dwordx4 v[88:91], v255, s[24:27], s53 offen offset:0 sc1
    v_lshlrev_b32 v12, 16, v3
    v_and_b32 v13, 0xffff0000, v3
    v_add_f32 v22, v22, v12
    v_mfma_f32_32x32x16_bf16 v[64:79], a[84:87], v[168:171], v[64:79]
    v_add_f32 v23, v23, v13
    s_waitcnt lgkmcnt(1)
    v_add_f32 v16, v16, v24
    v_add_f32 v17, v17, v25
    v_add_f32 v18, v18, v26
    v_add_f32 v19, v19, v27
    s_waitcnt lgkmcnt(0)
    v_add_f32 v20, v20, v28
    s_waitcnt vmcnt(9)
    v_mfma_f32_32x32x16_bf16 v[48:63], a[88:91], v[172:175], v[48:63]
    buffer_load_dwordx4 v[92:95], v255, s[24:27], s53 offen offset:1024 sc1
    v_add_f32 v21, v21, v29
    v_add_f32 v22, v22, v30
    v_add_f32 v23, v23, v31
    v_add_f32 v16, v16, v32
    v_mfma_f32_32x32x16_bf16 v[64:79], a[92:95], v[172:175], v[64:79]
    v_add_f32 v17, v17, v33
    v_add_f32 v18, v18, v34
    v_add_f32 v19, v19, v35
    v_add_f32 v20, v20, v36
    v_add_f32 v21, v21, v37
    v_add_f32 v22, v22, v38
    s_waitcnt vmcnt(9)
    v_mfma_f32_32x32x16_bf16 v[48:63], a[96:99], v[176:179], v[48:63]
    v_add_f32 v23, v23, v39
    v_add_f32 v16, v16, v40
    v_add_f32 v17, v17, v41
    v_add_f32 v18, v18, v42
    v_add_f32 v19, v19, v43
    v_mfma_f32_32x32x16_bf16 v[64:79], a[100:103], v[176:179], v[64:79]
    v_add_f32 v20, v20, v44
    v_add_f32 v21, v21, v45
    v_add_f32 v22, v22, v46
    v_add_f32 v23, v23, v47
    v_cvt_pk_bf16_f32 v8, v16, v17
    v_cvt_pk_bf16_f32 v9, v18, v19
    s_waitcnt vmcnt(8)
    v_mfma_f32_32x32x16_bf16 v[48:63], a[104:107], v[180:183], v[48:63]
    v_cvt_pk_bf16_f32 v10, v20, v21
    v_cvt_pk_bf16_f32 v11, v22, v23
    buffer_store_dwordx4 v[8:11], v255, s[24:27], s57 offen
    v_pk_add_f32 v[24:25], v[16:17], v[18:19]
    v_pk_mul_f32 v[26:27], v[16:17], v[16:17]
    v_mfma_f32_32x32x16_bf16 v[64:79], a[108:111], v[180:183], v[64:79]
    v_pk_fma_f32 v[26:27], v[18:19], v[18:19], v[26:27]
    v_pk_add_f32 v[24:25], v[24:25], v[20:21]
    v_pk_fma_f32 v[26:27], v[20:21], v[20:21], v[26:27]
    v_pk_add_f32 v[24:25], v[24:25], v[22:23]
    v_pk_fma_f32 v[26:27], v[22:23], v[22:23], v[26:27]
    v_add_f32 v24, v24, v25
    s_waitcnt vmcnt(8)
    v_mfma_f32_32x32x16_bf16 v[48:63], a[112:115], v[112:115], v[48:63]
    v_add_f32 v25, v26, v27
    v_mov_b32 v26, v24
    v_mov_b32 v27, v25
    v_lshlrev_b32 v28, 4, v254
    v_lshl_add_u32 v28, v253, 30, v28
    v_mfma_f32_32x32x16_bf16 v[64:79], a[116:119], v[112:115], v[64:79]
    v_permlane32_swap_b32 v24, v26
    v_permlane32_swap_b32 v25, v27
    v_add_f32 v24, v24, v26
    v_add_f32 v25, v25, v27
    v_mul_f32 v24, 0x3e800000, v24
    v_fma_f32 v25, -v24, v24, v25
    s_waitcnt vmcnt(7)
    v_mfma_f32_32x32x16_bf16 v[48:63], a[120:123], v[116:119], v[48:63]
    v_cvt_pk_bf16_f32 v24, v24, v25
    buffer_store_dword v24, v28, s[24:27], s59 offen
    v_mfma_f32_32x32x16_bf16 v[64:79], a[124:127], v[116:119], v[64:79]
    s_waitcnt vmcnt(7)
    v_mfma_f32_32x32x16_bf16 v[48:63], a[128:131], v[120:123], v[48:63]
    v_mfma_f32_32x32x16_bf16 v[64:79], a[132:135], v[120:123], v[64:79]
    s_waitcnt vmcnt(6)
    v_mfma_f32_32x32x16_bf16 v[64:79], a[140:143], v[124:127], v[64:79]
    s_waitcnt vmcnt(5)
    v_mfma_f32_32x32x16_bf16 v[64:79], a[148:151], v[80:83], v[64:79]
    s_waitcnt vmcnt(4)
    v_mfma_f32_32x32x16_bf16 v[64:79], a[156:159], v[84:87], v[64:79]
    s_add_u32 s56, s32, 4
    v_mov_b32 v136, s56
    v_mov_b32 v137, s33
    s_cmp_lg_u32 s40, 0
    s_waitcnt vmcnt(0)
    s_barrier
    s_cbranch_scc1 L_interleave_layers__spectral_fnet__swiglu_ffn__prompt_pb_7_slow
    buffer_store_dwordx2 v[136:137], v249, s[24:27], 0 offen
L_interleave_layers__spectral_fnet__swiglu_ffn__prompt_pb_7_back:
    v_mfma_f32_32x32x16_bf16 v[64:79], a[164:167], v[88:91], v[64:79]
    v_mfma_f32_32x32x16_bf16 v[64:79], a[172:175], v[92:95], v[64:79]
    v_mfma_f32_32x32x16_bf16 v[48:63], a[136:139], v[124:127], v[48:63]
    v_mfma_f32_32x32x16_bf16 v[48:63], a[144:147], v[80:83], v[48:63]
    v_mfma_f32_32x32x16_bf16 v[48:63], a[152:155], v[84:87], v[48:63]
    s_nop 8
    ds_write_b128 v146, v[64:67] offset:24576
    v_mfma_f32_32x32x16_bf16 v[48:63], a[160:163], v[88:91], v[48:63]
    ds_write_b128 v146, v[68:71] offset:25600
    v_mfma_f32_32x32x16_bf16 v[48:63], a[168:171], v[92:95], v[48:63]
    ds_write_b128 v147, v[72:75] offset:24576
    ds_write_b128 v147, v[76:79] offset:25600
    s_nop 9
    ds_write_b128 v145, v[56:59] offset:24576
    ds_write_b128 v145, v[60:63] offset:25600
    v_lshlrev_b32 v12, 16, v4
    v_and_b32 v13, 0xffff0000, v4
    v_add_f32 v48, v48, v12
    v_add_f32 v49, v49, v13
    v_lshlrev_b32 v12, 16, v5
    v_and_b32 v13, 0xffff0000, v5
    v_add_f32 v50, v50, v12
    v_add_f32 v51, v51, v13
    v_lshlrev_b32 v12, 16, v6
    v_and_b32 v13, 0xffff0000, v6
    v_add_f32 v52, v52, v12
    v_add_f32 v53, v53, v13
    v_lshlrev_b32 v12, 16, v7
    v_and_b32 v13, 0xffff0000, v7
    v_add_f32 v54, v54, v12
    v_add_f32 v55, v55, v13
    s_waitcnt lgkmcnt(0)
    s_barrier
    ds_read_b128 v[64:67], v144 offset:26624
    ds_read_b128 v[68:71], v144 offset:27648
    ds_read_b128 v[72:75], v144 offset:28672
    ds_read_b128 v[76:79], v144 offset:29696
    ds_read_b128 v[56:59], v144 offset:24576
    ds_read_b128 v[60:63], v144 offset:25600
    v_and_b32 v164, 7, v254
    s_lshl_b32 s71, s37, 6
    s_add_u32 s71, s71, s46
    v_lshl_add_u32 v164, v164, 3, s71
    s_andn2_b32 s71, 1073741824, s72
    buffer_load_dwordx2 v[166:167], v164, s[24:27], s71 offen sc1
    v_lshrrev_b32 v161, 4, v248
    v_and_b32 v160, 0xf0, v255
    v_lshl_add_u32 v160, v161, 10, v160
    v_add_u32 v160, s65, v160
    s_waitcnt lgkmcnt(5)
    v_pk_add_f32 v[48:49], v[48:49], v[64:65]
    v_pk_add_f32 v[50:51], v[50:51], v[66:67]
    s_waitcnt lgkmcnt(4)
    v_pk_add_f32 v[52:53], v[52:53], v[68:69]
    v_pk_add_f32 v[54:55], v[54:55], v[70:71]
    s_waitcnt lgkmcnt(3)
    v_pk_add_f32 v[48:49], v[48:49], v[72:73]
    v_pk_add_f32 v[50:51], v[50:51], v[74:75]
    s_waitcnt lgkmcnt(2)
    v_pk_add_f32 v[52:53], v[52:53], v[76:77]
    v_pk_add_f32 v[54:55], v[54:55], v[78:79]
    s_waitcnt lgkmcnt(1)
    v_pk_add_f32 v[48:49], v[48:49], v[56:57]
    v_pk_add_f32 v[50:51], v[50:51], v[58:59]
    s_waitcnt lgkmcnt(0)
    v_pk_add_f32 v[52:53], v[52:53], v[60:61]
    v_pk_add_f32 v[54:55], v[54:55], v[62:63]
    v_cvt_pk_bf16_f32 v8, v48, v49
    v_cvt_pk_bf16_f32 v9, v50, v51
    v_cvt_pk_bf16_f32 v10, v52, v53
    v_cvt_pk_bf16_f32 v11, v54, v55
    buffer_store_dwordx4 v[8:11], v255, s[24:27], s58 offen
    v_pk_add_f32 v[56:57], v[48:49], v[50:51]
    v_pk_mul_f32 v[58:59], v[48:49], v[48:49]
    v_pk_fma_f32 v[58:59], v[50:51], v[50:51], v[58:59]
    v_pk_add_f32 v[56:57], v[56:57], v[52:53]
    v_pk_fma_f32 v[58:59], v[52:53], v[52:53], v[58:59]
    v_pk_add_f32 v[56:57], v[56:57], v[54:55]
    v_pk_fma_f32 v[58:59], v[54:55], v[54:55], v[58:59]
    v_add_f32 v56, v56, v57
    v_add_f32 v57, v58, v59
    v_mov_b32 v58, v56
    v_mov_b32 v59, v57
    v_lshlrev_b32 v60, 4, v254
    v_lshl_add_u32 v60, v253, 30, v60
    v_permlane32_swap_b32 v56, v58
    v_permlane32_swap_b32 v57, v59
    v_add_f32 v56, v56, v58
    v_add_f32 v57, v57, v59
    v_mul_f32 v56, 0x3e800000, v56
    v_fma_f32 v57, -v56, v56, v57
    v_cvt_pk_bf16_f32 v56, v56, v57
    buffer_store_dword v56, v60, s[24:27], s60 offen
    s_add_u32 s56, s32, 5
    v_mov_b32 v136, s56
    v_mov_b32 v137, s33
    s_add_u32 s70, s32, 4
    s_waitcnt vmcnt(2)
    v_subrev_u32 v166, s70, v166
    v_xor_b32 v167, s33, v167
    v_lshrrev_b32 v166, 3, v166
    v_or_b32 v166, v166, v167
    v_cmp_ne_u32 vcc, 0, v166
    s_nop 0
    s_or_b32 vcc_lo, vcc_lo, s40
    s_and_b64 vcc, vcc, s[72:73]
    s_cbranch_vccnz L_interleave_layers__spectral_fnet__swiglu_ffn__prompt_cf_8_retry
L_interleave_layers__spectral_fnet__swiglu_ffn__prompt_cf_8_ok:
    s_cmp_lg_u32 s40, 0
    s_waitcnt vmcnt(0)
    s_barrier
    s_cbranch_scc1 L_interleave_layers__spectral_fnet__swiglu_ffn__prompt_pb_9_slow
    buffer_store_dwordx2 v[136:137], v249, s[24:27], 0 offen
L_interleave_layers__spectral_fnet__swiglu_ffn__prompt_pb_9_back:
    s_mov_b32 s60, s66
    buffer_load_dwordx4 v[64:67], v150, s[24:27], s60 offen offset:0 sc1
    buffer_load_dwordx4 v[68:71], v150, s[24:27], s60 offen offset:1024 sc1
    buffer_load_dwordx4 v[72:75], v150, s[24:27], s60 offen offset:2048 sc1
    buffer_load_dwordx4 v[76:79], v150, s[24:27], s60 offen offset:3072 sc1
    buffer_load_dwordx4 v[80:83], v150, s[24:27], s61 offen offset:0 sc1
    buffer_load_dwordx4 v[84:87], v150, s[24:27], s61 offen offset:1024 sc1
    v_and_b32 v164, 7, v254
    s_lshl_b32 s71, s37, 6
    s_add_u32 s71, s71, s46
    v_lshl_add_u32 v164, v164, 3, s71
    s_andn2_b32 s71, 1073741824, s72
    buffer_load_dwordx2 v[166:167], v164, s[24:27], s71 offen sc1
    buffer_load_dwordx4 v[88:91], v150, s[24:27], s61 offen offset:2048 sc1
    buffer_load_dwordx4 v[92:95], v150, s[24:27], s61 offen offset:3072 sc1
    s_lshl_b32 s65, s44, 12
    s_add_u32 s65, s65, 5242880
    buffer_load_dwordx4 v[40:43], v160, s[24:27], s65 offen offset:0 sc1
    buffer_load_dwordx4 v[44:47], v160, s[24:27], s65 offen offset:512 sc1
    s_waitcnt vmcnt(10)
    v_mfma_f32_32x32x16_bf16 v[0:15], v[64:67], v[184:187], 0
    s_add_u32 s70, s32, 5
    s_waitcnt vmcnt(4)
    v_subrev_u32 v166, s70, v166
    v_xor_b32 v167, s33, v167
    v_lshrrev_b32 v166, 3, v166
    v_or_b32 v166, v166, v167
    v_cmp_ne_u32 vcc, 0, v166
    s_nop 0
    s_or_b32 vcc_lo, vcc_lo, s40
    s_and_b64 vcc, vcc, s[72:73]
    s_cbranch_vccnz L_interleave_layers__spectral_fnet__swiglu_ffn__prompt_cf_10_retry
L_interleave_layers__spectral_fnet__swiglu_ffn__prompt_cf_10_ok:
    s_barrier
    buffer_load_dwordx4 v[96:99], v150, s[24:27], s62 offen offset:0 sc1
    v_mfma_f32_32x32x16_bf16 v[16:31], v[64:67], v[216:219], 0
    buffer_load_dwordx4 v[100:103], v150, s[24:27], s62 offen offset:1024 sc1
    s_lshl_b32 s69, s34, 10
    s_add_u32 s69, s69, 152064
    v_add_u32 v168, s69, v255
    v_add_u32 v169, 152064, v255
    s_waitcnt vmcnt(3)
    v_lshlrev_b32 v32, 16, v40
    v_mfma_f32_32x32x16_bf16 v[0:15], v[68:71], v[188:191], v[0:15]
    buffer_load_dwordx4 v[104:107], v150, s[24:27], s62 offen offset:2048 sc1
    v_and_b32 v33, 0xffff0000, v40
    v_fmac_f32 v33, v32, v32
    v_lshlrev_b32 v34, 16, v41
    v_and_b32 v35, 0xffff0000, v41
    v_fmac_f32 v35, v34, v34
    v_mfma_f32_32x32x16_bf16 v[16:31], v[68:71], v[220:223], v[16:31]
    buffer_load_dwordx4 v[108:111], v150, s[24:27], s62 offen offset:3072 sc1
    v_lshlrev_b32 v36, 16, v42
    v_and_b32 v37, 0xffff0000, v42
    v_fmac_f32 v37, v36, v36
    v_lshlrev_b32 v38, 16, v43
    v_and_b32 v39, 0xffff0000, v43
    v_mfma_f32_32x32x16_bf16 v[0:15], v[72:75], v[192:195], v[0:15]
    buffer_load_dwordx4 v[112:115], v150, s[24:27], s63 offen offset:0 sc1
    v_fmac_f32 v39, v38, v38
    s_waitcnt vmcnt(5)
    v_lshlrev_b32 v40, 16, v44
    v_and_b32 v41, 0xffff0000, v44
    v_fmac_f32 v41, v40, v40
    v_lshlrev_b32 v42, 16, v45
    v_mfma_f32_32x32x16_bf16 v[16:31], v[72:75], v[224:227], v[16:31]
    buffer_load_dwordx4 v[116:119], v150, s[24:27], s63 offen offset:1024 sc1
    v_and_b32 v43, 0xffff0000, v45
    v_fmac_f32 v43, v42, v42
    v_lshlrev_b32 v44, 16, v46
    v_and_b32 v45, 0xffff0000, v46
    v_fmac_f32 v45, v44, v44
    v_mfma_f32_32x32x16_bf16 v[0:15], v[76:79], v[196:199], v[0:15]
    buffer_load_dwordx4 v[120:123], v150, s[24:27], s63 offen offset:2048 sc1
    v_lshlrev_b32 v46, 16, v47
    v_and_b32 v47, 0xffff0000, v47
    v_fmac_f32 v47, v46, v46
    v_add_f32 v32, v32, v34
    v_add_f32 v33, v33, v35
    v_mfma_f32_32x32x16_bf16 v[16:31], v[76:79], v[228:231], v[16:31]
    buffer_load_dwordx4 v[124:127], v150, s[24:27], s63 offen offset:3072 sc1
    v_add_f32 v32, v32, v36
    v_add_f32 v33, v33, v37
    v_add_f32 v32, v32, v38
    v_add_f32 v33, v33, v39
    v_add_f32 v32, v32, v40
    v_mfma_f32_32x32x16_bf16 v[0:15], v[80:83], v[200:203], v[0:15]
    s_lshl_b32 s65, s64, 12
    v_add_f32 v33, v33, v41
    v_add_f32 v32, v32, v42
    v_add_f32 v33, v33, v43
    v_add_f32 v32, v32, v44
    v_add_f32 v33, v33, v45
    v_mfma_f32_32x32x16_bf16 v[16:31], v[80:83], v[232:235], v[16:31]
    s_add_u32 s65, s65, 5242880
    v_add_f32 v32, v32, v46
    v_add_f32 v33, v33, v47
    v_mov_b32 v34, v32
    v_mov_b32 v35, v33
    s_nop 0
    v_mfma_f32_32x32x16_bf16 v[0:15], v[84:87], v[204:207], v[0:15]
    buffer_load_dwordx4 v[136:139], v160, s[24:27], s65 offen offset:0 sc1
    v_permlane32_swap_b32 v32, v34
    v_permlane32_swap_b32 v33, v35
    v_add_f32 v32, v32, v34
    v_add_f32 v33, v33, v35
    v_mov_b32 v34, v32
    v_mfma_f32_32x32x16_bf16 v[16:31], v[84:87], v[236:239], v[16:31]
    buffer_load_dwordx4 v[140:143], v160, s[24:27], s65 offen offset:512 sc1
    v_mov_b32 v35, v33
    s_nop 0
    v_permlane16_swap_b32 v32, v34
    v_permlane16_swap_b32 v33, v35
    v_add_f32 v32, v32, v34
    v_mfma_f32_32x32x16_bf16 v[0:15], v[88:91], v[208:211], v[0:15]
    v_add_f32 v33, v33, v35
    v_mul_f32 v32, 0x3c000000, v32
    v_mul_f32 v34, v32, v32
    v_fma_f32 v33, v33, s45, -v34
    v_max_f32 v33, 0, v33
    v_add_f32 v33, 0x3727c5ac, v33
    v_mfma_f32_32x32x16_bf16 v[16:31], v[88:91], v[240:243], v[16:31]
    v_rsq_f32 v33, v33
    s_lshl_b32 s69, s34, 7
    s_add_u32 s69, s69, 151552
    v_and_b32 v34, 15, v254
    v_lshl_add_u32 v35, v253, 4, s69
    v_mfma_f32_32x32x16_bf16 v[0:15], v[92:95], v[212:215], v[0:15]
    v_lshl_add_u32 v34, v34, 2, s69
    ds_write_b32 v34, v33
    ds_read_b128 v[152:155], v35 offset:0
    ds_read_b128 v[156:159], v35 offset:32
    v_mfma_f32_32x32x16_bf16 v[16:31], v[92:95], v[244:247], v[16:31]
    s_waitcnt vmcnt(9)
    v_mfma_f32_32x32x16_bf16 v[32:47], v[96:99], v[184:187], 0
    v_mfma_f32_32x32x16_bf16 v[48:63], v[96:99], v[216:219], 0
    s_waitcnt vmcnt(8)
    v_mfma_f32_32x32x16_bf16 v[32:47], v[100:103], v[188:191], v[32:47]
    s_nop 1
    ds_write_b128 v145, v[8:11] offset:0
    v_mfma_f32_32x32x16_bf16 v[48:63], v[100:103], v[220:223], v[48:63]
    ds_write_b128 v145, v[12:15] offset:1024
    s_waitcnt vmcnt(7)
    v_mfma_f32_32x32x16_bf16 v[32:47], v[104:107], v[192:195], v[32:47]
    ds_write_b128 v146, v[16:19] offset:0
    v_mfma_f32_32x32x16_bf16 v[48:63], v[104:107], v[224:227], v[48:63]
    ds_write_b128 v146, v[20:23] offset:1024
    s_waitcnt vmcnt(6)
    v_mfma_f32_32x32x16_bf16 v[32:47], v[108:111], v[196:199], v[32:47]
    ds_write_b128 v147, v[24:27] offset:0
    v_mfma_f32_32x32x16_bf16 v[48:63], v[108:111], v[228:231], v[48:63]
    ds_write_b128 v147, v[28:31] offset:1024
    s_waitcnt vmcnt(5)
    v_mfma_f32_32x32x16_bf16 v[32:47], v[112:115], v[200:203], v[32:47]
    v_mfma_f32_32x32x16_bf16 v[48:63], v[112:115], v[232:235], v[48:63]
    s_waitcnt lgkmcnt(0)
    s_barrier
    ds_read_b128 v[16:19], v144 offset:2048
    ds_read_b128 v[20:23], v144 offset:3072
    ds_read_b128 v[24:27], v144 offset:4096
    ds_read_b128 v[28:31], v144 offset:5120
    s_waitcnt vmcnt(4)
    v_mfma_f32_32x32x16_bf16 v[48:63], v[116:119], v[236:239], v[48:63]
    ds_read_b128 v[8:11], v144 offset:0
    ds_read_b128 v[12:15], v144 offset:1024
    s_waitcnt lgkmcnt(1)
    v_add_f32 v0, v0, v8
    v_add_f32 v1, v1, v9
    v_add_f32 v2, v2, v10
    s_waitcnt vmcnt(3)
    v_mfma_f32_32x32x16_bf16 v[48:63], v[120:123], v[240:243], v[48:63]
    v_add_f32 v3, v3, v11
    s_waitcnt lgkmcnt(0)
    v_add_f32 v4, v4, v12
    v_add_f32 v5, v5, v13
    v_add_f32 v6, v6, v14
    v_add_f32 v7, v7, v15
    s_waitcnt vmcnt(2)
    v_mfma_f32_32x32x16_bf16 v[48:63], v[124:127], v[244:247], v[48:63]
    v_add_f32 v0, v0, v16
    v_add_f32 v1, v1, v17
    v_add_f32 v2, v2, v18
    v_add_f32 v3, v3, v19
    v_add_f32 v4, v4, v20
    v_mfma_f32_32x32x16_bf16 v[32:47], v[116:119], v[204:207], v[32:47]
    v_add_f32 v5, v5, v21
    v_add_f32 v6, v6, v22
    v_add_f32 v7, v7, v23
    v_add_f32 v0, v0, v24
    v_add_f32 v1, v1, v25
    v_add_f32 v2, v2, v26
    v_mfma_f32_32x32x16_bf16 v[32:47], v[120:123], v[208:211], v[32:47]
    v_add_f32 v3, v3, v27
    v_add_f32 v4, v4, v28
    v_add_f32 v5, v5, v29
    v_add_f32 v6, v6, v30
    v_add_f32 v7, v7, v31
    v_mul_f32 v0, v0, v152
    v_mfma_f32_32x32x16_bf16 v[32:47], v[124:127], v[212:215], v[32:47]
    ds_write_b128 v146, v[48:51] offset:24576
    v_mul_f32 v1, v1, v153
    v_mul_f32 v2, v2, v154
    v_mul_f32 v3, v3, v155
    v_mul_f32 v4, v4, v156
    v_mul_f32 v5, v5, v157
    ds_write_b128 v146, v[52:55] offset:25600
    v_mul_f32 v6, v6, v158
    v_mul_f32 v7, v7, v159
    v_cvt_pk_bf16_f32 v8, v0, v1
    v_cvt_pk_bf16_f32 v9, v2, v3
    v_cvt_pk_bf16_f32 v10, v4, v5
    v_cvt_pk_bf16_f32 v11, v6, v7
    ds_write_b128 v168, v[8:11] offset:0
    s_waitcnt vmcnt(1)
    v_lshlrev_b32 v128, 16, v136
    v_and_b32 v129, 0xffff0000, v136
    v_fmac_f32 v129, v128, v128
    v_lshlrev_b32 v130, 16, v137
    v_and_b32 v131, 0xffff0000, v137
    ds_write_b128 v147, v[56:59] offset:24576
    v_fmac_f32 v131, v130, v130
    v_lshlrev_b32 v132, 16, v138
    v_and_b32 v133, 0xffff0000, v138
    v_fmac_f32 v133, v132, v132
    v_lshlrev_b32 v134, 16, v139
    v_and_b32 v135, 0xffff0000, v139
    v_fmac_f32 v135, v134, v134
    s_waitcnt vmcnt(0)
    v_lshlrev_b32 v136, 16, v140
    v_and_b32 v137, 0xffff0000, v140
    v_fmac_f32 v137, v136, v136
    v_lshlrev_b32 v138, 16, v141
    v_and_b32 v139, 0xffff0000, v141
    ds_write_b128 v147, v[60:63] offset:25600
    v_fmac_f32 v139, v138, v138
    v_lshlrev_b32 v140, 16, v142
    v_and_b32 v141, 0xffff0000, v142
    v_fmac_f32 v141, v140, v140
    v_lshlrev_b32 v142, 16, v143
    v_and_b32 v143, 0xffff0000, v143
    v_fmac_f32 v143, v142, v142
    v_add_f32 v128, v128, v130
    v_add_f32 v129, v129, v131
    v_add_f32 v128, v128, v132
    v_add_f32 v129, v129, v133
    v_add_f32 v128, v128, v134
    ds_write_b128 v145, v[40:43] offset:24576
    v_add_f32 v129, v129, v135
    v_add_f32 v128, v128, v136
    v_add_f32 v129, v129, v137
    v_add_f32 v128, v128, v138
    v_add_f32 v129, v129, v139
    v_add_f32 v128, v128, v140
    v_add_f32 v129, v129, v141
    v_add_f32 v128, v128, v142
    v_add_f32 v129, v129, v143
    v_mov_b32 v130, v128
    v_mov_b32 v131, v129
    s_nop 0
    ds_write_b128 v145, v[44:47] offset:25600
    v_permlane32_swap_b32 v128, v130
    v_permlane32_swap_b32 v129, v131
    v_add_f32 v128, v128, v130
    v_add_f32 v129, v129, v131
    v_mov_b32 v130, v128
    v_mov_b32 v131, v129
    s_nop 0
    v_permlane16_swap_b32 v128, v130
    v_permlane16_swap_b32 v129, v131
    v_add_f32 v128, v128, v130
    v_add_f32 v129, v129, v131
    v_mul_f32 v128, 0x3c000000, v128
    v_mul_f32 v130, v128, v128
    v_fma_f32 v129, v129, s45, -v130
    v_max_f32 v129, 0, v129
    v_add_f32 v129, 0x3727c5ac, v129
    v_rsq_f32 v129, v129
    s_lshl_b32 s69, s34, 7
    s_add_u32 s69, s69, 151616
    v_and_b32 v130, 15, v254
    v_lshl_add_u32 v131, v253, 4, s69
    v_lshl_add_u32 v130, v130, 2, s69
    ds_write_b32 v130, v129
    ds_read_b128 v[172:175], v131 offset:0
    ds_read_b128 v[176:179], v131 offset:32
    s_waitcnt lgkmcnt(0)
    s_add_u32 s56, s32, 6
    v_mov_b32 v164, s56
    v_mov_b32 v165, s33
    s_cmp_lg_u32 s40, 0
    s_barrier
    s_cbranch_scc1 L_interleave_layers__spectral_fnet__swiglu_ffn__prompt_pb_11_slow
    buffer_store_dwordx2 v[164:165], v249, s[24:27], 0 offen
L_interleave_layers__spectral_fnet__swiglu_ffn__prompt_pb_11_back:
    ds_read_b128 v[48:51], v144 offset:26624
    ds_read_b128 v[52:55], v144 offset:27648
    ds_read_b128 v[56:59], v144 offset:28672
    ds_read_b128 v[60:63], v144 offset:29696
    ds_read_b128 v[40:43], v144 offset:24576
    ds_read_b128 v[44:47], v144 offset:25600
    ds_read_b128 v[64:67], v169 offset:0
    ds_read_b128 v[68:71], v169 offset:1024
    ds_read_b128 v[72:75], v169 offset:2048
    ds_read_b128 v[76:79], v169 offset:3072
    s_waitcnt lgkmcnt(5)
    v_add_f32 v32, v32, v40
    v_add_f32 v33, v33, v41
    v_add_f32 v34, v34, v42
    v_add_f32 v35, v35, v43
    s_waitcnt lgkmcnt(4)
    v_add_f32 v36, v36, v44
    v_add_f32 v37, v37, v45
    v_add_f32 v38, v38, v46
    v_add_f32 v39, v39, v47
    v_add_f32 v32, v32, v48
    v_add_f32 v33, v33, v49
    v_add_f32 v34, v34, v50
    v_add_f32 v35, v35, v51
    v_add_f32 v36, v36, v52
    v_add_f32 v37, v37, v53
    v_add_f32 v38, v38, v54
    v_add_f32 v39, v39, v55
    s_waitcnt lgkmcnt(3)
    v_mfma_f32_32x32x16_bf16 v[0:15], a[176:179], v[64:67], 0
    v_add_f32 v32, v32, v56
    v_add_f32 v33, v33, v57
    v_add_f32 v34, v34, v58
    v_add_f32 v35, v35, v59
    v_add_f32 v36, v36, v60
    v_add_f32 v37, v37, v61
    s_waitcnt lgkmcnt(2)
    v_mfma_f32_32x32x16_bf16 v[0:15], a[180:183], v[68:71], v[0:15]
    v_add_f32 v38, v38, v62
    v_add_f32 v39, v39, v63
    v_mul_f32 v32, v32, v172
    v_mul_f32 v33, v33, v173
    v_mul_f32 v34, v34, v174
    v_mul_f32 v35, v35, v175
    s_waitcnt lgkmcnt(1)
    v_mfma_f32_32x32x16_bf16 v[0:15], a[184:187], v[72:75], v[0:15]
    v_mul_f32 v36, v36, v176
    v_mul_f32 v37, v37, v177
    v_mul_f32 v38, v38, v178
    v_mul_f32 v39, v39, v179
    v_cvt_pk_bf16_f32 v40, v32, v33
    v_cvt_pk_bf16_f32 v41, v34, v35
    s_waitcnt lgkmcnt(0)
L_pad3:
    s_cbranch_execz L_pad7
    v_mfma_f32_32x32x16_bf16 v[0:15], a[188:191], v[76:79], v[0:15]
    v_cvt_pk_bf16_f32 v42, v36, v37
    v_cvt_pk_bf16_f32 v43, v38, v39
    ds_write_b128 v168, v[40:43] offset:4096
    v_lshlrev_b32 v168, 2, v254
    v_lshl_add_u32 v168, v253, 16, v168
    s_add_u32 s57, s47, 14680064
    s_waitcnt lgkmcnt(0)
    s_barrier
    ds_read_b128 v[80:83], v169 offset:4096
    ds_read_b128 v[84:87], v169 offset:5120
    ds_read_b128 v[88:91], v169 offset:6144
    ds_read_b128 v[92:95], v169 offset:7168
    s_waitcnt lgkmcnt(3)
    v_mfma_f32_32x32x16_bf16 v[0:15], a[192:195], v[80:83], v[0:15]
    s_waitcnt lgkmcnt(2)
    v_mfma_f32_32x32x16_bf16 v[0:15], a[196:199], v[84:87], v[0:15]
    s_waitcnt lgkmcnt(1)
    v_mfma_f32_32x32x16_bf16 v[0:15], a[200:203], v[88:91], v[0:15]
    s_waitcnt lgkmcnt(0)
    v_mfma_f32_32x32x16_bf16 v[0:15], a[204:207], v[92:95], v[0:15]
    s_add_u32 s58, s57, 0
    s_nop 10
    v_cvt_pk_bf16_f32 v16, v0, v1
    buffer_store_dword v16, v168, s[24:27], s58 offen sc1
    s_add_u32 s58, s57, 32768
    v_cvt_pk_bf16_f32 v17, v2, v3
    buffer_store_dword v17, v168, s[24:27], s58 offen sc1
    s_add_u32 s58, s57, 131072
    v_cvt_pk_bf16_f32 v18, v4, v5
    buffer_store_dword v18, v168, s[24:27], s58 offen sc1
    s_add_u32 s58, s57, 163840
    v_cvt_pk_bf16_f32 v19, v6, v7
    buffer_store_dword v19, v168, s[24:27], s58 offen sc1
    s_add_u32 s58, s57, 262144
    v_cvt_pk_bf16_f32 v20, v8, v9
    buffer_store_dword v20, v168, s[24:27], s58 offen sc1
    s_add_u32 s58, s57, 294912
    v_cvt_pk_bf16_f32 v21, v10, v11
    buffer_store_dword v21, v168, s[24:27], s58 offen sc1
    s_add_u32 s58, s57, 393216
    v_cvt_pk_bf16_f32 v22, v12, v13
    buffer_store_dword v22, v168, s[24:27], s58 offen sc1
    s_add_u32 s58, s57, 425984
    v_cvt_pk_bf16_f32 v23, v14, v15
    buffer_store_dword v23, v168, s[24:27], s58 offen sc1
    s_and_b32 s56, s34, 1
    s_lshl_b32 s57, s56, 5
    s_add_u32 s48, s39, s57
    s_lshr_b32 s63, s34, 1
    s_sub_u32 s58, 15, s38
    s_sub_u32 s59, 64, s48
    s_and_b32 s59, s59, 63
    s_cmp_lg_u32 s63, 0
    s_cselect_b32 s49, s58, s38
    s_cselect_b32 s59, s59, s48
    s_cselect_b64 vcc, -1, 0
    s_lshl_b32 s50, s59, 15
    s_add_u32 s50, s50, 14680064
    s_add_u32 s51, s44, s56
    v_lshrrev_b32 v2, 4, v254
    v_bfe_u32 v3, v254, 2, 1
    v_bfe_u32 v4, v254, 3, 1
    v_and_b32 v5, 3, v254
    v_lshl_add_u32 v5, v2, 4, v5
    v_lshl_add_u32 v5, v3, 3, v5
    v_lshl_add_u32 v5, v4, 2, v5
    s_lshl_b32 s61, s49, 5
    v_add_u32 v5, s61, v5
    v_sub_u32 v6, 512, v5
    v_and_b32 v6, 255, v6
    v_cndmask_b32 v6, v5, v6, vcc
    v_lshlrev_b32 v6, 2, v6
    v_lshl_add_u32 v6, v253, 12, v6
    v_cmp_eq_u32 vcc, 0, v5
    v_mov_b32 v7, 1073741824
    s_nop 0
    v_cndmask_b32 v168, v6, v7, vcc
    s_lshl_b32 s52, s51, 15
    s_lshl_b32 s62, s49, 11
    s_add_u32 s52, s52, s62
    s_lshl_b32 s62, s48, 15
    s_lshl_b32 s63, s49, 11
    s_add_u32 s62, s62, s63
    s_add_u32 s53, s62, 12582912
    buffer_load_dwordx4 v[160:163], v255, s[24:27], s53 offen sc1
    buffer_load_dwordx4 v[164:167], v255, s[24:27], s53 offen offset:1024 sc1
    s_and_b32 s68, s34, 1
    s_lshl_b32 s68, s68, 5
    s_add_u32 s68, s68, s39
    v_lshl_add_u32 v8, v254, 6, s68
    s_lshr_b32 s68, s34, 1
    s_lshl_b32 s68, s68, 31
    s_xor_b32 s68, s68, 0x3a000000
    v_cvt_f32_u32 v8, v8
    v_cvt_f32_u32 v9, v253
    v_mul_f32 v8, s68, v8
    v_mul_f32 v9, 4.0, v9
    v_mul_f32 v9, v8, v9
    v_fmamk_f32 v10, v8, 0x0, v9
    v_fmamk_f32 v11, v8, 0x3f800000, v9
    v_fmamk_f32 v12, v8, 0x40000000, v9
    v_fmamk_f32 v13, v8, 0x40400000, v9
    v_cos_f32 v14, v10
    v_sin_f32 v18, v10
    v_cos_f32 v15, v11
    v_sin_f32 v19, v11
    v_cos_f32 v16, v12
    v_sin_f32 v20, v12
    v_cos_f32 v17, v13
    v_sin_f32 v21, v13
    v_cvt_pk_bf16_f32 v128, v14, v18
    v_cvt_pk_bf16_f32 v129, v15, v19
    v_cvt_pk_bf16_f32 v130, v16, v20
    v_cvt_pk_bf16_f32 v131, v17, v21
    v_fmamk_f32 v10, v8, 0x41000000, v9
    v_fmamk_f32 v11, v8, 0x41100000, v9
    v_fmamk_f32 v12, v8, 0x41200000, v9
    v_fmamk_f32 v13, v8, 0x41300000, v9
    v_cos_f32 v14, v10
    v_sin_f32 v18, v10
    v_cos_f32 v15, v11
    v_sin_f32 v19, v11
    v_cos_f32 v16, v12
    v_sin_f32 v20, v12
    v_cos_f32 v17, v13
    v_sin_f32 v21, v13
    v_cvt_pk_bf16_f32 v132, v14, v18
    v_cvt_pk_bf16_f32 v133, v15, v19
    v_cvt_pk_bf16_f32 v134, v16, v20
    v_cvt_pk_bf16_f32 v135, v17, v21
    v_fmamk_f32 v10, v8, 0x41800000, v9
    v_fmamk_f32 v11, v8, 0x41880000, v9
    v_fmamk_f32 v12, v8, 0x41900000, v9
    v_fmamk_f32 v13, v8, 0x41980000, v9
    v_cos_f32 v14, v10
    v_sin_f32 v18, v10
    v_cos_f32 v15, v11
    v_sin_f32 v19, v11
    v_cos_f32 v16, v12
    v_sin_f32 v20, v12
    v_cos_f32 v17, v13
    v_sin_f32 v21, v13
    v_cvt_pk_bf16_f32 v136, v14, v18
    v_cvt_pk_bf16_f32 v137, v15, v19
    v_cvt_pk_bf16_f32 v138, v16, v20
    v_cvt_pk_bf16_f32 v139, v17, v21
    v_fmamk_f32 v10, v8, 0x41c00000, v9
    v_fmamk_f32 v11, v8, 0x41c80000, v9
    v_fmamk_f32 v12, v8, 0x41d00000, v9
    v_fmamk_f32 v13, v8, 0x41d80000, v9
    v_cos_f32 v14, v10
    v_sin_f32 v18, v10
    v_cos_f32 v15, v11
    v_sin_f32 v19, v11
    v_cos_f32 v16, v12
    v_sin_f32 v20, v12
    v_cos_f32 v17, v13
    v_sin_f32 v21, v13
    v_cvt_pk_bf16_f32 v140, v14, v18
    v_cvt_pk_bf16_f32 v141, v15, v19
    v_cvt_pk_bf16_f32 v142, v16, v20
    v_cvt_pk_bf16_f32 v143, v17, v21
    v_and_b32 v4, 7, v254
    s_lshl_b32 s71, s37, 6
    s_add_u32 s71, s71, s46
    v_lshl_add_u32 v4, v4, 3, s71
    s_andn2_b32 s71, 1073741824, s72
    buffer_load_dwordx2 v[6:7], v4, s[24:27], s71 offen sc1
    s_add_u32 s56, s50, 0
    buffer_load_dword v184, v168, s[24:27], s56 offen offset:0 sc1
    buffer_load_dword v185, v168, s[24:27], s56 offen offset:1024 sc1
    buffer_load_dword v186, v168, s[24:27], s56 offen offset:2048 sc1
    buffer_load_dword v187, v168, s[24:27], s56 offen offset:3072 sc1
    s_add_u32 s56, s50, 8192
    buffer_load_dword v188, v168, s[24:27], s56 offen offset:0 sc1
    buffer_load_dword v189, v168, s[24:27], s56 offen offset:1024 sc1
    buffer_load_dword v190, v168, s[24:27], s56 offen offset:2048 sc1
    buffer_load_dword v191, v168, s[24:27], s56 offen offset:3072 sc1
    s_add_u32 s56, s50, 16384
    buffer_load_dword v192, v168, s[24:27], s56 offen offset:0 sc1
    buffer_load_dword v193, v168, s[24:27], s56 offen offset:1024 sc1
    buffer_load_dword v194, v168, s[24:27], s56 offen offset:2048 sc1
    buffer_load_dword v195, v168, s[24:27], s56 offen offset:3072 sc1
    s_add_u32 s56, s50, 24576
    buffer_load_dword v196, v168, s[24:27], s56 offen offset:0 sc1
    buffer_load_dword v197, v168, s[24:27], s56 offen offset:1024 sc1
    buffer_load_dword v198, v168, s[24:27], s56 offen offset:2048 sc1
    buffer_load_dword v199, v168, s[24:27], s56 offen offset:3072 sc1
    s_lshl_b32 s60, s35, 1
    s_sub_u32 s59, 32, s60
    s_cmp_eq_u32 s35, 0
    s_cselect_b32 s59, 16, s59
    s_add_u32 s61, s60, 1
    s_sub_u32 s62, 31, s60
    s_bitcmp1_b32 s34, 0
    s_cselect_b32 s60, s59, s60
    s_cselect_b32 s61, s62, s61
    s_bitcmp1_b32 s34, 1
    s_cselect_b32 s60, s61, s60
    s_lshl_b32 s60, s60, 15
    s_add_u32 s60, s60, 12582912
    s_add_u32 s60, s60, s28
    s_add_u32 s70, s32, 6
    s_waitcnt vmcnt(16)
    v_subrev_u32 v6, s70, v6
    v_xor_b32 v7, s33, v7
    v_lshrrev_b32 v6, 3, v6
    v_or_b32 v6, v6, v7
    v_cmp_ne_u32 vcc, 0, v6
    s_nop 0
    s_or_b32 vcc_lo, vcc_lo, s40
    s_and_b64 vcc, vcc, s[72:73]
    s_cbranch_vccnz L_interleave_layers__spectral_fnet__swiglu_ffn__prompt_cf_12_retry
L_interleave_layers__spectral_fnet__swiglu_ffn__prompt_cf_12_ok:
    s_barrier
    v_lshlrev_b32 v0, 16, v160
    v_and_b32 v1, 0xffff0000, v160
    v_lshlrev_b32 v2, 16, v161
    v_and_b32 v3, 0xffff0000, v161
    v_lshlrev_b32 v4, 16, v162
    v_and_b32 v5, 0xffff0000, v162
    v_lshlrev_b32 v6, 16, v163
    v_and_b32 v7, 0xffff0000, v163
    v_lshlrev_b32 v8, 16, v164
    v_and_b32 v9, 0xffff0000, v164
    v_lshlrev_b32 v10, 16, v165
    v_and_b32 v11, 0xffff0000, v165
    v_lshlrev_b32 v12, 16, v166
    v_and_b32 v13, 0xffff0000, v166
    v_lshlrev_b32 v14, 16, v167
    v_and_b32 v15, 0xffff0000, v167
    s_lshl_b32 s57, s51, 12
    s_lshl_b32 s58, s38, 9
    s_add_u32 s57, s57, s58
    s_lshr_b32 s58, s34, 1
    s_lshl_b32 s58, s58, 3
    s_add_u32 s57, s57, s58
    s_add_u32 s57, s57, 5242880
    s_mov_b32 s74, 0
    s_waitcnt vmcnt(13)
    v_max3_u32 v16, v184, v185, v186
    s_waitcnt vmcnt(10)
    v_max3_u32 v17, v187, v188, v189
    s_waitcnt vmcnt(7)
    v_max3_u32 v18, v190, v191, v192
    s_waitcnt vmcnt(4)
    v_max3_u32 v19, v193, v194, v195
    s_waitcnt vmcnt(1)
    v_max3_u32 v20, v196, v197, v198
    v_max3_u32 v16, v16, v17, v18
    s_waitcnt vmcnt(0)
    v_max3_u32 v19, v19, v20, v199
    v_max_u32 v16, v16, v19
    v_cmp_eq_u32 vcc, -1, v16
    s_nop 0
    s_cbranch_vccnz L_z1_retry
L_z1_ok:
    s_mov_b32 s56, s53
    v_mfma_f32_32x32x16_bf16 v[0:15], v[184:187], v[128:131], v[0:15]
    v_mfma_f32_32x32x16_bf16 v[0:15], v[188:191], v[132:135], v[0:15]
    v_mfma_f32_32x32x16_bf16 v[0:15], v[192:195], v[136:139], v[0:15]
    v_mfma_f32_32x32x16_bf16 v[0:15], v[196:199], v[140:143], v[0:15]
    s_nop 11
    v_cvt_pk_bf16_f32 v16, v0, v1
    v_cvt_pk_bf16_f32 v17, v2, v3
    v_cvt_pk_bf16_f32 v18, v4, v5
    v_cvt_pk_bf16_f32 v19, v6, v7
    buffer_store_dwordx4 v[16:19], v255, s[24:27], s56 offen offset:0
    v_cvt_pk_bf16_f32 v20, v8, v9
    v_cvt_pk_bf16_f32 v21, v10, v11
    v_cvt_pk_bf16_f32 v22, v12, v13
    v_cvt_pk_bf16_f32 v23, v14, v15
    buffer_store_dwordx4 v[20:23], v255, s[24:27], s56 offen offset:1024
    v_pk_add_f32 v[24:25], v[0:1], v[2:3]
    v_pk_mul_f32 v[26:27], v[0:1], v[0:1]
    v_pk_fma_f32 v[26:27], v[2:3], v[2:3], v[26:27]
    v_pk_add_f32 v[24:25], v[24:25], v[4:5]
    v_pk_fma_f32 v[26:27], v[4:5], v[4:5], v[26:27]
    v_pk_add_f32 v[24:25], v[24:25], v[6:7]
    v_pk_fma_f32 v[26:27], v[6:7], v[6:7], v[26:27]
    v_pk_add_f32 v[24:25], v[24:25], v[8:9]
    v_pk_fma_f32 v[26:27], v[8:9], v[8:9], v[26:27]
    v_pk_add_f32 v[24:25], v[24:25], v[10:11]
    v_pk_fma_f32 v[26:27], v[10:11], v[10:11], v[26:27]
    v_pk_add_f32 v[24:25], v[24:25], v[12:13]
    v_pk_fma_f32 v[26:27], v[12:13], v[12:13], v[26:27]
    v_pk_add_f32 v[24:25], v[24:25], v[14:15]
    v_pk_fma_f32 v[26:27], v[14:15], v[14:15], v[26:27]
    v_add_f32 v24, v24, v25
    v_add_f32 v25, v26, v27
    v_mov_b32 v26, v24
    v_mov_b32 v27, v25
    v_lshlrev_b32 v28, 4, v254
    v_lshl_add_u32 v28, v253, 30, v28
    v_permlane32_swap_b32 v24, v26
    v_permlane32_swap_b32 v25, v27
    v_add_f32 v24, v24, v26
    v_add_f32 v25, v25, v27
    buffer_store_dwordx2 v[24:25], v28, s[24:27], s57 offen
    s_add_u32 s56, s32, 7
    v_mov_b32 v2, s56
    v_mov_b32 v3, s33
    s_cmp_lg_u32 s40, 0
    s_waitcnt vmcnt(0)
    s_barrier
    s_cbranch_scc1 L_interleave_layers__spectral_fnet__swiglu_ffn__prompt_pb_13_slow
    buffer_store_dwordx2 v[2:3], v249, s[24:27], 0 offen
L_interleave_layers__spectral_fnet__swiglu_ffn__prompt_pb_13_back:
    s_lshl_b32 s57, s35, 2
    s_add_u32 s57, s57, s34
    s_lshl_b32 s57, s57, 1
    s_mul_i32 s58, s57, 86
    s_add_u32 s58, s58, s42
    s_lshl_b32 s58, s58, 10
    s_add_u32 s58, s58, 6291456
    s_add_u32 s58, s58, s28
    s_add_u32 s59, s58, 88064
    s_add_u32 s62, s57, 1
    v_lshlrev_b32 v151, 4, v254
    v_lshl_add_u32 v151, v253, 11, v151
    s_mul_i32 s48, s44, 86
    s_mul_i32 s50, s34, 22
    s_add_u32 s48, s48, s50
    s_lshl_b32 s48, s48, 10
    s_add_u32 s48, s48, 6291456
    s_add_u32 s49, s48, 88064
    s_lshr_b32 s50, s34, 1
    s_and_b32 s50, s50, s34
    s_mul_i32 s50, s50, 1073721344
    s_add_u32 s50, s50, 20480
    s_lshl_b32 s52, s38, 2
    s_add_u32 s52, s52, s34
    s_lshl_b32 s51, s39, 5
    s_add_u32 s51, s51, s52
    s_lshl_b32 s51, s51, 10
    s_add_u32 s51, s51, 12582912
    ds_read_b128 v[80:83], v255 offset:0
    ds_read_b128 v[84:87], v255 offset:1024
    ds_read_b128 v[88:91], v255 offset:2048
    ds_read_b128 v[92:95], v255 offset:3072
    ds_read_b128 v[96:99], v255 offset:4096
    ds_read_b128 v[100:103], v255 offset:5120
    v_lshl_add_u32 v4, v254, 3, s46
    s_andn2_b32 s71, 1073741824, s72
    buffer_load_dwordx2 v[6:7], v4, s[24:27], s71 offen sc1
    s_add_u32 s70, s32, 7
    s_waitcnt vmcnt(0)
    v_subrev_u32 v6, s70, v6
    v_xor_b32 v7, s33, v7
    v_lshrrev_b32 v6, 3, v6
    v_or_b32 v6, v6, v7
    v_cmp_ne_u32 vcc, 0, v6
    s_nop 0
    s_or_b32 vcc_lo, vcc_lo, s40
    s_and_b64 vcc, vcc, s[72:73]
    s_cbranch_vccnz L_interleave_layers__spectral_fnet__swiglu_ffn__prompt_cf_14_retry
L_interleave_layers__spectral_fnet__swiglu_ffn__prompt_cf_14_ok:
    s_barrier
    s_cmp_lg_u32 s28, 0
    s_cbranch_scc1 L_idle1
    s_add_u32 s61, s60, 0
    buffer_load_dwordx4 v[152:155], v255, s[24:27], s61 offen offset:0 sc1
    buffer_load_dwordx4 v[156:159], v255, s[24:27], s61 offen offset:1024 sc1
    buffer_load_dwordx4 v[160:163], v255, s[24:27], s61 offen offset:2048 sc1
    buffer_load_dwordx4 v[164:167], v255, s[24:27], s61 offen offset:3072 sc1
    s_add_u32 s61, s60, 4096
    buffer_load_dwordx4 v[168:171], v255, s[24:27], s61 offen offset:0 sc1
    buffer_load_dwordx4 v[172:175], v255, s[24:27], s61 offen offset:1024 sc1
    s_waitcnt vmcnt(5) lgkmcnt(4)
    v_mfma_f32_32x32x16_bf16 v[0:15], v[80:83], v[152:155], 0
    ds_read_b128 v[104:107], v255 offset:6144
    v_mfma_f32_32x32x16_bf16 v[16:31], v[84:87], v[152:155], 0
    ds_read_b128 v[108:111], v255 offset:7168
    s_waitcnt vmcnt(4) lgkmcnt(4)
    v_mfma_f32_32x32x16_bf16 v[32:47], v[88:91], v[152:155], 0
    ds_read_b128 v[80:83], v255 offset:8192
    buffer_load_dwordx4 v[176:179], v255, s[24:27], s61 offen offset:2048 sc1
    v_mfma_f32_32x32x16_bf16 v[0:15], v[92:95], v[156:159], v[0:15]
    ds_read_b128 v[84:87], v255 offset:9216
    s_waitcnt lgkmcnt(4)
    v_mfma_f32_32x32x16_bf16 v[16:31], v[96:99], v[156:159], v[16:31]
    ds_read_b128 v[88:91], v255 offset:10240
    buffer_load_dwordx4 v[180:183], v255, s[24:27], s61 offen offset:3072 sc1
    v_mfma_f32_32x32x16_bf16 v[32:47], v[100:103], v[156:159], v[32:47]
    ds_read_b128 v[92:95], v255 offset:11264
    s_waitcnt vmcnt(5) lgkmcnt(4)
    v_mfma_f32_32x32x16_bf16 v[0:15], v[104:107], v[160:163], v[0:15]
    ds_read_b128 v[96:99], v255 offset:12288
    v_mfma_f32_32x32x16_bf16 v[16:31], v[108:111], v[160:163], v[16:31]
    ds_read_b128 v[100:103], v255 offset:13312
    s_add_u32 s61, s60, 8192
    buffer_load_dwordx4 v[184:187], v255, s[24:27], s61 offen offset:0 sc1
    s_waitcnt vmcnt(5) lgkmcnt(4)
    v_mfma_f32_32x32x16_bf16 v[32:47], v[80:83], v[160:163], v[32:47]
    ds_read_b128 v[104:107], v255 offset:14336
    v_mfma_f32_32x32x16_bf16 v[0:15], v[84:87], v[164:167], v[0:15]
    ds_read_b128 v[108:111], v255 offset:15360
    buffer_load_dwordx4 v[188:191], v255, s[24:27], s61 offen offset:1024 sc1
    s_waitcnt lgkmcnt(4)
    v_mfma_f32_32x32x16_bf16 v[16:31], v[88:91], v[164:167], v[16:31]
    ds_read_b128 v[80:83], v255 offset:16384
    v_mfma_f32_32x32x16_bf16 v[32:47], v[92:95], v[164:167], v[32:47]
    ds_read_b128 v[84:87], v255 offset:17408
    s_lshl_b32 s63, s57, 12
    s_add_u32 s63, s63, 5242880
    buffer_load_dwordx4 v[112:115], v151, s[24:27], s63 offen offset:0 sc1
    s_waitcnt vmcnt(6) lgkmcnt(4)
    v_mfma_f32_32x32x16_bf16 v[0:15], v[96:99], v[168:171], v[0:15]
    ds_read_b128 v[88:91], v255 offset:18432
    buffer_load_dwordx4 v[192:195], v255, s[24:27], s61 offen offset:2048 sc1
    v_mfma_f32_32x32x16_bf16 v[16:31], v[100:103], v[168:171], v[16:31]
    ds_read_b128 v[92:95], v255 offset:19456
    buffer_load_dwordx4 v[116:119], v151, s[24:27], s63 offen offset:512 sc1
    s_waitcnt vmcnt(7) lgkmcnt(4)
    v_mfma_f32_32x32x16_bf16 v[32:47], v[104:107], v[168:171], v[32:47]
    ds_read_b128 v[96:99], v255 offset:20480
    buffer_load_dwordx4 v[196:199], v255, s[24:27], s61 offen offset:3072 sc1
    v_mfma_f32_32x32x16_bf16 v[0:15], v[108:111], v[172:175], v[0:15]
    ds_read_b128 v[100:103], v255 offset:21504
    buffer_load_dwordx4 v[120:123], v151, s[24:27], s63 offen offset:1024 sc1
    s_waitcnt lgkmcnt(4)
    v_mfma_f32_32x32x16_bf16 v[16:31], v[80:83], v[172:175], v[16:31]
    ds_read_b128 v[104:107], v255 offset:22528
    s_add_u32 s61, s60, 12288
    buffer_load_dwordx4 v[200:203], v255, s[24:27], s61 offen offset:0 sc1
    v_mfma_f32_32x32x16_bf16 v[32:47], v[84:87], v[172:175], v[32:47]
    ds_read_b128 v[108:111], v255 offset:23552
    buffer_load_dwordx4 v[124:127], v151, s[24:27], s63 offen offset:1536 sc1
    s_waitcnt vmcnt(10) lgkmcnt(4)
    v_mfma_f32_32x32x16_bf16 v[0:15], v[88:91], v[176:179], v[0:15]
    ds_read_b128 v[80:83], v255 offset:24576
    v_mfma_f32_32x32x16_bf16 v[16:31], v[92:95], v[176:179], v[16:31]
    ds_read_b128 v[84:87], v255 offset:25600
    buffer_load_dwordx4 v[204:207], v255, s[24:27], s61 offen offset:1024 sc1
    s_waitcnt vmcnt(10) lgkmcnt(4)
    v_mfma_f32_32x32x16_bf16 v[32:47], v[96:99], v[176:179], v[32:47]
    ds_read_b128 v[88:91], v255 offset:26624
    v_mfma_f32_32x32x16_bf16 v[0:15], v[100:103], v[180:183], v[0:15]
    ds_read_b128 v[92:95], v255 offset:27648
    buffer_load_dwordx4 v[208:211], v255, s[24:27], s61 offen offset:2048 sc1
    s_waitcnt lgkmcnt(4)
    v_mfma_f32_32x32x16_bf16 v[16:31], v[104:107], v[180:183], v[16:31]
    ds_read_b128 v[96:99], v255 offset:28672
    v_mfma_f32_32x32x16_bf16 v[32:47], v[108:111], v[180:183], v[32:47]
    ds_read_b128 v[100:103], v255 offset:29696
    s_waitcnt vmcnt(10) lgkmcnt(4)
    v_mfma_f32_32x32x16_bf16 v[0:15], v[80:83], v[184:187], v[0:15]
    ds_read_b128 v[104:107], v255 offset:30720
    buffer_load_dwordx4 v[212:215], v255, s[24:27], s61 offen offset:3072 sc1
    v_mfma_f32_32x32x16_bf16 v[16:31], v[84:87], v[184:187], v[16:31]
    ds_read_b128 v[108:111], v255 offset:31744
    s_waitcnt vmcnt(10) lgkmcnt(4)
    v_mfma_f32_32x32x16_bf16 v[32:47], v[88:91], v[184:187], v[32:47]
    ds_read_b128 v[80:83], v255 offset:32768
    s_add_u32 s61, s60, 16384
    buffer_load_dwordx4 v[216:219], v255, s[24:27], s61 offen offset:0 sc1
    v_mfma_f32_32x32x16_bf16 v[0:15], v[92:95], v[188:191], v[0:15]
    ds_read_b128 v[84:87], v255 offset:33792
    s_waitcnt lgkmcnt(4)
    v_mfma_f32_32x32x16_bf16 v[16:31], v[96:99], v[188:191], v[16:31]
    ds_read_b128 v[88:91], v255 offset:34816
    buffer_load_dwordx4 v[220:223], v255, s[24:27], s61 offen offset:1024 sc1
    v_mfma_f32_32x32x16_bf16 v[32:47], v[100:103], v[188:191], v[32:47]
    ds_read_b128 v[92:95], v255 offset:35840
    s_waitcnt vmcnt(10) lgkmcnt(4)
    v_mfma_f32_32x32x16_bf16 v[0:15], v[104:107], v[192:195], v[0:15]
    ds_read_b128 v[96:99], v255 offset:36864
    v_mfma_f32_32x32x16_bf16 v[16:31], v[108:111], v[192:195], v[16:31]
    ds_read_b128 v[100:103], v255 offset:37888
    buffer_load_dwordx4 v[224:227], v255, s[24:27], s61 offen offset:2048 sc1
    s_waitcnt vmcnt(9) lgkmcnt(4)
    v_mfma_f32_32x32x16_bf16 v[32:47], v[80:83], v[192:195], v[32:47]
    ds_read_b128 v[104:107], v255 offset:38912
    v_mfma_f32_32x32x16_bf16 v[0:15], v[84:87], v[196:199], v[0:15]
    ds_read_b128 v[108:111], v255 offset:39936
    buffer_load_dwordx4 v[228:231], v255, s[24:27], s61 offen offset:3072 sc1
    s_waitcnt lgkmcnt(4)
    v_mfma_f32_32x32x16_bf16 v[16:31], v[88:91], v[196:199], v[16:31]
    ds_read_b128 v[80:83], v255 offset:40960
    v_mfma_f32_32x32x16_bf16 v[32:47], v[92:95], v[196:199], v[32:47]
    ds_read_b128 v[84:87], v255 offset:41984
    s_waitcnt vmcnt(8) lgkmcnt(4)
    v_mfma_f32_32x32x16_bf16 v[0:15], v[96:99], v[200:203], v[0:15]
    ds_read_b128 v[88:91], v255 offset:43008
    s_add_u32 s61, s60, 20480
    buffer_load_dwordx4 v[232:235], v255, s[24:27], s61 offen offset:0 sc1
    v_mfma_f32_32x32x16_bf16 v[16:31], v[100:103], v[200:203], v[16:31]
    ds_read_b128 v[92:95], v255 offset:44032
    s_waitcnt vmcnt(7) lgkmcnt(4)
    v_mfma_f32_32x32x16_bf16 v[32:47], v[104:107], v[200:203], v[32:47]
    ds_read_b128 v[96:99], v255 offset:45056
    buffer_load_dwordx4 v[236:239], v255, s[24:27], s61 offen offset:1024 sc1
    v_mfma_f32_32x32x16_bf16 v[0:15], v[108:111], v[204:207], v[0:15]
    ds_read_b128 v[100:103], v255 offset:46080
    s_waitcnt lgkmcnt(4)
    v_mfma_f32_32x32x16_bf16 v[16:31], v[80:83], v[204:207], v[16:31]
    ds_read_b128 v[104:107], v255 offset:47104
    buffer_load_dwordx4 v[240:243], v255, s[24:27], s61 offen offset:2048 sc1
    v_add_f32 v112, v112, v114
    v_add_f32 v113, v113, v115
    v_add_f32 v112, v112, v116
    v_add_f32 v113, v113, v117
    v_mfma_f32_32x32x16_bf16 v[32:47], v[84:87], v[204:207], v[32:47]
    ds_read_b128 v[108:111], v255 offset:48128
    v_add_f32 v112, v112, v118
    v_add_f32 v113, v113, v119
    v_add_f32 v112, v112, v120
    v_add_f32 v113, v113, v121
    s_waitcnt vmcnt(8) lgkmcnt(4)
    v_mfma_f32_32x32x16_bf16 v[0:15], v[88:91], v[208:211], v[0:15]
    ds_read_b128 v[80:83], v250 offset:0
    v_add_f32 v112, v112, v122
    v_add_f32 v113, v113, v123
    v_add_f32 v112, v112, v124
    v_add_f32 v113, v113, v125
    v_add_f32 v112, v112, v126
    v_mfma_f32_32x32x16_bf16 v[16:31], v[92:95], v[208:211], v[16:31]
    ds_read_b128 v[84:87], v250 offset:1024
    buffer_load_dwordx4 v[244:247], v255, s[24:27], s61 offen offset:3072 sc1
    v_add_f32 v113, v113, v127
    v_mov_b32 v114, v112
    v_mov_b32 v115, v113
    s_waitcnt vmcnt(8) lgkmcnt(4)
    v_mfma_f32_32x32x16_bf16 v[32:47], v[96:99], v[208:211], v[32:47]
    ds_read_b128 v[88:91], v250 offset:2048
    s_nop 0
    v_permlane32_swap_b32 v112, v114
    v_permlane32_swap_b32 v113, v115
    v_add_f32 v112, v112, v114
    v_add_f32 v113, v113, v115
    v_mfma_f32_32x32x16_bf16 v[0:15], v[100:103], v[212:215], v[0:15]
    ds_read_b128 v[92:95], v250 offset:3072
    s_add_u32 s61, s60, 24576
    buffer_load_dwordx4 a[224:227], v255, s[24:27], s61 offen offset:0 sc1
    v_mul_f32 v112, 0xbb000000, v112
    v_mul_f32 v114, v112, v112
    s_waitcnt lgkmcnt(4)
    v_mfma_f32_32x32x16_bf16 v[16:31], v[104:107], v[212:215], v[16:31]
    ds_read_b128 v[96:99], v250 offset:4096
    v_fma_f32 v113, v113, s45, -v114
    v_max_f32 v113, 0, v113
    v_add_f32 v128, 0x3727c5ac, v113
    v_rsq_f32 v129, v128
    v_mfma_f32_32x32x16_bf16 v[32:47], v[108:111], v[212:215], v[32:47]
    ds_read_b128 v[100:103], v250 offset:5120
    v_cvt_pk_bf16_f32 v132, v112, v112
    v_mul_f32 v129, 0xbfb8aa3b, v129
    v_lshlrev_b32 v114, 16, v132
    v_sub_f32 v114, v112, v114
    s_waitcnt vmcnt(8) lgkmcnt(4)
    v_mfma_f32_32x32x16_bf16 v[0:15], v[80:83], v[216:219], v[0:15]
    ds_read_b128 v[104:107], v250 offset:6144
    buffer_load_dwordx4 a[228:231], v255, s[24:27], s61 offen offset:1024 sc1
    v_cvt_pk_bf16_f32 v133, v114, 0
    v_mov_b32 v134, 0
    v_mov_b32 v135, 0
    v_mfma_f32_32x32x16_bf16 v[16:31], v[84:87], v[216:219], v[16:31]
    ds_read_b128 v[108:111], v250 offset:7168
    s_waitcnt vmcnt(8) lgkmcnt(4)
    v_mfma_f32_32x32x16_bf16 v[32:47], v[88:91], v[216:219], v[32:47]
    ds_read_b128 v[80:83], v250 offset:8192
    buffer_load_dwordx4 a[232:235], v255, s[24:27], s61 offen offset:2048 sc1
    v_mfma_f32_32x32x16_bf16 v[0:15], v[92:95], v[220:223], v[0:15]
    ds_read_b128 v[84:87], v250 offset:9216
    s_waitcnt lgkmcnt(4)
    v_mfma_f32_32x32x16_bf16 v[16:31], v[96:99], v[220:223], v[16:31]
    ds_read_b128 v[88:91], v250 offset:10240
    buffer_load_dwordx4 a[236:239], v255, s[24:27], s61 offen offset:3072 sc1
    v_mfma_f32_32x32x16_bf16 v[32:47], v[100:103], v[220:223], v[32:47]
    ds_read_b128 v[92:95], v250 offset:11264
    s_waitcnt vmcnt(9) lgkmcnt(4)
    v_mfma_f32_32x32x16_bf16 v[0:15], v[104:107], v[224:227], v[0:15]
    ds_read_b128 v[96:99], v250 offset:12288
    v_mfma_f32_32x32x16_bf16 v[16:31], v[108:111], v[224:227], v[16:31]
    ds_read_b128 v[100:103], v250 offset:13312
    s_add_u32 s61, s60, 28672
    buffer_load_dwordx4 a[240:243], v255, s[24:27], s61 offen offset:0 sc1
    s_waitcnt vmcnt(9) lgkmcnt(4)
    v_mfma_f32_32x32x16_bf16 v[32:47], v[80:83], v[224:227], v[32:47]
    ds_read_b128 v[104:107], v250 offset:14336
    v_mfma_f32_32x32x16_bf16 v[0:15], v[84:87], v[228:231], v[0:15]
    ds_read_b128 v[108:111], v250 offset:15360
    buffer_load_dwordx4 a[244:247], v255, s[24:27], s61 offen offset:1024 sc1
    s_waitcnt lgkmcnt(4)
    v_mfma_f32_32x32x16_bf16 v[16:31], v[88:91], v[228:231], v[16:31]
    ds_read_b128 v[80:83], v250 offset:16384
    v_mfma_f32_32x32x16_bf16 v[32:47], v[92:95], v[228:231], v[32:47]
    ds_read_b128 v[84:87], v250 offset:17408
    s_waitcnt vmcnt(9) lgkmcnt(4)
    v_mfma_f32_32x32x16_bf16 v[0:15], v[96:99], v[232:235], v[0:15]
    ds_read_b128 v[88:91], v250 offset:18432
    buffer_load_dwordx4 a[248:251], v255, s[24:27], s61 offen offset:2048 sc1
    v_mfma_f32_32x32x16_bf16 v[16:31], v[100:103], v[232:235], v[16:31]
    ds_read_b128 v[92:95], v250 offset:19456
    s_waitcnt vmcnt(9) lgkmcnt(4)
    v_mfma_f32_32x32x16_bf16 v[32:47], v[104:107], v[232:235], v[32:47]
    ds_read_b128 v[96:99], v250 offset:20480
    buffer_load_dwordx4 a[252:255], v255, s[24:27], s61 offen offset:3072 sc1
    v_mfma_f32_32x32x16_bf16 v[0:15], v[108:111], v[236:239], v[0:15]
    ds_read_b128 v[100:103], v250 offset:21504
    s_lshl_b32 s63, s62, 12
    s_add_u32 s63, s63, 5242880
    buffer_load_dwordx4 v[112:115], v151, s[24:27], s63 offen offset:0 sc1
    s_waitcnt lgkmcnt(4)
    v_mfma_f32_32x32x16_bf16 v[16:31], v[80:83], v[236:239], v[16:31]
    ds_read_b128 v[104:107], v250 offset:22528
    s_add_u32 s61, s60, 1048576
    buffer_load_dwordx4 v[152:155], v255, s[24:27], s61 offen offset:0 sc1
    v_mfma_f32_32x32x16_bf16 v[32:47], v[84:87], v[236:239], v[32:47]
    ds_read_b128 v[108:111], v250 offset:23552
    buffer_load_dwordx4 v[116:119], v151, s[24:27], s63 offen offset:512 sc1
    s_waitcnt vmcnt(12) lgkmcnt(4)
    v_mfma_f32_32x32x16_bf16 v[0:15], v[88:91], v[240:243], v[0:15]
    ds_read_b128 v[80:83], v250 offset:24576
    v_mfma_f32_32x32x16_bf16 v[16:31], v[92:95], v[240:243], v[16:31]
    ds_read_b128 v[84:87], v250 offset:25600
    buffer_load_dwordx4 v[156:159], v255, s[24:27], s61 offen offset:1024 sc1
    s_waitcnt vmcnt(12) lgkmcnt(4)
    v_mfma_f32_32x32x16_bf16 v[32:47], v[96:99], v[240:243], v[32:47]
    ds_read_b128 v[88:91], v250 offset:26624
    v_mfma_f32_32x32x16_bf16 v[0:15], v[100:103], v[244:247], v[0:15]
    ds_read_b128 v[92:95], v250 offset:27648
    buffer_load_dwordx4 v[160:163], v255, s[24:27], s61 offen offset:2048 sc1
    s_waitcnt lgkmcnt(4)
    v_mfma_f32_32x32x16_bf16 v[16:31], v[104:107], v[244:247], v[16:31]
    ds_read_b128 v[96:99], v250 offset:28672
    v_mfma_f32_32x32x16_bf16 v[32:47], v[108:111], v[244:247], v[32:47]
    ds_read_b128 v[100:103], v250 offset:29696
    buffer_load_dwordx4 v[120:123], v151, s[24:27], s63 offen offset:1024 sc1
    s_waitcnt vmcnt(13) lgkmcnt(4)
    v_mfma_f32_32x32x16_bf16 v[0:15], v[80:83], a[224:227], v[0:15]
    ds_read_b128 v[104:107], v250 offset:30720
    buffer_load_dwordx4 v[164:167], v255, s[24:27], s61 offen offset:3072 sc1
    v_mfma_f32_32x32x16_bf16 v[16:31], v[84:87], a[224:227], v[16:31]
    ds_read_b128 v[108:111], v250 offset:31744
    buffer_load_dwordx4 v[124:127], v151, s[24:27], s63 offen offset:1536 sc1
    s_waitcnt vmcnt(14) lgkmcnt(4)
    v_mfma_f32_32x32x16_bf16 v[32:47], v[88:91], a[224:227], v[32:47]
    ds_read_b128 v[80:83], v250 offset:32768
    s_add_u32 s61, s60, 1052672
    buffer_load_dwordx4 v[168:171], v255, s[24:27], s61 offen offset:0 sc1
    v_mfma_f32_32x32x16_bf16 v[0:15], v[92:95], a[228:231], v[0:15]
L_pad4:
    s_cbranch_execz L_pad8
    ds_read_b128 v[84:87], v250 offset:33792
    s_waitcnt lgkmcnt(4)
    v_mfma_f32_32x32x16_bf16 v[16:31], v[96:99], a[228:231], v[16:31]
    ds_read_b128 v[88:91], v250 offset:34816
    buffer_load_dwordx4 v[172:175], v255, s[24:27], s61 offen offset:1024 sc1
    v_mfma_f32_32x32x16_bf16 v[32:47], v[100:103], a[228:231], v[32:47]
    ds_read_b128 v[92:95], v250 offset:35840
    s_waitcnt vmcnt(15) lgkmcnt(4)
    v_mfma_f32_32x32x16_bf16 v[0:15], v[104:107], a[232:235], v[0:15]
    ds_read_b128 v[96:99], v250 offset:36864
    v_mfma_f32_32x32x16_bf16 v[16:31], v[108:111], a[232:235], v[16:31]
    ds_read_b128 v[100:103], v250 offset:37888
    buffer_load_dwordx4 v[176:179], v255, s[24:27], s61 offen offset:2048 sc1
    s_waitcnt vmcnt(15) lgkmcnt(4)
    v_mfma_f32_32x32x16_bf16 v[32:47], v[80:83], a[232:235], v[32:47]
    ds_read_b128 v[104:107], v250 offset:38912
    v_mfma_f32_32x32x16_bf16 v[0:15], v[84:87], a[236:239], v[0:15]
    ds_read_b128 v[108:111], v250 offset:39936
    buffer_load_dwordx4 v[180:183], v255, s[24:27], s61 offen offset:3072 sc1
    s_waitcnt lgkmcnt(4)
    v_mfma_f32_32x32x16_bf16 v[16:31], v[88:91], a[236:239], v[16:31]
    ds_read_b128 v[80:83], v250 offset:40960
    v_mfma_f32_32x32x16_bf16 v[32:47], v[92:95], a[236:239], v[32:47]
    ds_read_b128 v[84:87], v250 offset:41984
    s_waitcnt vmcnt(15) lgkmcnt(4)
    v_mfma_f32_32x32x16_bf16 v[0:15], v[96:99], a[240:243], v[0:15]
    ds_read_b128 v[88:91], v250 offset:43008
    s_add_u32 s61, s60, 1056768
    buffer_load_dwordx4 v[184:187], v255, s[24:27], s61 offen offset:0 sc1
    s_waitcnt vmcnt(12)
    v_add_f32 v112, v112, v114
    v_add_f32 v113, v113, v115
    s_waitcnt vmcnt(10)
    v_add_f32 v112, v112, v116
    v_mfma_f32_32x32x16_bf16 v[16:31], v[100:103], a[240:243], v[16:31]
    ds_read_b128 v[92:95], v250 offset:44032
    v_add_f32 v113, v113, v117
    v_add_f32 v112, v112, v118
    v_add_f32 v113, v113, v119
    s_waitcnt vmcnt(7)
    v_add_f32 v112, v112, v120
    s_waitcnt lgkmcnt(4)
    v_mfma_f32_32x32x16_bf16 v[32:47], v[104:107], a[240:243], v[32:47]
    ds_read_b128 v[96:99], v250 offset:45056
    buffer_load_dwordx4 v[188:191], v255, s[24:27], s61 offen offset:1024 sc1
    v_add_f32 v113, v113, v121
    v_add_f32 v112, v112, v122
    v_add_f32 v113, v113, v123
    s_waitcnt vmcnt(6)
    v_add_f32 v112, v112, v124
    v_mfma_f32_32x32x16_bf16 v[0:15], v[108:111], a[244:247], v[0:15]
    ds_read_b128 v[100:103], v250 offset:46080
    v_add_f32 v113, v113, v125
    v_add_f32 v112, v112, v126
    v_add_f32 v113, v113, v127
    v_mov_b32 v114, v112
    s_waitcnt lgkmcnt(4)
    v_mfma_f32_32x32x16_bf16 v[16:31], v[80:83], a[244:247], v[16:31]
    ds_read_b128 v[104:107], v250 offset:47104
    buffer_load_dwordx4 v[192:195], v255, s[24:27], s61 offen offset:2048 sc1
    v_mov_b32 v115, v113
    s_nop 0
    v_permlane32_swap_b32 v112, v114
    v_permlane32_swap_b32 v113, v115
    v_mfma_f32_32x32x16_bf16 v[32:47], v[84:87], a[244:247], v[32:47]
    ds_read_b128 v[108:111], v250 offset:48128
    v_add_f32 v112, v112, v114
    v_add_f32 v113, v113, v115
    v_mul_f32 v112, 0xbb000000, v112
    v_mul_f32 v114, v112, v112
    s_waitcnt lgkmcnt(4)
    v_mfma_f32_32x32x16_bf16 v[0:15], v[88:91], a[248:251], v[0:15]
    ds_read_b128 v[80:83], v255 offset:0
    v_fma_f32 v113, v113, s45, -v114
    v_max_f32 v113, 0, v113
    v_add_f32 v130, 0x3727c5ac, v113
    v_rsq_f32 v131, v130
    v_mfma_f32_32x32x16_bf16 v[16:31], v[92:95], a[248:251], v[16:31]
    ds_read_b128 v[84:87], v255 offset:1024
    buffer_load_dwordx4 v[196:199], v255, s[24:27], s61 offen offset:3072 sc1
    v_cvt_pk_bf16_f32 v136, v112, v112
    v_mul_f32 v131, 0xbfb8aa3b, v131
    v_lshlrev_b32 v114, 16, v136
    s_waitcnt lgkmcnt(4)
    v_mfma_f32_32x32x16_bf16 v[32:47], v[96:99], a[248:251], v[32:47]
    ds_read_b128 v[88:91], v255 offset:3072
    v_sub_f32 v114, v112, v114
    v_cvt_pk_bf16_f32 v137, v114, 0
    v_mov_b32 v138, 0
    v_mov_b32 v139, 0
    v_mfma_f32_32x32x16_bf16 v[0:15], v[100:103], a[252:255], v[0:15]
    ds_read_b128 v[92:95], v255 offset:4096
    s_add_u32 s61, s60, 1060864
    buffer_load_dwordx4 v[200:203], v255, s[24:27], s61 offen offset:0 sc1
    v_mfma_f32_32x32x16_bf16 v[0:15], a[208:211], v[132:135], v[0:15]
    s_waitcnt lgkmcnt(4)
    v_mfma_f32_32x32x16_bf16 v[16:31], v[104:107], a[252:255], v[16:31]
    ds_read_b128 v[96:99], v255 offset:6144
    v_mfma_f32_32x32x16_bf16 v[16:31], a[212:215], v[132:135], v[16:31]
    v_mfma_f32_32x32x16_bf16 v[32:47], v[108:111], a[252:255], v[32:47]
    ds_read_b128 v[100:103], v255 offset:7168
    v_mfma_f32_32x32x16_bf16 v[32:47], a[216:219], v[132:135], v[32:47]
    s_waitcnt lgkmcnt(4)
    v_mfma_f32_32x32x16_bf16 v[48:63], v[80:83], v[152:155], 0
    ds_read_b128 v[104:107], v255 offset:9216
    buffer_load_dwordx4 v[204:207], v255, s[24:27], s61 offen offset:1024 sc1
    v_mfma_f32_32x32x16_bf16 v[64:79], v[84:87], v[152:155], 0
    ds_read_b128 v[108:111], v255 offset:10240
    s_waitcnt lgkmcnt(4)
    v_mfma_f32_32x32x16_bf16 v[48:63], v[88:91], v[156:159], v[48:63]
    ds_read_b128 v[80:83], v255 offset:12288
    buffer_load_dwordx4 v[208:211], v255, s[24:27], s61 offen offset:2048 sc1
    v_mul_f32 v140, v0, v129
    v_mul_f32 v141, v1, v129
    v_mul_f32 v142, v2, v129
    v_mul_f32 v143, v3, v129
    v_mfma_f32_32x32x16_bf16 v[64:79], v[92:95], v[156:159], v[64:79]
    ds_read_b128 v[84:87], v255 offset:13312
    v_exp_f32 v140, v140
    v_mul_f32 v0, v0, v8
    s_waitcnt lgkmcnt(4)
    v_mfma_f32_32x32x16_bf16 v[48:63], v[96:99], v[160:163], v[48:63]
    ds_read_b128 v[88:91], v255 offset:15360
    buffer_load_dwordx4 v[212:215], v255, s[24:27], s61 offen offset:3072 sc1
    v_exp_f32 v141, v141
    v_mul_f32 v1, v1, v9
    v_mfma_f32_32x32x16_bf16 v[64:79], v[100:103], v[160:163], v[64:79]
    ds_read_b128 v[92:95], v255 offset:16384
    v_exp_f32 v142, v142
    v_mul_f32 v2, v2, v10
    s_waitcnt lgkmcnt(4)
    v_mfma_f32_32x32x16_bf16 v[48:63], v[104:107], v[164:167], v[48:63]
    ds_read_b128 v[96:99], v255 offset:18432
    v_exp_f32 v143, v143
    v_mul_f32 v3, v3, v11
    v_fma_f32 v140, v140, v128, v128
    v_fma_f32 v141, v141, v128, v128
    v_mfma_f32_32x32x16_bf16 v[64:79], v[108:111], v[164:167], v[64:79]
    ds_read_b128 v[100:103], v255 offset:19456
    s_add_u32 s61, s60, 1064960
    buffer_load_dwordx4 v[216:219], v255, s[24:27], s61 offen offset:0 sc1
    v_fma_f32 v142, v142, v128, v128
    v_fma_f32 v143, v143, v128, v128
    s_waitcnt vmcnt(12) lgkmcnt(4)
    v_mfma_f32_32x32x16_bf16 v[48:63], v[80:83], v[168:171], v[48:63]
    ds_read_b128 v[104:107], v255 offset:21504
    v_rcp_f32 v140, v140
    v_rcp_f32 v141, v141
    v_mfma_f32_32x32x16_bf16 v[64:79], v[84:87], v[168:171], v[64:79]
    ds_read_b128 v[108:111], v255 offset:22528
    buffer_load_dwordx4 v[220:223], v255, s[24:27], s61 offen offset:1024 sc1
    v_rcp_f32 v142, v142
    s_waitcnt vmcnt(12) lgkmcnt(4)
    v_mfma_f32_32x32x16_bf16 v[48:63], v[88:91], v[172:175], v[48:63]
    ds_read_b128 v[80:83], v255 offset:24576
    v_rcp_f32 v143, v143
    v_mul_f32 v0, v0, v140
    v_mul_f32 v1, v1, v141
    v_mul_f32 v2, v2, v142
    v_mfma_f32_32x32x16_bf16 v[64:79], v[92:95], v[172:175], v[64:79]
    ds_read_b128 v[84:87], v255 offset:25600
    v_mul_f32 v3, v3, v143
    v_cvt_pk_bf16_f32 v144, v0, v1
    v_cvt_pk_bf16_f32 v145, v2, v3
    v_mul_f32 v140, v4, v129
    s_waitcnt vmcnt(11) lgkmcnt(4)
    v_mfma_f32_32x32x16_bf16 v[48:63], v[96:99], v[176:179], v[48:63]
    ds_read_b128 v[88:91], v255 offset:27648
    buffer_load_dwordx4 v[224:227], v255, s[24:27], s61 offen offset:2048 sc1
    v_mul_f32 v141, v5, v129
    v_mul_f32 v142, v6, v129
    v_mul_f32 v143, v7, v129
    v_mfma_f32_32x32x16_bf16 v[64:79], v[100:103], v[176:179], v[64:79]
    ds_read_b128 v[92:95], v255 offset:28672
    v_exp_f32 v140, v140
    v_mul_f32 v4, v4, v12
    s_waitcnt vmcnt(11) lgkmcnt(4)
    v_mfma_f32_32x32x16_bf16 v[48:63], v[104:107], v[180:183], v[48:63]
    ds_read_b128 v[96:99], v255 offset:30720
    buffer_load_dwordx4 v[228:231], v255, s[24:27], s61 offen offset:3072 sc1
    v_exp_f32 v141, v141
    v_mul_f32 v5, v5, v13
    v_mfma_f32_32x32x16_bf16 v[64:79], v[108:111], v[180:183], v[64:79]
    ds_read_b128 v[100:103], v255 offset:31744
    v_exp_f32 v142, v142
    v_mul_f32 v6, v6, v14
    s_waitcnt vmcnt(11) lgkmcnt(4)
    v_mfma_f32_32x32x16_bf16 v[48:63], v[80:83], v[184:187], v[48:63]
    ds_read_b128 v[104:107], v255 offset:33792
    s_add_u32 s61, s60, 1069056
    buffer_load_dwordx4 v[232:235], v255, s[24:27], s61 offen offset:0 sc1
    v_exp_f32 v143, v143
    v_mul_f32 v7, v7, v15
    v_mfma_f32_32x32x16_bf16 v[64:79], v[84:87], v[184:187], v[64:79]
    ds_read_b128 v[108:111], v255 offset:34816
    v_fma_f32 v140, v140, v128, v128
    v_fma_f32 v141, v141, v128, v128
    v_fma_f32 v142, v142, v128, v128
    v_fma_f32 v143, v143, v128, v128
    s_waitcnt vmcnt(11) lgkmcnt(4)
    v_mfma_f32_32x32x16_bf16 v[48:63], v[88:91], v[188:191], v[48:63]
    ds_read_b128 v[80:83], v255 offset:36864
    v_rcp_f32 v140, v140
    v_rcp_f32 v141, v141
    v_mfma_f32_32x32x16_bf16 v[64:79], v[92:95], v[188:191], v[64:79]
    ds_read_b128 v[84:87], v255 offset:37888
    buffer_load_dwordx4 v[236:239], v255, s[24:27], s61 offen offset:1024 sc1
    v_rcp_f32 v142, v142
    s_waitcnt vmcnt(11) lgkmcnt(4)
    v_mfma_f32_32x32x16_bf16 v[48:63], v[96:99], v[192:195], v[48:63]
    ds_read_b128 v[88:91], v255 offset:39936
    v_rcp_f32 v143, v143
    v_mul_f32 v4, v4, v140
    v_mul_f32 v5, v5, v141
    v_mul_f32 v6, v6, v142
    v_mfma_f32_32x32x16_bf16 v[64:79], v[100:103], v[192:195], v[64:79]
    ds_read_b128 v[92:95], v255 offset:40960
    buffer_load_dwordx4 v[240:243], v255, s[24:27], s61 offen offset:2048 sc1
    v_mul_f32 v7, v7, v143
    v_cvt_pk_bf16_f32 v146, v4, v5
    v_cvt_pk_bf16_f32 v147, v6, v7
    s_waitcnt vmcnt(11) lgkmcnt(4)
    v_mfma_f32_32x32x16_bf16 v[48:63], v[104:107], v[196:199], v[48:63]
    ds_read_b128 v[96:99], v255 offset:43008
    buffer_store_dwordx4 v[144:147], v255, s[24:27], s58 offen offset:0 sc1
    v_mul_f32 v140, v16, v129
    v_mul_f32 v141, v17, v129
    v_mul_f32 v142, v18, v129
    v_mul_f32 v143, v19, v129
    v_mfma_f32_32x32x16_bf16 v[64:79], v[108:111], v[196:199], v[64:79]
    ds_read_b128 v[100:103], v255 offset:44032
    v_exp_f32 v140, v140
    v_mul_f32 v16, v16, v24
    s_waitcnt vmcnt(11) lgkmcnt(4)
    v_mfma_f32_32x32x16_bf16 v[48:63], v[80:83], v[200:203], v[48:63]
    ds_read_b128 v[104:107], v255 offset:46080
    buffer_load_dwordx4 v[244:247], v255, s[24:27], s61 offen offset:3072 sc1
    v_exp_f32 v141, v141
    v_mul_f32 v17, v17, v25
    v_mfma_f32_32x32x16_bf16 v[64:79], v[84:87], v[200:203], v[64:79]
    ds_read_b128 v[108:111], v255 offset:47104
    v_exp_f32 v142, v142
    v_mul_f32 v18, v18, v26
    s_waitcnt vmcnt(11) lgkmcnt(4)
    v_mfma_f32_32x32x16_bf16 v[48:63], v[88:91], v[204:207], v[48:63]
    ds_read_b128 v[80:83], v250 offset:0
    s_add_u32 s61, s60, 1073152
    buffer_load_dwordx4 a[224:227], v255, s[24:27], s61 offen offset:0 sc1
    v_exp_f32 v143, v143
    v_mul_f32 v19, v19, v27
    v_mfma_f32_32x32x16_bf16 v[64:79], v[92:95], v[204:207], v[64:79]
    ds_read_b128 v[84:87], v250 offset:1024
    v_fma_f32 v140, v140, v128, v128
    v_fma_f32 v141, v141, v128, v128
    v_fma_f32 v142, v142, v128, v128
    v_fma_f32 v143, v143, v128, v128
    s_waitcnt vmcnt(11) lgkmcnt(4)
    v_mfma_f32_32x32x16_bf16 v[48:63], v[96:99], v[208:211], v[48:63]
    ds_read_b128 v[88:91], v250 offset:3072
    buffer_load_dwordx4 a[228:231], v255, s[24:27], s61 offen offset:1024 sc1
    v_rcp_f32 v140, v140
    v_rcp_f32 v141, v141
    v_mfma_f32_32x32x16_bf16 v[64:79], v[100:103], v[208:211], v[64:79]
    ds_read_b128 v[92:95], v250 offset:4096
    v_rcp_f32 v142, v142
    v_rcp_f32 v143, v143
    s_waitcnt vmcnt(11) lgkmcnt(4)
    v_mfma_f32_32x32x16_bf16 v[48:63], v[104:107], v[212:215], v[48:63]
    ds_read_b128 v[96:99], v250 offset:6144
    v_mul_f32 v16, v16, v140
    v_mul_f32 v17, v17, v141
    v_mul_f32 v18, v18, v142
    v_mul_f32 v19, v19, v143
    v_cvt_pk_bf16_f32 v144, v16, v17
    v_mfma_f32_32x32x16_bf16 v[64:79], v[108:111], v[212:215], v[64:79]
    ds_read_b128 v[100:103], v250 offset:7168
    buffer_load_dwordx4 a[232:235], v255, s[24:27], s61 offen offset:2048 sc1
    v_cvt_pk_bf16_f32 v145, v18, v19
    v_mul_f32 v140, v20, v129
    v_mul_f32 v141, v21, v129
    s_waitcnt vmcnt(11) lgkmcnt(4)
    v_mfma_f32_32x32x16_bf16 v[48:63], v[80:83], v[216:219], v[48:63]
    ds_read_b128 v[104:107], v250 offset:9216
    v_mul_f32 v142, v22, v129
    v_mul_f32 v143, v23, v129
    v_exp_f32 v140, v140
    v_mul_f32 v20, v20, v28
    v_mfma_f32_32x32x16_bf16 v[64:79], v[84:87], v[216:219], v[64:79]
    ds_read_b128 v[108:111], v250 offset:10240
    buffer_load_dwordx4 a[236:239], v255, s[24:27], s61 offen offset:3072 sc1
    v_exp_f32 v141, v141
    v_mul_f32 v21, v21, v29
    s_waitcnt vmcnt(11) lgkmcnt(4)
    v_mfma_f32_32x32x16_bf16 v[48:63], v[88:91], v[220:223], v[48:63]
    ds_read_b128 v[80:83], v250 offset:12288
    v_exp_f32 v142, v142
    v_mul_f32 v22, v22, v30
    v_exp_f32 v143, v143
    v_mfma_f32_32x32x16_bf16 v[64:79], v[92:95], v[220:223], v[64:79]
    ds_read_b128 v[84:87], v250 offset:13312
    v_mul_f32 v23, v23, v31
    v_fma_f32 v140, v140, v128, v128
    v_fma_f32 v141, v141, v128, v128
    v_fma_f32 v142, v142, v128, v128
    s_waitcnt vmcnt(10) lgkmcnt(4)
    v_mfma_f32_32x32x16_bf16 v[48:63], v[96:99], v[224:227], v[48:63]
    ds_read_b128 v[88:91], v250 offset:15360
    s_add_u32 s61, s60, 1077248
    buffer_load_dwordx4 a[240:243], v255, s[24:27], s61 offen offset:0 sc1
    v_fma_f32 v143, v143, v128, v128
    v_rcp_f32 v140, v140
    v_mfma_f32_32x32x16_bf16 v[64:79], v[100:103], v[224:227], v[64:79]
    ds_read_b128 v[92:95], v250 offset:16384
    v_rcp_f32 v141, v141
    v_rcp_f32 v142, v142
    s_waitcnt vmcnt(10) lgkmcnt(4)
    v_mfma_f32_32x32x16_bf16 v[48:63], v[104:107], v[228:231], v[48:63]
    ds_read_b128 v[96:99], v250 offset:18432
    buffer_load_dwordx4 a[244:247], v255, s[24:27], s61 offen offset:1024 sc1
    v_rcp_f32 v143, v143
    v_mul_f32 v20, v20, v140
    v_mul_f32 v21, v21, v141
    v_mfma_f32_32x32x16_bf16 v[64:79], v[108:111], v[228:231], v[64:79]
    ds_read_b128 v[100:103], v250 offset:19456
    v_mul_f32 v22, v22, v142
    v_mul_f32 v23, v23, v143
    v_cvt_pk_bf16_f32 v146, v20, v21
    v_cvt_pk_bf16_f32 v147, v22, v23
    s_waitcnt vmcnt(10) lgkmcnt(4)
    v_mfma_f32_32x32x16_bf16 v[48:63], v[80:83], v[232:235], v[48:63]
    ds_read_b128 v[104:107], v250 offset:21504
    buffer_load_dwordx4 a[248:251], v255, s[24:27], s61 offen offset:2048 sc1
    buffer_store_dwordx4 v[144:147], v255, s[24:27], s58 offen offset:1024 sc1
    v_mul_f32 v140, v32, v129
    v_mul_f32 v141, v33, v129
    v_mul_f32 v142, v34, v129
    v_mfma_f32_32x32x16_bf16 v[64:79], v[84:87], v[232:235], v[64:79]
    ds_read_b128 v[108:111], v250 offset:22528
    v_mul_f32 v143, v35, v129
    v_exp_f32 v140, v140
    v_mul_f32 v32, v32, v40
    s_waitcnt vmcnt(11) lgkmcnt(4)
    v_mfma_f32_32x32x16_bf16 v[48:63], v[88:91], v[236:239], v[48:63]
    ds_read_b128 v[80:83], v250 offset:24576
    v_exp_f32 v141, v141
    v_mul_f32 v33, v33, v41
    v_exp_f32 v142, v142
    v_mfma_f32_32x32x16_bf16 v[64:79], v[92:95], v[236:239], v[64:79]
    ds_read_b128 v[84:87], v250 offset:25600
    buffer_load_dwordx4 a[252:255], v255, s[24:27], s61 offen offset:3072 sc1
    v_mul_f32 v34, v34, v42
    v_exp_f32 v143, v143
    s_waitcnt vmcnt(11) lgkmcnt(4)
    v_mfma_f32_32x32x16_bf16 v[48:63], v[96:99], v[240:243], v[48:63]
    ds_read_b128 v[88:91], v250 offset:27648
    v_mul_f32 v35, v35, v43
    v_fma_f32 v140, v140, v128, v128
    v_fma_f32 v141, v141, v128, v128
    v_fma_f32 v142, v142, v128, v128
    v_fma_f32 v143, v143, v128, v128
    v_mfma_f32_32x32x16_bf16 v[64:79], v[100:103], v[240:243], v[64:79]
    ds_read_b128 v[92:95], v250 offset:28672
    v_rcp_f32 v140, v140
    v_rcp_f32 v141, v141
    s_waitcnt vmcnt(9) lgkmcnt(4)
    v_mfma_f32_32x32x16_bf16 v[48:63], v[104:107], v[244:247], v[48:63]
    ds_read_b128 v[96:99], v250 offset:30720
    v_rcp_f32 v142, v142
    v_rcp_f32 v143, v143
    v_mul_f32 v32, v32, v140
    v_mfma_f32_32x32x16_bf16 v[64:79], v[108:111], v[244:247], v[64:79]
    ds_read_b128 v[100:103], v250 offset:31744
    v_mul_f32 v33, v33, v141
    v_mul_f32 v34, v34, v142
    v_mul_f32 v35, v35, v143
    v_cvt_pk_bf16_f32 v144, v32, v33
    s_waitcnt vmcnt(8) lgkmcnt(4)
    v_mfma_f32_32x32x16_bf16 v[48:63], v[80:83], a[224:227], v[48:63]
    ds_read_b128 v[104:107], v250 offset:33792
    v_cvt_pk_bf16_f32 v145, v34, v35
    v_mul_f32 v140, v36, v129
    v_mul_f32 v141, v37, v129
    v_mul_f32 v142, v38, v129
    v_mul_f32 v143, v39, v129
    v_mfma_f32_32x32x16_bf16 v[64:79], v[84:87], a[224:227], v[64:79]
    ds_read_b128 v[108:111], v250 offset:34816
    v_exp_f32 v140, v140
    v_mul_f32 v36, v36, v44
    s_waitcnt vmcnt(7) lgkmcnt(4)
    v_mfma_f32_32x32x16_bf16 v[48:63], v[88:91], a[228:231], v[48:63]
    ds_read_b128 v[80:83], v250 offset:36864
    v_exp_f32 v141, v141
    v_mul_f32 v37, v37, v45
    v_exp_f32 v142, v142
    v_mfma_f32_32x32x16_bf16 v[64:79], v[92:95], a[228:231], v[64:79]
    ds_read_b128 v[84:87], v250 offset:37888
    v_mul_f32 v38, v38, v46
    v_exp_f32 v143, v143
    v_mul_f32 v39, v39, v47
    s_waitcnt vmcnt(6) lgkmcnt(4)
    v_mfma_f32_32x32x16_bf16 v[48:63], v[96:99], a[232:235], v[48:63]
    ds_read_b128 v[88:91], v250 offset:39936
    v_fma_f32 v140, v140, v128, v128
    v_fma_f32 v141, v141, v128, v128
    v_fma_f32 v142, v142, v128, v128
    v_fma_f32 v143, v143, v128, v128
    v_mfma_f32_32x32x16_bf16 v[64:79], v[100:103], a[232:235], v[64:79]
    ds_read_b128 v[92:95], v250 offset:40960
    v_rcp_f32 v140, v140
    v_rcp_f32 v141, v141
    s_waitcnt vmcnt(5) lgkmcnt(4)
    v_mfma_f32_32x32x16_bf16 v[48:63], v[104:107], a[236:239], v[48:63]
    ds_read_b128 v[96:99], v250 offset:43008
    v_rcp_f32 v142, v142
    v_rcp_f32 v143, v143
    v_mul_f32 v36, v36, v140
    v_mfma_f32_32x32x16_bf16 v[64:79], v[108:111], a[236:239], v[64:79]
    ds_read_b128 v[100:103], v250 offset:44032
    v_mul_f32 v37, v37, v141
    v_mul_f32 v38, v38, v142
    v_mul_f32 v39, v39, v143
    v_cvt_pk_bf16_f32 v146, v36, v37
    s_waitcnt vmcnt(4) lgkmcnt(4)
    v_mfma_f32_32x32x16_bf16 v[48:63], v[80:83], a[240:243], v[48:63]
    ds_read_b128 v[104:107], v250 offset:46080
    v_cvt_pk_bf16_f32 v147, v38, v39
    buffer_store_dwordx4 v[144:147], v255, s[24:27], s58 offen offset:2048 sc1
    v_mfma_f32_32x32x16_bf16 v[64:79], v[84:87], a[240:243], v[64:79]
    ds_read_b128 v[108:111], v250 offset:47104
    s_waitcnt vmcnt(4) lgkmcnt(4)
    v_mfma_f32_32x32x16_bf16 v[48:63], v[88:91], a[244:247], v[48:63]
    ds_read_b128 v[80:83], v255 offset:2048
    v_mfma_f32_32x32x16_bf16 v[64:79], v[92:95], a[244:247], v[64:79]
    ds_read_b128 v[84:87], v255 offset:5120
    s_waitcnt vmcnt(3) lgkmcnt(4)
    v_mfma_f32_32x32x16_bf16 v[48:63], v[96:99], a[248:251], v[48:63]
    ds_read_b128 v[88:91], v255 offset:8192
    v_mfma_f32_32x32x16_bf16 v[64:79], v[100:103], a[248:251], v[64:79]
    ds_read_b128 v[92:95], v255 offset:11264
    s_waitcnt vmcnt(1) lgkmcnt(4)
    v_mfma_f32_32x32x16_bf16 v[48:63], v[104:107], a[252:255], v[48:63]
    ds_read_b128 v[96:99], v255 offset:14336
    v_mfma_f32_32x32x16_bf16 v[48:63], a[208:211], v[136:139], v[48:63]
    v_mfma_f32_32x32x16_bf16 v[64:79], v[108:111], a[252:255], v[64:79]
    ds_read_b128 v[100:103], v255 offset:17408
    v_mfma_f32_32x32x16_bf16 v[64:79], a[212:215], v[136:139], v[64:79]
    s_waitcnt lgkmcnt(4)
    v_mfma_f32_32x32x16_bf16 v[0:15], v[80:83], v[152:155], 0
    ds_read_b128 v[104:107], v255 offset:20480
    v_mfma_f32_32x32x16_bf16 v[0:15], v[84:87], v[156:159], v[0:15]
    ds_read_b128 v[108:111], v255 offset:23552
    s_waitcnt lgkmcnt(4)
    v_mfma_f32_32x32x16_bf16 v[0:15], v[88:91], v[160:163], v[0:15]
    ds_read_b128 v[80:83], v255 offset:26624
    s_nop 0
    v_mul_f32 v140, v48, v131
    v_mul_f32 v141, v49, v131
    v_mul_f32 v142, v50, v131
    v_mul_f32 v143, v51, v131
    v_mfma_f32_32x32x16_bf16 v[0:15], v[92:95], v[164:167], v[0:15]
    ds_read_b128 v[84:87], v255 offset:29696
    v_exp_f32 v140, v140
    v_mul_f32 v48, v48, v56
    s_waitcnt lgkmcnt(4)
    v_mfma_f32_32x32x16_bf16 v[0:15], v[96:99], v[168:171], v[0:15]
    ds_read_b128 v[88:91], v255 offset:32768
    v_exp_f32 v141, v141
    v_mul_f32 v49, v49, v57
    v_exp_f32 v142, v142
    v_mfma_f32_32x32x16_bf16 v[0:15], v[100:103], v[172:175], v[0:15]
    ds_read_b128 v[92:95], v255 offset:35840
    v_mul_f32 v50, v50, v58
    v_exp_f32 v143, v143
    v_mul_f32 v51, v51, v59
    s_waitcnt lgkmcnt(4)
    v_mfma_f32_32x32x16_bf16 v[0:15], v[104:107], v[176:179], v[0:15]
    ds_read_b128 v[96:99], v255 offset:38912
    s_add_u32 s56, s32, 8
    v_mov_b32 v112, s56
    v_mov_b32 v113, s33
    s_cmp_lg_u32 s40, 0
    s_waitcnt vmcnt(0)
    s_barrier
    s_cbranch_scc1 L_interleave_layers__spectral_fnet__swiglu_ffn__prompt_pb_15_slow
    buffer_store_dwordx2 v[112:113], v249, s[24:27], 0 offen
L_interleave_layers__spectral_fnet__swiglu_ffn__prompt_pb_15_back:
    v_mfma_f32_32x32x16_bf16 v[0:15], v[108:111], v[180:183], v[0:15]
    ds_read_b128 v[100:103], v255 offset:41984
    v_fma_f32 v140, v140, v130, v130
    v_fma_f32 v141, v141, v130, v130
    v_fma_f32 v142, v142, v130, v130
    v_fma_f32 v143, v143, v130, v130
    s_waitcnt lgkmcnt(4)
    v_mfma_f32_32x32x16_bf16 v[0:15], v[80:83], v[184:187], v[0:15]
    ds_read_b128 v[104:107], v255 offset:45056
    v_rcp_f32 v140, v140
    v_rcp_f32 v141, v141
    v_mfma_f32_32x32x16_bf16 v[0:15], v[84:87], v[188:191], v[0:15]
    ds_read_b128 v[108:111], v255 offset:48128
    v_rcp_f32 v142, v142
    v_rcp_f32 v143, v143
    s_waitcnt lgkmcnt(4)
    v_mfma_f32_32x32x16_bf16 v[0:15], v[88:91], v[192:195], v[0:15]
    ds_read_b128 v[80:83], v250 offset:2048
    v_mul_f32 v48, v48, v140
    v_mul_f32 v49, v49, v141
    v_mul_f32 v50, v50, v142
    v_mul_f32 v51, v51, v143
    v_cvt_pk_bf16_f32 v120, v48, v49
    v_mfma_f32_32x32x16_bf16 v[0:15], v[92:95], v[196:199], v[0:15]
    ds_read_b128 v[84:87], v250 offset:5120
    v_cvt_pk_bf16_f32 v121, v50, v51
    v_mul_f32 v140, v52, v131
    v_mul_f32 v141, v53, v131
    v_mul_f32 v142, v54, v131
    s_waitcnt lgkmcnt(4)
    v_mfma_f32_32x32x16_bf16 v[0:15], v[96:99], v[200:203], v[0:15]
    ds_read_b128 v[88:91], v250 offset:8192
    v_mul_f32 v143, v55, v131
    v_exp_f32 v140, v140
    v_mul_f32 v52, v52, v60
    v_mfma_f32_32x32x16_bf16 v[0:15], v[100:103], v[204:207], v[0:15]
    ds_read_b128 v[92:95], v250 offset:11264
    v_exp_f32 v141, v141
    v_mul_f32 v53, v53, v61
    s_waitcnt lgkmcnt(4)
    v_mfma_f32_32x32x16_bf16 v[0:15], v[104:107], v[208:211], v[0:15]
    ds_read_b128 v[96:99], v250 offset:14336
    v_exp_f32 v142, v142
    v_mul_f32 v54, v54, v62
    v_exp_f32 v143, v143
    v_mfma_f32_32x32x16_bf16 v[0:15], v[108:111], v[212:215], v[0:15]
    ds_read_b128 v[100:103], v250 offset:17408
    v_mul_f32 v55, v55, v63
    v_fma_f32 v140, v140, v130, v130
    v_fma_f32 v141, v141, v130, v130
    v_fma_f32 v142, v142, v130, v130
    s_waitcnt lgkmcnt(4)
    v_mfma_f32_32x32x16_bf16 v[0:15], v[80:83], v[216:219], v[0:15]
    ds_read_b128 v[104:107], v250 offset:20480
    v_fma_f32 v143, v143, v130, v130
    v_rcp_f32 v140, v140
    v_rcp_f32 v141, v141
    v_mfma_f32_32x32x16_bf16 v[0:15], v[84:87], v[220:223], v[0:15]
    ds_read_b128 v[108:111], v250 offset:23552
    v_rcp_f32 v142, v142
    v_rcp_f32 v143, v143
    s_waitcnt lgkmcnt(4)
    v_mfma_f32_32x32x16_bf16 v[0:15], v[88:91], v[224:227], v[0:15]
    ds_read_b128 v[80:83], v250 offset:26624
    v_mul_f32 v52, v52, v140
    v_mul_f32 v53, v53, v141
    v_mul_f32 v54, v54, v142
    v_mul_f32 v55, v55, v143
    v_cvt_pk_bf16_f32 v122, v52, v53
    v_mfma_f32_32x32x16_bf16 v[0:15], v[92:95], v[228:231], v[0:15]
    ds_read_b128 v[84:87], v250 offset:29696
    v_cvt_pk_bf16_f32 v123, v54, v55
    buffer_store_dwordx4 v[120:123], v255, s[24:27], s59 offen offset:0 sc1
    v_mul_f32 v140, v64, v131
    v_mul_f32 v141, v65, v131
    s_waitcnt lgkmcnt(4)
    v_mfma_f32_32x32x16_bf16 v[0:15], v[96:99], v[232:235], v[0:15]
    ds_read_b128 v[88:91], v250 offset:32768
    v_mul_f32 v142, v66, v131
    v_mul_f32 v143, v67, v131
    v_exp_f32 v140, v140
    v_mul_f32 v64, v64, v72
    v_mfma_f32_32x32x16_bf16 v[0:15], v[100:103], v[236:239], v[0:15]
    ds_read_b128 v[92:95], v250 offset:35840
    v_exp_f32 v141, v141
    v_mul_f32 v65, v65, v73
    s_waitcnt lgkmcnt(4)
    v_mfma_f32_32x32x16_bf16 v[0:15], v[104:107], v[240:243], v[0:15]
    ds_read_b128 v[96:99], v250 offset:38912
    v_exp_f32 v142, v142
    v_mul_f32 v66, v66, v74
    v_exp_f32 v143, v143
    v_mfma_f32_32x32x16_bf16 v[0:15], v[108:111], v[244:247], v[0:15]
    ds_read_b128 v[100:103], v250 offset:41984
    v_mul_f32 v67, v67, v75
    v_fma_f32 v140, v140, v130, v130
    v_fma_f32 v141, v141, v130, v130
    v_fma_f32 v142, v142, v130, v130
    s_waitcnt lgkmcnt(4)
    v_mfma_f32_32x32x16_bf16 v[0:15], v[80:83], a[224:227], v[0:15]
    ds_read_b128 v[104:107], v250 offset:45056
    v_fma_f32 v143, v143, v130, v130
    v_rcp_f32 v140, v140
    v_rcp_f32 v141, v141
    v_mfma_f32_32x32x16_bf16 v[0:15], v[84:87], a[228:231], v[0:15]
    ds_read_b128 v[108:111], v250 offset:48128
    v_rcp_f32 v142, v142
    v_rcp_f32 v143, v143
    s_waitcnt lgkmcnt(4)
    v_mfma_f32_32x32x16_bf16 v[0:15], v[88:91], a[232:235], v[0:15]
    v_lshl_add_u32 v114, v254, 3, s46
    s_andn2_b32 s71, 1073741824, s72
    buffer_load_dwordx2 v[116:117], v114, s[24:27], s71 offen sc1
    v_mul_f32 v64, v64, v140
    v_mul_f32 v65, v65, v141
    v_mul_f32 v66, v66, v142
    v_mfma_f32_32x32x16_bf16 v[0:15], v[92:95], a[236:239], v[0:15]
    v_mul_f32 v67, v67, v143
    v_cvt_pk_bf16_f32 v124, v64, v65
    v_cvt_pk_bf16_f32 v125, v66, v67
    v_mul_f32 v140, v68, v131
    v_mul_f32 v141, v69, v131
    s_waitcnt lgkmcnt(2)
    v_mfma_f32_32x32x16_bf16 v[0:15], v[96:99], a[240:243], v[0:15]
    v_mul_f32 v142, v70, v131
    v_mul_f32 v143, v71, v131
    v_exp_f32 v140, v140
    v_mul_f32 v68, v68, v76
    v_mfma_f32_32x32x16_bf16 v[0:15], v[100:103], a[244:247], v[0:15]
    v_exp_f32 v141, v141
    v_mul_f32 v69, v69, v77
    v_exp_f32 v142, v142
    s_waitcnt lgkmcnt(0)
    v_mfma_f32_32x32x16_bf16 v[0:15], v[104:107], a[248:251], v[0:15]
    v_mul_f32 v70, v70, v78
    v_exp_f32 v143, v143
    v_mul_f32 v71, v71, v79
    v_fma_f32 v140, v140, v130, v130
    v_fma_f32 v141, v141, v130, v130
    v_mfma_f32_32x32x16_bf16 v[0:15], v[108:111], a[252:255], v[0:15]
    v_mfma_f32_32x32x16_bf16 v[0:15], a[216:219], v[136:139], v[0:15]
    v_fma_f32 v142, v142, v130, v130
    v_fma_f32 v143, v143, v130, v130
    v_rcp_f32 v140, v140
L_idle1_back:
    s_add_u32 s70, s32, 8
    s_waitcnt vmcnt(0)
    v_subrev_u32 v116, s70, v116
    v_xor_b32 v117, s33, v117
    v_lshrrev_b32 v116, 3, v116
    v_or_b32 v116, v116, v117
    v_cmp_ne_u32 vcc, 0, v116
    s_nop 0
    s_or_b32 vcc_lo, vcc_lo, s40
    s_and_b64 vcc, vcc, s[72:73]
    s_cbranch_vccnz L_interleave_layers__spectral_fnet__swiglu_ffn__prompt_cf_16_retry
L_interleave_layers__spectral_fnet__swiglu_ffn__prompt_cf_16_ok:
    s_barrier
    s_add_u32 s53, s48, 0
    buffer_load_dwordx4 v[80:83], v255, s[24:27], s53 offen offset:0 sc1
    v_rcp_f32 v141, v141
    v_rcp_f32 v142, v142
    v_rcp_f32 v143, v143
    v_mul_f32 v68, v68, v140
    v_mul_f32 v69, v69, v141
    v_mul_f32 v70, v70, v142
    v_mul_f32 v71, v71, v143
    v_cvt_pk_bf16_f32 v126, v68, v69
    v_cvt_pk_bf16_f32 v127, v70, v71
    buffer_load_dwordx4 v[84:87], v255, s[24:27], s53 offen offset:1024 sc1
    buffer_store_dwordx4 v[124:127], v255, s[24:27], s59 offen offset:1024 sc1
    v_pk_mul_f32 v[140:141], v[0:1], v[130:131] op_sel:[0,1] op_sel_hi:[1,1]
    v_pk_mul_f32 v[142:143], v[2:3], v[130:131] op_sel:[0,1] op_sel_hi:[1,1]
    v_exp_f32 v140, v140
    v_exp_f32 v141, v141
    v_exp_f32 v142, v142
    v_exp_f32 v143, v143
    v_pk_mul_f32 v[0:1], v[0:1], v[8:9]
    buffer_load_dwordx4 v[88:91], v255, s[24:27], s53 offen offset:2048 sc1
    v_pk_mul_f32 v[2:3], v[2:3], v[10:11]
    v_pk_fma_f32 v[140:141], v[140:141], v[130:131], v[130:131] op_sel:[0,0,0] op_sel_hi:[1,0,0]
    v_pk_fma_f32 v[142:143], v[142:143], v[130:131], v[130:131] op_sel:[0,0,0] op_sel_hi:[1,0,0]
    v_rcp_f32 v140, v140
    v_rcp_f32 v141, v141
    v_rcp_f32 v142, v142
    v_rcp_f32 v143, v143
    v_pk_mul_f32 v[0:1], v[0:1], v[140:141]
    buffer_load_dwordx4 v[92:95], v255, s[24:27], s53 offen offset:3072 sc1
    v_pk_mul_f32 v[2:3], v[2:3], v[142:143]
L_pad5:
    s_cbranch_execz L_chain_ret
    v_cvt_pk_bf16_f32 v144, v0, v1
    v_cvt_pk_bf16_f32 v145, v2, v3
    v_pk_mul_f32 v[140:141], v[4:5], v[130:131] op_sel:[0,1] op_sel_hi:[1,1]
    v_pk_mul_f32 v[142:143], v[6:7], v[130:131] op_sel:[0,1] op_sel_hi:[1,1]
    v_exp_f32 v140, v140
    v_exp_f32 v141, v141
    v_exp_f32 v142, v142
    v_exp_f32 v143, v143
    v_pk_mul_f32 v[4:5], v[4:5], v[12:13]
    v_pk_mul_f32 v[6:7], v[6:7], v[14:15]
    v_pk_fma_f32 v[140:141], v[140:141], v[130:131], v[130:131] op_sel:[0,0,0] op_sel_hi:[1,0,0]
    v_pk_fma_f32 v[142:143], v[142:143], v[130:131], v[130:131] op_sel:[0,0,0] op_sel_hi:[1,0,0]
    v_rcp_f32 v140, v140
    v_rcp_f32 v141, v141
    v_rcp_f32 v142, v142
    v_rcp_f32 v143, v143
    v_pk_mul_f32 v[4:5], v[4:5], v[140:141]
    v_pk_mul_f32 v[6:7], v[6:7], v[142:143]
    v_cvt_pk_bf16_f32 v146, v4, v5
    v_cvt_pk_bf16_f32 v147, v6, v7
    buffer_store_dwordx4 v[144:147], v255, s[24:27], s59 offen offset:2048 sc1
    s_add_u32 s53, s48, 4096
    buffer_load_dwordx4 v[96:99], v255, s[24:27], s53 offen offset:0 sc1
    buffer_load_dwordx4 v[100:103], v255, s[24:27], s53 offen offset:1024 sc1
    buffer_load_dwordx4 v[104:107], v255, s[24:27], s53 offen offset:2048 sc1
    buffer_load_dwordx4 v[108:111], v255, s[24:27], s53 offen offset:3072 sc1
    s_add_u32 s56, s32, 9
    v_mov_b32 v136, s56
    v_mov_b32 v137, s33
    s_cmp_lg_u32 s40, 0
    s_waitcnt vmcnt(4)
    s_barrier
    s_cbranch_scc1 L_interleave_layers__spectral_fnet__swiglu_ffn__prompt_pb_17_slow
    buffer_store_dwordx2 v[136:137], v249, s[24:27], 0 offen
L_interleave_layers__spectral_fnet__swiglu_ffn__prompt_pb_17_back:
    s_add_u32 s54, s51, 1048576
    buffer_load_dwordx4 v[0:3], v255, s[24:27], s51 offen sc1
    buffer_load_dwordx4 v[4:7], v255, s[24:27], s54 offen sc1
    v_mfma_f32_32x32x16_bf16 v[16:31], a[0:3], v[80:83], 0
    s_add_u32 s53, s48, 8192
    buffer_load_dwordx4 v[152:155], v255, s[24:27], s53 offen offset:0 sc1
    v_lshlrev_b32 v128, 16, v254
    v_lshl_add_u32 v128, v253, 4, v128
    s_lshl_b32 s57, s39, 10
    s_lshl_b32 s58, s52, 5
    v_mfma_f32_32x32x16_bf16 v[32:47], a[4:7], v[80:83], 0
    s_add_u32 s57, s57, s58
    s_add_u32 s58, s57, 32768
    s_xor_b32 s69, s34, 0
    s_mul_i32 s69, s69, 6144
    s_add_u32 s69, s69, 98304
    v_add_u32 v144, s69, v255
    v_mfma_f32_32x32x16_bf16 v[16:31], a[8:11], v[84:87], v[16:31]
    buffer_load_dwordx4 v[156:159], v255, s[24:27], s53 offen offset:1024 sc1
    s_xor_b32 s69, s34, 1
    s_mul_i32 s69, s69, 6144
    s_add_u32 s69, s69, 98304
    v_add_u32 v145, s69, v255
    s_xor_b32 s69, s34, 2
    v_mfma_f32_32x32x16_bf16 v[32:47], a[12:15], v[84:87], v[32:47]
    s_mul_i32 s69, s69, 6144
    s_add_u32 s69, s69, 100352
    v_add_u32 v146, s69, v255
    s_xor_b32 s69, s34, 3
    s_mul_i32 s69, s69, 6144
    s_add_u32 s69, s69, 102400
    v_mfma_f32_32x32x16_bf16 v[16:31], a[16:19], v[88:91], v[16:31]
    buffer_load_dwordx4 v[160:163], v255, s[24:27], s53 offen offset:2048 sc1
    v_add_u32 v147, s69, v255
    v_mfma_f32_32x32x16_bf16 v[32:47], a[20:23], v[88:91], v[32:47]
    v_mfma_f32_32x32x16_bf16 v[16:31], a[24:27], v[92:95], v[16:31]
    buffer_load_dwordx4 v[164:167], v255, s[24:27], s53 offen offset:3072 sc1
    v_mfma_f32_32x32x16_bf16 v[32:47], a[28:31], v[92:95], v[32:47]
    s_waitcnt vmcnt(10)
    v_mfma_f32_32x32x16_bf16 v[16:31], a[32:35], v[96:99], v[16:31]
    s_add_u32 s53, s48, 12288
    buffer_load_dwordx4 v[168:171], v255, s[24:27], s53 offen offset:0 sc1
    v_mfma_f32_32x32x16_bf16 v[32:47], a[36:39], v[96:99], v[32:47]
    s_waitcnt vmcnt(10)
    v_mfma_f32_32x32x16_bf16 v[16:31], a[40:43], v[100:103], v[16:31]
    buffer_load_dwordx4 v[172:175], v255, s[24:27], s53 offen offset:1024 sc1
    v_mfma_f32_32x32x16_bf16 v[32:47], a[44:47], v[100:103], v[32:47]
    s_waitcnt vmcnt(10)
    v_mfma_f32_32x32x16_bf16 v[16:31], a[48:51], v[104:107], v[16:31]
    buffer_load_dwordx4 v[176:179], v255, s[24:27], s53 offen offset:2048 sc1
    v_mfma_f32_32x32x16_bf16 v[32:47], a[52:55], v[104:107], v[32:47]
    s_waitcnt vmcnt(10)
    v_mfma_f32_32x32x16_bf16 v[16:31], a[56:59], v[108:111], v[16:31]
    v_lshl_add_u32 v132, v254, 3, s46
    s_andn2_b32 s71, 1073741824, s72
    buffer_load_dwordx2 v[134:135], v132, s[24:27], s71 offen sc1
    buffer_load_dwordx4 v[180:183], v255, s[24:27], s53 offen offset:3072 sc1
    v_mfma_f32_32x32x16_bf16 v[32:47], a[60:63], v[108:111], v[32:47]
    s_waitcnt vmcnt(8)
    v_mfma_f32_32x32x16_bf16 v[16:31], a[64:67], v[152:155], v[16:31]
    s_add_u32 s53, s48, 16384
    buffer_load_dwordx4 v[112:115], v255, s[24:27], s53 offen offset:0 sc1
    v_mfma_f32_32x32x16_bf16 v[32:47], a[68:71], v[152:155], v[32:47]
    s_waitcnt vmcnt(8)
    v_mfma_f32_32x32x16_bf16 v[16:31], a[72:75], v[156:159], v[16:31]
    buffer_load_dwordx4 v[116:119], v255, s[24:27], s53 offen offset:1024 sc1
    v_mfma_f32_32x32x16_bf16 v[32:47], a[76:79], v[156:159], v[32:47]
    s_waitcnt vmcnt(8)
    v_mfma_f32_32x32x16_bf16 v[16:31], a[80:83], v[160:163], v[16:31]
    buffer_load_dwordx4 v[120:123], v255, s[24:27], s53 offen offset:2048 sc1
    v_mfma_f32_32x32x16_bf16 v[32:47], a[84:87], v[160:163], v[32:47]
    s_waitcnt vmcnt(8)
    v_mfma_f32_32x32x16_bf16 v[16:31], a[88:91], v[164:167], v[16:31]
    buffer_load_dwordx4 v[124:127], v255, s[24:27], s53 offen offset:3072 sc1
    v_mfma_f32_32x32x16_bf16 v[32:47], a[92:95], v[164:167], v[32:47]
    s_waitcnt vmcnt(8)
    v_mfma_f32_32x32x16_bf16 v[16:31], a[96:99], v[168:171], v[16:31]
    s_add_u32 s53, s48, s50
    buffer_load_dwordx4 v[80:83], v255, s[24:27], s53 offen offset:0 sc1
    v_mfma_f32_32x32x16_bf16 v[32:47], a[100:103], v[168:171], v[32:47]
    s_waitcnt vmcnt(8)
    v_mfma_f32_32x32x16_bf16 v[16:31], a[104:107], v[172:175], v[16:31]
    buffer_load_dwordx4 v[84:87], v255, s[24:27], s53 offen offset:1024 sc1
    v_mfma_f32_32x32x16_bf16 v[32:47], a[108:111], v[172:175], v[32:47]
    s_waitcnt vmcnt(8)
    v_mfma_f32_32x32x16_bf16 v[16:31], a[112:115], v[176:179], v[16:31]
    s_add_u32 s70, s32, 9
    s_waitcnt vmcnt(7)
    v_subrev_u32 v134, s70, v134
    v_xor_b32 v135, s33, v135
    v_lshrrev_b32 v134, 3, v134
    v_or_b32 v134, v134, v135
    v_cmp_ne_u32 vcc, 0, v134
    s_nop 0
    s_or_b32 vcc_lo, vcc_lo, s40
    s_and_b64 vcc, vcc, s[72:73]
    s_cbranch_vccnz L_interleave_layers__spectral_fnet__swiglu_ffn__prompt_cf_18_retry
L_interleave_layers__spectral_fnet__swiglu_ffn__prompt_cf_18_ok:
    s_barrier
    s_add_u32 s53, s49, 0
    buffer_load_dwordx4 v[88:91], v255, s[24:27], s53 offen offset:0 sc1
    v_mfma_f32_32x32x16_bf16 v[32:47], a[116:119], v[176:179], v[32:47]
    s_waitcnt vmcnt(7)
    v_mfma_f32_32x32x16_bf16 v[16:31], a[120:123], v[180:183], v[16:31]
    buffer_load_dwordx4 v[92:95], v255, s[24:27], s53 offen offset:1024 sc1
    v_mfma_f32_32x32x16_bf16 v[32:47], a[124:127], v[180:183], v[32:47]
    s_waitcnt vmcnt(7)
    v_mfma_f32_32x32x16_bf16 v[16:31], a[128:131], v[112:115], v[16:31]
    buffer_load_dwordx4 v[96:99], v255, s[24:27], s53 offen offset:2048 sc1
    v_mfma_f32_32x32x16_bf16 v[32:47], a[132:135], v[112:115], v[32:47]
    s_waitcnt vmcnt(7)
    v_mfma_f32_32x32x16_bf16 v[16:31], a[136:139], v[116:119], v[16:31]
    buffer_load_dwordx4 v[100:103], v255, s[24:27], s53 offen offset:3072 sc1
    v_mfma_f32_32x32x16_bf16 v[32:47], a[140:143], v[116:119], v[32:47]
    s_waitcnt vmcnt(7)
    v_mfma_f32_32x32x16_bf16 v[16:31], a[144:147], v[120:123], v[16:31]
    s_add_u32 s53, s49, 4096
    buffer_load_dwordx4 v[104:107], v255, s[24:27], s53 offen offset:0 sc1
    v_mfma_f32_32x32x16_bf16 v[32:47], a[148:151], v[120:123], v[32:47]
    s_waitcnt vmcnt(7)
    v_mfma_f32_32x32x16_bf16 v[16:31], a[152:155], v[124:127], v[16:31]
    buffer_load_dwordx4 v[108:111], v255, s[24:27], s53 offen offset:1024 sc1
    v_mfma_f32_32x32x16_bf16 v[32:47], a[156:159], v[124:127], v[32:47]
    s_waitcnt vmcnt(7)
    v_mfma_f32_32x32x16_bf16 v[16:31], a[160:163], v[80:83], v[16:31]
    buffer_load_dwordx4 v[152:155], v255, s[24:27], s53 offen offset:2048 sc1
    buffer_load_dwordx4 v[156:159], v255, s[24:27], s53 offen offset:3072 sc1
    v_mfma_f32_32x32x16_bf16 v[32:47], a[164:167], v[80:83], v[32:47]
    s_waitcnt vmcnt(8)
    v_mfma_f32_32x32x16_bf16 v[16:31], a[168:171], v[84:87], v[16:31]
    s_add_u32 s53, s49, 8192
    buffer_load_dwordx4 v[160:163], v255, s[24:27], s53 offen offset:0 sc1
    buffer_load_dwordx4 v[164:167], v255, s[24:27], s53 offen offset:1024 sc1
    v_mfma_f32_32x32x16_bf16 v[32:47], a[172:175], v[84:87], v[32:47]
    s_waitcnt vmcnt(9)
    v_mfma_f32_32x32x16_bf16 v[48:63], a[0:3], v[88:91], 0
    buffer_load_dwordx4 v[168:171], v255, s[24:27], s53 offen offset:2048 sc1
    v_mfma_f32_32x32x16_bf16 v[64:79], a[4:7], v[88:91], 0
    s_waitcnt vmcnt(9)
    v_mfma_f32_32x32x16_bf16 v[48:63], a[8:11], v[92:95], v[48:63]
    buffer_load_dwordx4 v[172:175], v255, s[24:27], s53 offen offset:3072 sc1
    v_mfma_f32_32x32x16_bf16 v[64:79], a[12:15], v[92:95], v[64:79]
    ds_write_b128 v145, v[24:27] offset:0
    s_waitcnt vmcnt(9)
    v_mfma_f32_32x32x16_bf16 v[48:63], a[16:19], v[96:99], v[48:63]
    s_add_u32 s53, s49, 12288
    buffer_load_dwordx4 v[176:179], v255, s[24:27], s53 offen offset:0 sc1
    v_mfma_f32_32x32x16_bf16 v[64:79], a[20:23], v[96:99], v[64:79]
    ds_write_b128 v145, v[28:31] offset:1024
    s_waitcnt vmcnt(9)
    v_mfma_f32_32x32x16_bf16 v[48:63], a[24:27], v[100:103], v[48:63]
    buffer_load_dwordx4 v[180:183], v255, s[24:27], s53 offen offset:1024 sc1
    v_mfma_f32_32x32x16_bf16 v[64:79], a[28:31], v[100:103], v[64:79]
    ds_write_b128 v146, v[32:35] offset:0
    s_waitcnt vmcnt(9)
    v_mfma_f32_32x32x16_bf16 v[48:63], a[32:35], v[104:107], v[48:63]
    buffer_load_dwordx4 v[112:115], v255, s[24:27], s53 offen offset:2048 sc1
    v_mfma_f32_32x32x16_bf16 v[64:79], a[36:39], v[104:107], v[64:79]
    ds_write_b128 v146, v[36:39] offset:1024
    s_waitcnt vmcnt(9)
    v_mfma_f32_32x32x16_bf16 v[48:63], a[40:43], v[108:111], v[48:63]
    buffer_load_dwordx4 v[116:119], v255, s[24:27], s53 offen offset:3072 sc1
    v_mfma_f32_32x32x16_bf16 v[64:79], a[44:47], v[108:111], v[64:79]
    ds_write_b128 v147, v[40:43] offset:0
    s_waitcnt vmcnt(9)
    v_mfma_f32_32x32x16_bf16 v[48:63], a[48:51], v[152:155], v[48:63]
    s_add_u32 s53, s49, 16384
    buffer_load_dwordx4 v[120:123], v255, s[24:27], s53 offen offset:0 sc1
    v_mfma_f32_32x32x16_bf16 v[64:79], a[52:55], v[152:155], v[64:79]
    ds_write_b128 v147, v[44:47] offset:1024
    s_waitcnt vmcnt(9)
    v_mfma_f32_32x32x16_bf16 v[48:63], a[56:59], v[156:159], v[48:63]
    buffer_load_dwordx4 v[124:127], v255, s[24:27], s53 offen offset:1024 sc1
    v_mfma_f32_32x32x16_bf16 v[64:79], a[60:63], v[156:159], v[64:79]
    s_waitcnt vmcnt(9)
    v_mfma_f32_32x32x16_bf16 v[48:63], a[64:67], v[160:163], v[48:63]
    buffer_load_dwordx4 v[80:83], v255, s[24:27], s53 offen offset:2048 sc1
    s_waitcnt lgkmcnt(0)
    s_barrier
    ds_read_b128 v[32:35], v144 offset:2048
    ds_read_b128 v[36:39], v144 offset:3072
    v_mfma_f32_32x32x16_bf16 v[64:79], a[68:71], v[160:163], v[64:79]
    ds_read_b128 v[40:43], v144 offset:4096
    ds_read_b128 v[44:47], v144 offset:5120
    ds_read_b128 v[24:27], v144 offset:0
    ds_read_b128 v[28:31], v144 offset:1024
    v_lshlrev_b32 v12, 16, v0
    v_and_b32 v13, 0xffff0000, v0
    s_waitcnt vmcnt(9)
    v_mfma_f32_32x32x16_bf16 v[48:63], a[72:75], v[164:167], v[48:63]
    buffer_load_dwordx4 v[84:87], v255, s[24:27], s53 offen offset:3072 sc1
    v_add_f32 v16, v16, v12
    v_add_f32 v17, v17, v13
    v_lshlrev_b32 v12, 16, v1
    v_and_b32 v13, 0xffff0000, v1
    v_mfma_f32_32x32x16_bf16 v[64:79], a[76:79], v[164:167], v[64:79]
    v_add_f32 v18, v18, v12
    v_add_f32 v19, v19, v13
    v_lshlrev_b32 v12, 16, v2
    v_and_b32 v13, 0xffff0000, v2
    v_add_f32 v20, v20, v12
    v_add_f32 v21, v21, v13
    s_waitcnt vmcnt(9)
    v_mfma_f32_32x32x16_bf16 v[48:63], a[80:83], v[168:171], v[48:63]
    s_add_u32 s53, s49, s50
    buffer_load_dwordx4 v[88:91], v255, s[24:27], s53 offen offset:0 sc1
    v_lshlrev_b32 v12, 16, v3
    v_and_b32 v13, 0xffff0000, v3
    v_add_f32 v22, v22, v12
    v_mfma_f32_32x32x16_bf16 v[64:79], a[84:87], v[168:171], v[64:79]
    v_add_f32 v23, v23, v13
    s_waitcnt lgkmcnt(1)
    v_add_f32 v16, v16, v24
    v_add_f32 v17, v17, v25
    v_add_f32 v18, v18, v26
    v_add_f32 v19, v19, v27
    s_waitcnt lgkmcnt(0)
    v_add_f32 v20, v20, v28
    s_waitcnt vmcnt(9)
    v_mfma_f32_32x32x16_bf16 v[48:63], a[88:91], v[172:175], v[48:63]
    buffer_load_dwordx4 v[92:95], v255, s[24:27], s53 offen offset:1024 sc1
    v_add_f32 v21, v21, v29
    v_add_f32 v22, v22, v30
    v_add_f32 v23, v23, v31
    v_add_f32 v16, v16, v32
    v_mfma_f32_32x32x16_bf16 v[64:79], a[92:95], v[172:175], v[64:79]
    v_add_f32 v17, v17, v33
    v_add_f32 v18, v18, v34
    v_add_f32 v19, v19, v35
    v_add_f32 v20, v20, v36
    v_add_f32 v21, v21, v37
    v_add_f32 v22, v22, v38
    s_waitcnt vmcnt(9)
    v_mfma_f32_32x32x16_bf16 v[48:63], a[96:99], v[176:179], v[48:63]
    v_add_f32 v23, v23, v39
    v_add_f32 v16, v16, v40
    v_add_f32 v17, v17, v41
    v_add_f32 v18, v18, v42
    v_add_f32 v19, v19, v43
    v_mfma_f32_32x32x16_bf16 v[64:79], a[100:103], v[176:179], v[64:79]
    v_add_f32 v20, v20, v44
    v_add_f32 v21, v21, v45
    v_add_f32 v22, v22, v46
    v_add_f32 v23, v23, v47
    v_cvt_pk_bf16_f32 v8, v16, v17
    v_cvt_pk_bf16_f32 v9, v18, v19
    s_waitcnt vmcnt(8)
    v_mfma_f32_32x32x16_bf16 v[48:63], a[104:107], v[180:183], v[48:63]
    v_cvt_pk_bf16_f32 v10, v20, v21
    v_cvt_pk_bf16_f32 v11, v22, v23
    buffer_store_dwordx4 v[8:11], v128, s[20:23], s57 offen
    v_mfma_f32_32x32x16_bf16 v[64:79], a[108:111], v[180:183], v[64:79]
    s_waitcnt vmcnt(8)
    v_mfma_f32_32x32x16_bf16 v[48:63], a[112:115], v[112:115], v[48:63]
    v_mfma_f32_32x32x16_bf16 v[64:79], a[116:119], v[112:115], v[64:79]
    s_waitcnt vmcnt(7)
    v_mfma_f32_32x32x16_bf16 v[48:63], a[120:123], v[116:119], v[48:63]
    v_mfma_f32_32x32x16_bf16 v[64:79], a[124:127], v[116:119], v[64:79]
    s_waitcnt vmcnt(6)
    v_mfma_f32_32x32x16_bf16 v[48:63], a[128:131], v[120:123], v[48:63]
    v_mfma_f32_32x32x16_bf16 v[64:79], a[132:135], v[120:123], v[64:79]
    s_waitcnt vmcnt(5)
    v_mfma_f32_32x32x16_bf16 v[64:79], a[140:143], v[124:127], v[64:79]
    s_waitcnt vmcnt(4)
    v_mfma_f32_32x32x16_bf16 v[64:79], a[148:151], v[80:83], v[64:79]
    s_waitcnt vmcnt(3)
    v_mfma_f32_32x32x16_bf16 v[64:79], a[156:159], v[84:87], v[64:79]
    s_waitcnt vmcnt(2)
    v_mfma_f32_32x32x16_bf16 v[64:79], a[164:167], v[88:91], v[64:79]
    s_waitcnt vmcnt(1)
    v_mfma_f32_32x32x16_bf16 v[64:79], a[172:175], v[92:95], v[64:79]
    v_mfma_f32_32x32x16_bf16 v[48:63], a[136:139], v[124:127], v[48:63]
    v_mfma_f32_32x32x16_bf16 v[48:63], a[144:147], v[80:83], v[48:63]
    v_mfma_f32_32x32x16_bf16 v[48:63], a[152:155], v[84:87], v[48:63]
    s_nop 8
    ds_write_b128 v146, v[64:67] offset:24576
    v_mfma_f32_32x32x16_bf16 v[48:63], a[160:163], v[88:91], v[48:63]
    ds_write_b128 v146, v[68:71] offset:25600
    v_mfma_f32_32x32x16_bf16 v[48:63], a[168:171], v[92:95], v[48:63]
    ds_write_b128 v147, v[72:75] offset:24576
    ds_write_b128 v147, v[76:79] offset:25600
    s_nop 9
    ds_write_b128 v145, v[56:59] offset:24576
    ds_write_b128 v145, v[60:63] offset:25600
    v_lshlrev_b32 v12, 16, v4
    v_and_b32 v13, 0xffff0000, v4
    v_add_f32 v48, v48, v12
    v_add_f32 v49, v49, v13
    v_lshlrev_b32 v12, 16, v5
    v_and_b32 v13, 0xffff0000, v5
    v_add_f32 v50, v50, v12
    v_add_f32 v51, v51, v13
    v_lshlrev_b32 v12, 16, v6
    v_and_b32 v13, 0xffff0000, v6
    v_add_f32 v52, v52, v12
    v_add_f32 v53, v53, v13
    v_lshlrev_b32 v12, 16, v7
    v_and_b32 v13, 0xffff0000, v7
    v_add_f32 v54, v54, v12
    v_add_f32 v55, v55, v13
    s_waitcnt lgkmcnt(0)
    s_barrier
    ds_read_b128 v[64:67], v144 offset:26624
    ds_read_b128 v[68:71], v144 offset:27648
    ds_read_b128 v[72:75], v144 offset:28672
    ds_read_b128 v[76:79], v144 offset:29696
    ds_read_b128 v[56:59], v144 offset:24576
    ds_read_b128 v[60:63], v144 offset:25600
    s_waitcnt lgkmcnt(5)
    v_pk_add_f32 v[48:49], v[48:49], v[64:65]
    v_pk_add_f32 v[50:51], v[50:51], v[66:67]
    s_waitcnt lgkmcnt(4)
    v_pk_add_f32 v[52:53], v[52:53], v[68:69]
    v_pk_add_f32 v[54:55], v[54:55], v[70:71]
    s_waitcnt lgkmcnt(3)
    v_pk_add_f32 v[48:49], v[48:49], v[72:73]
    v_pk_add_f32 v[50:51], v[50:51], v[74:75]
    s_waitcnt lgkmcnt(2)
    v_pk_add_f32 v[52:53], v[52:53], v[76:77]
    v_pk_add_f32 v[54:55], v[54:55], v[78:79]
    s_waitcnt lgkmcnt(1)
    v_pk_add_f32 v[48:49], v[48:49], v[56:57]
    v_pk_add_f32 v[50:51], v[50:51], v[58:59]
    s_waitcnt lgkmcnt(0)
    v_pk_add_f32 v[52:53], v[52:53], v[60:61]
    v_pk_add_f32 v[54:55], v[54:55], v[62:63]
    v_cvt_pk_bf16_f32 v8, v48, v49
    v_cvt_pk_bf16_f32 v9, v50, v51
    v_cvt_pk_bf16_f32 v10, v52, v53
    v_cvt_pk_bf16_f32 v11, v54, v55
    buffer_store_dwordx4 v[8:11], v128, s[20:23], s58 offen
L_fin:
    s_add_u32 s56, s32, 16
    v_mov_b32 v2, s56
    v_and_b32 v3, 1073741824, v249
    s_cmp_eq_u32 s2, 0
    s_cselect_b32 s57, 0, 1073741824
    buffer_store_dword v2, v3, s[24:27], s57 offen sc1
L_end:
    s_endpgm
L_idle0:
    s_lshl_b32 s64, s38, 5
    v_add_u32 v48, s64, v248
    v_and_b32 v48, 255, v48
    v_lshlrev_b32 v48, 3, v48
    v_add_u32 v48, 16384, v48
    buffer_load_dwordx2 v[50:51], v48, s[24:27], 0 offen sc1
    s_mov_b32 s74, 0
    s_add_u32 s64, s32, 1
    s_waitcnt vmcnt(0)
    v_xor_b32 v50, s64, v50
    v_xor_b32 v51, s33, v51
    v_or_b32 v50, v50, v51
    v_cmp_ne_u32 vcc, 0, v50
    s_nop 0
    s_cbranch_vccnz L_aux2_retry
L_aux2_ok:
    s_add_u32 s83, s81, 0
    buffer_load_dwordx4 a[0:3], v150, s[24:27], s83 offen offset:0 sc1
    s_add_u32 s84, s82, 0
    buffer_load_dwordx4 a[4:7], v150, s[24:27], s84 offen offset:0 sc1
    buffer_load_dwordx4 a[8:11], v150, s[24:27], s83 offen offset:2048 sc1
    buffer_load_dwordx4 a[12:15], v150, s[24:27], s84 offen offset:2048 sc1
    s_add_u32 s83, s81, 4096
    buffer_load_dwordx4 a[16:19], v150, s[24:27], s83 offen offset:0 sc1
    s_add_u32 s84, s82, 4096
    buffer_load_dwordx4 a[20:23], v150, s[24:27], s84 offen offset:0 sc1
    buffer_load_dwordx4 a[24:27], v150, s[24:27], s83 offen offset:2048 sc1
    buffer_load_dwordx4 a[28:31], v150, s[24:27], s84 offen offset:2048 sc1
    s_add_u32 s83, s81, 8192
    buffer_load_dwordx4 a[32:35], v150, s[24:27], s83 offen offset:0 sc1
    s_add_u32 s84, s82, 8192
    buffer_load_dwordx4 a[36:39], v150, s[24:27], s84 offen offset:0 sc1
    buffer_load_dwordx4 a[40:43], v150, s[24:27], s83 offen offset:2048 sc1
    buffer_load_dwordx4 a[44:47], v150, s[24:27], s84 offen offset:2048 sc1
    s_add_u32 s83, s81, 12288
    buffer_load_dwordx4 a[48:51], v150, s[24:27], s83 offen offset:0 sc1
    s_add_u32 s84, s82, 12288
    buffer_load_dwordx4 a[52:55], v150, s[24:27], s84 offen offset:0 sc1
    buffer_load_dwordx4 a[56:59], v150, s[24:27], s83 offen offset:2048 sc1
    buffer_load_dwordx4 a[60:63], v150, s[24:27], s84 offen offset:2048 sc1
    s_add_u32 s83, s81, 16384
    buffer_load_dwordx4 a[64:67], v150, s[24:27], s83 offen offset:0 sc1
    s_add_u32 s84, s82, 16384
    buffer_load_dwordx4 a[68:71], v150, s[24:27], s84 offen offset:0 sc1
    buffer_load_dwordx4 a[72:75], v150, s[24:27], s83 offen offset:2048 sc1
    buffer_load_dwordx4 a[76:79], v150, s[24:27], s84 offen offset:2048 sc1
    s_add_u32 s83, s81, 20480
    buffer_load_dwordx4 a[80:83], v150, s[24:27], s83 offen offset:0 sc1
    s_add_u32 s84, s82, 20480
    buffer_load_dwordx4 a[84:87], v150, s[24:27], s84 offen offset:0 sc1
    buffer_load_dwordx4 a[88:91], v150, s[24:27], s83 offen offset:2048 sc1
    buffer_load_dwordx4 a[92:95], v150, s[24:27], s84 offen offset:2048 sc1
    s_add_u32 s83, s81, 24576
    buffer_load_dwordx4 a[96:99], v150, s[24:27], s83 offen offset:0 sc1
    s_add_u32 s84, s82, 24576
    buffer_load_dwordx4 a[100:103], v150, s[24:27], s84 offen offset:0 sc1
    buffer_load_dwordx4 a[104:107], v150, s[24:27], s83 offen offset:2048 sc1
    buffer_load_dwordx4 a[108:111], v150, s[24:27], s84 offen offset:2048 sc1
    s_add_u32 s83, s81, 28672
    buffer_load_dwordx4 a[112:115], v150, s[24:27], s83 offen offset:0 sc1
    s_add_u32 s56, s32, 2
    v_mov_b32 v112, s56
    v_mov_b32 v113, s33
    s_cmp_lg_u32 s40, 0
    s_barrier
    s_cbranch_scc1 L_interleave_layers__spectral_fnet__swiglu_ffn__prompt_pb_19_slow
    buffer_store_dwordx2 v[112:113], v249, s[24:27], 0 offen
L_interleave_layers__spectral_fnet__swiglu_ffn__prompt_pb_19_back:
    s_waitcnt vmcnt(0) lgkmcnt(0)
    s_branch L_idle0_back
L_idle1:
    s_add_u32 s56, s32, 8
    v_mov_b32 v112, s56
    v_mov_b32 v113, s33
    s_cmp_lg_u32 s40, 0
    s_barrier
    s_cbranch_scc1 L_interleave_layers__spectral_fnet__swiglu_ffn__prompt_pb_20_slow
    buffer_store_dwordx2 v[112:113], v249, s[24:27], 0 offen
L_interleave_layers__spectral_fnet__swiglu_ffn__prompt_pb_20_back:
    v_lshl_add_u32 v114, v254, 3, s46
    s_andn2_b32 s71, 1073741824, s72
    buffer_load_dwordx2 v[116:117], v114, s[24:27], s71 offen sc1
    s_waitcnt vmcnt(0) lgkmcnt(0)
    s_branch L_idle1_back
L_flags_retry:
    buffer_load_dwordx2 v[106:107], v104, s[24:27], 0 offen sc1
    buffer_load_dwordx2 v[108:109], v105, s[24:27], 0 offen sc1
    s_add_u32 s56, s32, 8
    s_add_u32 s57, s32, 1
    s_waitcnt vmcnt(1)
    v_subrev_u32 v110, s56, v106
    s_waitcnt vmcnt(0)
    v_xor_b32 v111, s57, v108
    v_lshrrev_b32 v110, 3, v110
    v_xor_b32 v112, s33, v107
    v_xor_b32 v113, s33, v109
    v_or3_b32 v110, v110, v111, v112
    v_or_b32 v110, v110, v113
    v_cmp_ne_u32 vcc, 0, v110
    s_add_u32 s74, s74, 1
    s_cbranch_vccz L_flags_ok
    s_cmp_lt_u32 s74, 32768
    s_cbranch_scc1 L_flags_retry
    s_add_u32 s75, s75, 1
    s_branch L_flags_ok
L_z0_retry:
    s_add_u32 s56, s50, 0
    buffer_load_dword v184, v168, s[24:27], s56 offen offset:0 sc1
    buffer_load_dword v185, v168, s[24:27], s56 offen offset:1024 sc1
    buffer_load_dword v186, v168, s[24:27], s56 offen offset:2048 sc1
    buffer_load_dword v187, v168, s[24:27], s56 offen offset:3072 sc1
    s_add_u32 s56, s50, 8192
    buffer_load_dword v188, v168, s[24:27], s56 offen offset:0 sc1
    buffer_load_dword v189, v168, s[24:27], s56 offen offset:1024 sc1
    buffer_load_dword v190, v168, s[24:27], s56 offen offset:2048 sc1
    buffer_load_dword v191, v168, s[24:27], s56 offen offset:3072 sc1
    s_add_u32 s56, s50, 16384
    buffer_load_dword v192, v168, s[24:27], s56 offen offset:0 sc1
    buffer_load_dword v193, v168, s[24:27], s56 offen offset:1024 sc1
    buffer_load_dword v194, v168, s[24:27], s56 offen offset:2048 sc1
    buffer_load_dword v195, v168, s[24:27], s56 offen offset:3072 sc1
    s_add_u32 s56, s50, 24576
    buffer_load_dword v196, v168, s[24:27], s56 offen offset:0 sc1
    buffer_load_dword v197, v168, s[24:27], s56 offen offset:1024 sc1
    buffer_load_dword v198, v168, s[24:27], s56 offen offset:2048 sc1
    buffer_load_dword v199, v168, s[24:27], s56 offen offset:3072 sc1
    s_waitcnt vmcnt(13)
    v_max3_u32 v16, v184, v185, v186
    s_waitcnt vmcnt(10)
    v_max3_u32 v17, v187, v188, v189
    s_waitcnt vmcnt(7)
    v_max3_u32 v18, v190, v191, v192
    s_waitcnt vmcnt(4)
    v_max3_u32 v19, v193, v194, v195
    s_waitcnt vmcnt(1)
    v_max3_u32 v20, v196, v197, v198
    v_max3_u32 v16, v16, v17, v18
    s_waitcnt vmcnt(0)
    v_max3_u32 v19, v19, v20, v199
    v_max_u32 v16, v16, v19
    v_cmp_eq_u32 vcc, -1, v16
    s_add_u32 s74, s74, 1
    s_cbranch_vccz L_z0_ok
    s_cmp_lt_u32 s74, 32768
    s_cbranch_scc1 L_z0_retry
    s_add_u32 s75, s75, 1
    s_branch L_z0_ok
L_aux_retry:
    buffer_load_dwordx2 v[50:51], v48, s[24:27], 0 offen sc1
    s_add_u32 s64, s32, 1
    s_waitcnt vmcnt(0)
    v_xor_b32 v50, s64, v50
    v_xor_b32 v51, s33, v51
    v_or_b32 v50, v50, v51
    v_cmp_ne_u32 vcc, 0, v50
    s_add_u32 s74, s74, 1
    s_cbranch_vccz L_aux_ok
    s_cmp_lt_u32 s74, 32768
    s_cbranch_scc1 L_aux_retry
    s_add_u32 s75, s75, 1
    s_branch L_aux_ok
L_z1_retry:
L_pad6:
    s_cbranch_execz L_chain_ret
    s_add_u32 s56, s50, 0
    buffer_load_dword v184, v168, s[24:27], s56 offen offset:0 sc1
    buffer_load_dword v185, v168, s[24:27], s56 offen offset:1024 sc1
    buffer_load_dword v186, v168, s[24:27], s56 offen offset:2048 sc1
    buffer_load_dword v187, v168, s[24:27], s56 offen offset:3072 sc1
    s_add_u32 s56, s50, 8192
    buffer_load_dword v188, v168, s[24:27], s56 offen offset:0 sc1
    buffer_load_dword v189, v168, s[24:27], s56 offen offset:1024 sc1
    buffer_load_dword v190, v168, s[24:27], s56 offen offset:2048 sc1
    buffer_load_dword v191, v168, s[24:27], s56 offen offset:3072 sc1
    s_add_u32 s56, s50, 16384
    buffer_load_dword v192, v168, s[24:27], s56 offen offset:0 sc1
    buffer_load_dword v193, v168, s[24:27], s56 offen offset:1024 sc1
    buffer_load_dword v194, v168, s[24:27], s56 offen offset:2048 sc1
    buffer_load_dword v195, v168, s[24:27], s56 offen offset:3072 sc1
    s_add_u32 s56, s50, 24576
    buffer_load_dword v196, v168, s[24:27], s56 offen offset:0 sc1
    buffer_load_dword v197, v168, s[24:27], s56 offen offset:1024 sc1
    buffer_load_dword v198, v168, s[24:27], s56 offen offset:2048 sc1
    buffer_load_dword v199, v168, s[24:27], s56 offen offset:3072 sc1
    s_waitcnt vmcnt(13)
    v_max3_u32 v16, v184, v185, v186
    s_waitcnt vmcnt(10)
    v_max3_u32 v17, v187, v188, v189
    s_waitcnt vmcnt(7)
    v_max3_u32 v18, v190, v191, v192
    s_waitcnt vmcnt(4)
    v_max3_u32 v19, v193, v194, v195
    s_waitcnt vmcnt(1)
    v_max3_u32 v20, v196, v197, v198
    v_max3_u32 v16, v16, v17, v18
    s_waitcnt vmcnt(0)
    v_max3_u32 v19, v19, v20, v199
    v_max_u32 v16, v16, v19
    v_cmp_eq_u32 vcc, -1, v16
    s_add_u32 s74, s74, 1
    s_cbranch_vccz L_z1_ok
    s_cmp_lt_u32 s74, 32768
    s_cbranch_scc1 L_z1_retry
    s_add_u32 s75, s75, 1
    s_branch L_z1_ok
L_aux2_retry:
    buffer_load_dwordx2 v[50:51], v48, s[24:27], 0 offen sc1
    s_add_u32 s64, s32, 1
    s_waitcnt vmcnt(0)
    v_xor_b32 v50, s64, v50
    v_xor_b32 v51, s33, v51
    v_or_b32 v50, v50, v51
    v_cmp_ne_u32 vcc, 0, v50
    s_add_u32 s74, s74, 1
    s_cbranch_vccz L_aux2_ok
    s_cmp_lt_u32 s74, 32768
    s_cbranch_scc1 L_aux2_retry
    s_add_u32 s75, s75, 1
    s_branch L_aux2_ok
L_interleave_layers__spectral_fnet__swiglu_ffn__prompt_cf_2_retry:
    s_mov_b32 s74, 0
L_interleave_layers__spectral_fnet__swiglu_ffn__prompt_cf_2_again:
    buffer_load_dwordx2 v[6:7], v4, s[24:27], 0 offen sc1
    s_add_u32 s70, s32, 1
    s_waitcnt vmcnt(0)
    v_subrev_u32 v6, s70, v6
    v_xor_b32 v7, s33, v7
    v_lshrrev_b32 v6, 3, v6
    v_or_b32 v6, v6, v7
    v_cmp_ne_u32 vcc, 0, v6
    s_add_u32 s74, s74, 1
    s_cbranch_vccz L_interleave_layers__spectral_fnet__swiglu_ffn__prompt_cf_2_seen
    s_cmp_lt_u32 s74, 32768
    s_cbranch_scc1 L_interleave_layers__spectral_fnet__swiglu_ffn__prompt_cf_2_again
    s_add_u32 s75, s75, 1
L_interleave_layers__spectral_fnet__swiglu_ffn__prompt_cf_2_seen:
    s_cmp_eq_u32 s40, 0
    s_cbranch_scc1 L_interleave_layers__spectral_fnet__swiglu_ffn__prompt_cf_2_ok
    buffer_inv sc1
    s_waitcnt vmcnt(0)
    s_branch L_interleave_layers__spectral_fnet__swiglu_ffn__prompt_cf_2_ok
L_interleave_layers__spectral_fnet__swiglu_ffn__prompt_cf_4_retry:
    s_mov_b32 s74, 0
L_interleave_layers__spectral_fnet__swiglu_ffn__prompt_cf_4_again:
    buffer_load_dwordx2 v[116:117], v114, s[24:27], 0 offen sc1
    s_add_u32 s70, s32, 2
    s_waitcnt vmcnt(0)
    v_subrev_u32 v116, s70, v116
    v_xor_b32 v117, s33, v117
    v_lshrrev_b32 v116, 3, v116
    v_or_b32 v116, v116, v117
    v_cmp_ne_u32 vcc, 0, v116
    s_add_u32 s74, s74, 1
    s_cbranch_vccz L_interleave_layers__spectral_fnet__swiglu_ffn__prompt_cf_4_seen
    s_cmp_lt_u32 s74, 32768
    s_cbranch_scc1 L_interleave_layers__spectral_fnet__swiglu_ffn__prompt_cf_4_again
    s_add_u32 s75, s75, 1
L_interleave_layers__spectral_fnet__swiglu_ffn__prompt_cf_4_seen:
    s_cmp_eq_u32 s40, 0
    s_cbranch_scc1 L_interleave_layers__spectral_fnet__swiglu_ffn__prompt_cf_4_ok
    buffer_inv sc1
    s_waitcnt vmcnt(0)
    s_branch L_interleave_layers__spectral_fnet__swiglu_ffn__prompt_cf_4_ok
L_interleave_layers__spectral_fnet__swiglu_ffn__prompt_cf_6_retry:
    s_mov_b32 s74, 0
L_interleave_layers__spectral_fnet__swiglu_ffn__prompt_cf_6_again:
    buffer_load_dwordx2 v[134:135], v132, s[24:27], 0 offen sc1
    s_add_u32 s70, s32, 3
    s_waitcnt vmcnt(0)
    v_subrev_u32 v134, s70, v134
    v_xor_b32 v135, s33, v135
    v_lshrrev_b32 v134, 3, v134
    v_or_b32 v134, v134, v135
    v_cmp_ne_u32 vcc, 0, v134
    s_add_u32 s74, s74, 1
    s_cbranch_vccz L_interleave_layers__spectral_fnet__swiglu_ffn__prompt_cf_6_seen
    s_cmp_lt_u32 s74, 32768
    s_cbranch_scc1 L_interleave_layers__spectral_fnet__swiglu_ffn__prompt_cf_6_again
    s_add_u32 s75, s75, 1
L_interleave_layers__spectral_fnet__swiglu_ffn__prompt_cf_6_seen:
    s_cmp_eq_u32 s40, 0
    s_cbranch_scc1 L_interleave_layers__spectral_fnet__swiglu_ffn__prompt_cf_6_ok
    buffer_inv sc1
    s_waitcnt vmcnt(0)
    s_branch L_interleave_layers__spectral_fnet__swiglu_ffn__prompt_cf_6_ok
L_interleave_layers__spectral_fnet__swiglu_ffn__prompt_cf_8_retry:
    s_mov_b32 s74, 0
L_interleave_layers__spectral_fnet__swiglu_ffn__prompt_cf_8_again:
    buffer_load_dwordx2 v[166:167], v164, s[24:27], 0 offen sc1
    s_add_u32 s70, s32, 4
    s_waitcnt vmcnt(0)
    v_subrev_u32 v166, s70, v166
    v_xor_b32 v167, s33, v167
    v_lshrrev_b32 v166, 3, v166
    v_or_b32 v166, v166, v167
    v_cmp_ne_u32 vcc, 0, v166
    s_add_u32 s74, s74, 1
    s_cbranch_vccz L_interleave_layers__spectral_fnet__swiglu_ffn__prompt_cf_8_seen
    s_cmp_lt_u32 s74, 32768
    s_cbranch_scc1 L_interleave_layers__spectral_fnet__swiglu_ffn__prompt_cf_8_again
    s_add_u32 s75, s75, 1
L_interleave_layers__spectral_fnet__swiglu_ffn__prompt_cf_8_seen:
    s_cmp_eq_u32 s40, 0
    s_cbranch_scc1 L_interleave_layers__spectral_fnet__swiglu_ffn__prompt_cf_8_ok
    buffer_inv sc1
    s_waitcnt vmcnt(0)
    s_branch L_interleave_layers__spectral_fnet__swiglu_ffn__prompt_cf_8_ok
L_interleave_layers__spectral_fnet__swiglu_ffn__prompt_cf_10_retry:
    s_mov_b32 s74, 0
L_interleave_layers__spectral_fnet__swiglu_ffn__prompt_cf_10_again:
    buffer_load_dwordx2 v[166:167], v164, s[24:27], 0 offen sc1
    s_add_u32 s70, s32, 5
    s_waitcnt vmcnt(0)
    v_subrev_u32 v166, s70, v166
    v_xor_b32 v167, s33, v167
    v_lshrrev_b32 v166, 3, v166
    v_or_b32 v166, v166, v167
    v_cmp_ne_u32 vcc, 0, v166
    s_add_u32 s74, s74, 1
    s_cbranch_vccz L_interleave_layers__spectral_fnet__swiglu_ffn__prompt_cf_10_seen
    s_cmp_lt_u32 s74, 32768
    s_cbranch_scc1 L_interleave_layers__spectral_fnet__swiglu_ffn__prompt_cf_10_again
    s_add_u32 s75, s75, 1
L_interleave_layers__spectral_fnet__swiglu_ffn__prompt_cf_10_seen:
    s_cmp_eq_u32 s40, 0
    s_cbranch_scc1 L_interleave_layers__spectral_fnet__swiglu_ffn__prompt_cf_10_ok
    buffer_inv sc1
    s_waitcnt vmcnt(0)
    s_branch L_interleave_layers__spectral_fnet__swiglu_ffn__prompt_cf_10_ok
L_interleave_layers__spectral_fnet__swiglu_ffn__prompt_cf_12_retry:
    s_mov_b32 s74, 0
L_interleave_layers__spectral_fnet__swiglu_ffn__prompt_cf_12_again:
L_pad7:
    s_cbranch_execz L_chain_ret
    buffer_load_dwordx2 v[6:7], v4, s[24:27], 0 offen sc1
    s_add_u32 s70, s32, 6
    s_waitcnt vmcnt(0)
    v_subrev_u32 v6, s70, v6
    v_xor_b32 v7, s33, v7
    v_lshrrev_b32 v6, 3, v6
    v_or_b32 v6, v6, v7
    v_cmp_ne_u32 vcc, 0, v6
    s_add_u32 s74, s74, 1
    s_cbranch_vccz L_interleave_layers__spectral_fnet__swiglu_ffn__prompt_cf_12_seen
    s_cmp_lt_u32 s74, 32768
    s_cbranch_scc1 L_interleave_layers__spectral_fnet__swiglu_ffn__prompt_cf_12_again
    s_add_u32 s75, s75, 1
L_interleave_layers__spectral_fnet__swiglu_ffn__prompt_cf_12_seen:
    s_cmp_eq_u32 s40, 0
    s_cbranch_scc1 L_interleave_layers__spectral_fnet__swiglu_ffn__prompt_cf_12_ok
    buffer_inv sc1
    s_waitcnt vmcnt(0)
    s_branch L_interleave_layers__spectral_fnet__swiglu_ffn__prompt_cf_12_ok
L_interleave_layers__spectral_fnet__swiglu_ffn__prompt_cf_14_retry:
L_pad8:
    s_cbranch_execz L_chain_ret
    s_mov_b32 s74, 0
L_interleave_layers__spectral_fnet__swiglu_ffn__prompt_cf_14_again:
    buffer_load_dwordx2 v[6:7], v4, s[24:27], 0 offen sc1
    s_add_u32 s70, s32, 7
    s_waitcnt vmcnt(0)
    v_subrev_u32 v6, s70, v6
    v_xor_b32 v7, s33, v7
    v_lshrrev_b32 v6, 3, v6
    v_or_b32 v6, v6, v7
    v_cmp_ne_u32 vcc, 0, v6
    s_add_u32 s74, s74, 1
    s_cbranch_vccz L_interleave_layers__spectral_fnet__swiglu_ffn__prompt_cf_14_seen
    s_cmp_lt_u32 s74, 32768
    s_cbranch_scc1 L_interleave_layers__spectral_fnet__swiglu_ffn__prompt_cf_14_again
    s_add_u32 s75, s75, 1
L_interleave_layers__spectral_fnet__swiglu_ffn__prompt_cf_14_seen:
    s_cmp_eq_u32 s40, 0
    s_cbranch_scc1 L_interleave_layers__spectral_fnet__swiglu_ffn__prompt_cf_14_ok
    buffer_inv sc1
    s_waitcnt vmcnt(0)
    s_branch L_interleave_layers__spectral_fnet__swiglu_ffn__prompt_cf_14_ok
L_interleave_layers__spectral_fnet__swiglu_ffn__prompt_cf_16_retry:
    s_mov_b32 s74, 0
L_interleave_layers__spectral_fnet__swiglu_ffn__prompt_cf_16_again:
    buffer_load_dwordx2 v[116:117], v114, s[24:27], 0 offen sc1
    s_add_u32 s70, s32, 8
    s_waitcnt vmcnt(0)
    v_subrev_u32 v116, s70, v116
    v_xor_b32 v117, s33, v117
    v_lshrrev_b32 v116, 3, v116
    v_or_b32 v116, v116, v117
    v_cmp_ne_u32 vcc, 0, v116
    s_add_u32 s74, s74, 1
    s_cbranch_vccz L_interleave_layers__spectral_fnet__swiglu_ffn__prompt_cf_16_seen
    s_cmp_lt_u32 s74, 32768
    s_cbranch_scc1 L_interleave_layers__spectral_fnet__swiglu_ffn__prompt_cf_16_again
    s_add_u32 s75, s75, 1
L_interleave_layers__spectral_fnet__swiglu_ffn__prompt_cf_16_seen:
    s_cmp_eq_u32 s40, 0
    s_cbranch_scc1 L_interleave_layers__spectral_fnet__swiglu_ffn__prompt_cf_16_ok
    buffer_inv sc1
    s_waitcnt vmcnt(0)
    s_branch L_interleave_layers__spectral_fnet__swiglu_ffn__prompt_cf_16_ok
L_interleave_layers__spectral_fnet__swiglu_ffn__prompt_cf_18_retry:
    s_mov_b32 s74, 0
L_interleave_layers__spectral_fnet__swiglu_ffn__prompt_cf_18_again:
    buffer_load_dwordx2 v[134:135], v132, s[24:27], 0 offen sc1
    s_add_u32 s70, s32, 9
    s_waitcnt vmcnt(0)
    v_subrev_u32 v134, s70, v134
    v_xor_b32 v135, s33, v135
    v_lshrrev_b32 v134, 3, v134
    v_or_b32 v134, v134, v135
    v_cmp_ne_u32 vcc, 0, v134
    s_add_u32 s74, s74, 1
    s_cbranch_vccz L_interleave_layers__spectral_fnet__swiglu_ffn__prompt_cf_18_seen
    s_cmp_lt_u32 s74, 32768
    s_cbranch_scc1 L_interleave_layers__spectral_fnet__swiglu_ffn__prompt_cf_18_again
    s_add_u32 s75, s75, 1
L_interleave_layers__spectral_fnet__swiglu_ffn__prompt_cf_18_seen:
    s_cmp_eq_u32 s40, 0
    s_cbranch_scc1 L_interleave_layers__spectral_fnet__swiglu_ffn__prompt_cf_18_ok
    buffer_inv sc1
    s_waitcnt vmcnt(0)
    s_branch L_interleave_layers__spectral_fnet__swiglu_ffn__prompt_cf_18_ok
L_interleave_layers__spectral_fnet__swiglu_ffn__prompt_pb_1_slow:
    buffer_wbl2 sc1
    s_waitcnt vmcnt(0)
    buffer_store_dwordx2 v[2:3], v249, s[24:27], 0 offen sc1
    s_nop 7
    s_branch L_interleave_layers__spectral_fnet__swiglu_ffn__prompt_pb_1_back
L_interleave_layers__spectral_fnet__swiglu_ffn__prompt_pb_3_slow:
    buffer_wbl2 sc1
    s_waitcnt vmcnt(0)
    buffer_store_dwordx2 v[112:113], v249, s[24:27], 0 offen sc1
    s_nop 7
    s_branch L_interleave_layers__spectral_fnet__swiglu_ffn__prompt_pb_3_back
L_interleave_layers__spectral_fnet__swiglu_ffn__prompt_pb_5_slow:
    buffer_wbl2 sc1
    s_waitcnt vmcnt(0)
    buffer_store_dwordx2 v[132:133], v249, s[24:27], 0 offen sc1
    s_nop 7
    s_branch L_interleave_layers__spectral_fnet__swiglu_ffn__prompt_pb_5_back
L_interleave_layers__spectral_fnet__swiglu_ffn__prompt_pb_7_slow:
    buffer_wbl2 sc1
    s_waitcnt vmcnt(0)
    buffer_store_dwordx2 v[136:137], v249, s[24:27], 0 offen sc1
    s_nop 7
    s_branch L_interleave_layers__spectral_fnet__swiglu_ffn__prompt_pb_7_back
L_interleave_layers__spectral_fnet__swiglu_ffn__prompt_pb_9_slow:
    buffer_wbl2 sc1
    s_waitcnt vmcnt(0)
    buffer_store_dwordx2 v[136:137], v249, s[24:27], 0 offen sc1
    s_nop 7
    s_branch L_interleave_layers__spectral_fnet__swiglu_ffn__prompt_pb_9_back
L_interleave_layers__spectral_fnet__swiglu_ffn__prompt_pb_11_slow:
    buffer_wbl2 sc1
    s_waitcnt vmcnt(0)
    buffer_store_dwordx2 v[164:165], v249, s[24:27], 0 offen sc1
    s_nop 7
    s_branch L_interleave_layers__spectral_fnet__swiglu_ffn__prompt_pb_11_back
L_interleave_layers__spectral_fnet__swiglu_ffn__prompt_pb_13_slow:
    buffer_wbl2 sc1
    s_waitcnt vmcnt(0)
    buffer_store_dwordx2 v[2:3], v249, s[24:27], 0 offen sc1
    s_nop 7
    s_branch L_interleave_layers__spectral_fnet__swiglu_ffn__prompt_pb_13_back
L_interleave_layers__spectral_fnet__swiglu_ffn__prompt_pb_15_slow:
    buffer_wbl2 sc1
    s_waitcnt vmcnt(0)
    buffer_store_dwordx2 v[112:113], v249, s[24:27], 0 offen sc1
    s_nop 7
    s_branch L_interleave_layers__spectral_fnet__swiglu_ffn__prompt_pb_15_back
L_interleave_layers__spectral_fnet__swiglu_ffn__prompt_pb_17_slow:
    buffer_wbl2 sc1
    s_waitcnt vmcnt(0)
    buffer_store_dwordx2 v[136:137], v249, s[24:27], 0 offen sc1
    s_nop 7
    s_branch L_interleave_layers__spectral_fnet__swiglu_ffn__prompt_pb_17_back
L_interleave_layers__spectral_fnet__swiglu_ffn__prompt_pb_19_slow:
    buffer_wbl2 sc1
    s_waitcnt vmcnt(0)
    buffer_store_dwordx2 v[112:113], v249, s[24:27], 0 offen sc1
    s_nop 7
    s_branch L_interleave_layers__spectral_fnet__swiglu_ffn__prompt_pb_19_back
L_interleave_layers__spectral_fnet__swiglu_ffn__prompt_pb_20_slow:
    buffer_wbl2 sc1
    s_waitcnt vmcnt(0)
    buffer_store_dwordx2 v[112:113], v249, s[24:27], 0 offen sc1
    s_nop 7
    s_branch L_interleave_layers__spectral_fnet__swiglu_ffn__prompt_pb_20_back
.fill 64, 4, 0xbf800000
.section .rodata,"a"
.p2align 6
.amdhsa_kernel interleave_layers__spectral_fnet__swiglu_ffn__prompt_kernel
  .amdhsa_next_free_vgpr 512
  .amdhsa_next_free_sgpr 102
  .amdhsa_accum_offset 256
  .amdhsa_group_segment_fixed_size 0
  .amdhsa_kernarg_size 96
  .amdhsa_user_sgpr_count 2
  .amdhsa_user_sgpr_kernarg_segment_ptr 1
  .amdhsa_system_sgpr_workgroup_id_x 1
  .amdhsa_float_denorm_mode_32 3
.end_amdhsa_kernel
```
